```python
import torch

def _softmax(x, axis=-1):
    return torch.softmax(x, dim=axis)

def _gelu(x):
    return torch.nn.functional.gelu(x, approximate='tanh')

def _silu(x):
    return torch.nn.functional.silu(x)

def _sigmoid(x):
    return torch.sigmoid(x)

def _layernorm(x, axis=-1, eps=1e-05):
    m = x.mean(dim=axis, keepdim=True)
    v = x.var(dim=axis, keepdim=True, unbiased=False)
    return (x - m) / torch.sqrt(v + eps)

def _scatter_add(tgt, idx, src, axis=0):
    return tgt.clone().index_add_(axis, idx, src)

def _segment_sum(src, seg, n):
    out = torch.zeros((n,) + src.shape[1:], dtype=src.dtype)
    return out.index_add_(0, seg, src)

def _pad(x, pw):
    flat = tuple((v for pair in reversed(pw) for v in pair))
    return torch.nn.functional.pad(x, flat)
kernel_name = 'interleave_layers__linear_attn_block__memory_aug_recurrent_mem_tr__prompt'

def setup_inputs():

    _w = lambda a: (lambda t: t.to(torch.bfloat16) if t.is_floating_point() else t)(torch.as_tensor(a))

    def _A_setup():
        B, S, D = (1, 2048, 576)
        return {'x': _w((lambda *s: torch.randn(*s, dtype=torch.bfloat16) * 0.05)(B, S, D)), 'wqkv': _w((lambda *s: torch.randn(*s, dtype=torch.bfloat16) * 0.05)(D, 3 * D)), 'wo': _w((lambda *s: torch.randn(*s, dtype=torch.bfloat16) * 0.05)(D, D))}
    _A_in = _A_setup()

    def _B_setup():
        B, S, Dm = (1, 2048, 576)
        H, Dh = (32, 128)
        M, seg = (8, 32)
        seg = min(seg, S)
        S = S // seg * seg
        return {'x': _w((lambda *s: torch.randn(*s, dtype=torch.bfloat16) * 0.05)(B, S, Dm)), 'mem0': _w((lambda *s: torch.randn(*s, dtype=torch.bfloat16) * 0.8)(B, M, Dm)), 'Wq': _w((lambda *s: torch.randn(*s, dtype=torch.bfloat16) * 1.6)(Dm, H, Dh) * Dm ** (-0.5)), 'Wk': _w((lambda *s: torch.randn(*s, dtype=torch.bfloat16) * 1.6)(Dm, H, Dh) * Dm ** (-0.5)), 'Wv': _w((lambda *s: torch.randn(*s, dtype=torch.bfloat16) * 0.8)(Dm, H, Dh) * Dm ** (-0.5)), 'Wo': _w((lambda *s: torch.randn(*s, dtype=torch.bfloat16) * 0.8)(H, Dh, Dm) * (H * Dh) ** (-0.5)), 'seg_len': seg}
    _B_in = _B_setup()
    return {'A_x': _A_in['x'], 'A_wqkv': _A_in['wqkv'], 'A_wo': _A_in['wo'], 'B_x': _B_in['x'], 'B_mem0': _B_in['mem0'], 'B_Wq': _B_in['Wq'], 'B_Wk': _B_in['Wk'], 'B_Wv': _B_in['Wv'], 'B_Wo': _B_in['Wo'], 'B_seg_len': _B_in['seg_len']}

def reference(A_x, A_wqkv, A_wo, B_x, B_mem0, B_Wq, B_Wk, B_Wv, B_Wo, B_seg_len):

    def _A_ref(x, wqkv, wo):
        B, S, D = x.shape
        H = 32
        Dh = D // H
        qkv = (lambda x, *d: x.permute(*d))((x @ wqkv).reshape(B, S, 3, H, Dh), 2, 0, 3, 1, 4)
        q, k, v = (qkv[0], qkv[1], qkv[2])
        phi = lambda t: torch.where(t > 0, t + 1, torch.exp(t)) + 1e-06
        pq, pk = (phi(q), phi(k))
        kv = torch.einsum('bhsd,bhse->bhde', pk, v)
        z = torch.einsum('bhsd->bhd', pk)
        num = torch.einsum('bhqd,bhde->bhqe', pq, kv)
        den = torch.einsum('bhqd,bhd->bhq', pq, z)[..., None] + 1e-06
        o = num / den
        return (lambda x, *d: x.permute(*d))(o, 0, 2, 1, 3).reshape(B, S, D) @ wo

    def _B_ref(x, mem0, Wq, Wk, Wv, Wo, seg_len):
        B, S, Dm = x.shape
        H, Dh = (Wq.shape[1], Wq.shape[2])
        M = mem0.shape[1]
        scale = Dh ** (-0.5)
        n_seg = S // seg_len
        L = M + seg_len
        idx = torch.arange(L)
        mask = (idx[:, None] < M) | (idx[:, None] >= idx[None, :])
        mem = mem0
        outs = []
        for s in range(n_seg):
            xs = x[:, s * seg_len:(s + 1) * seg_len, :].clone()
            h = torch.concatenate([mem, xs], axis=1)
            q = torch.einsum('btd,dhe->bhte', h, Wq)
            k = torch.einsum('btd,dhe->bhte', h, Wk)
            v = torch.einsum('btd,dhe->bhte', h, Wv)
            scores = torch.einsum('bhqe,bhke->bhqk', q, k) * scale
            scores = torch.where(mask[None, None], scores, -1000000000.0)
            p = _softmax(scores, axis=-1)
            o = torch.einsum('bhqk,bhke->bhqe', p, v)
            o = torch.einsum('bhte,hed->btd', o, Wo)
            mem = o[:, :M, :].clone()
            outs.append(o[:, M:, :])
        return torch.concatenate(outs, axis=1)
    x = A_x
    x = x + _A_ref(_layernorm(x, axis=-1), A_wqkv, A_wo)
    x = x + _B_ref(_layernorm(x, axis=-1), B_mem0, B_Wq, B_Wk, B_Wv, B_Wo, B_seg_len)
    x = x + _A_ref(_layernorm(x, axis=-1), A_wqkv, A_wo)
    x = x + _B_ref(_layernorm(x, axis=-1), B_mem0, B_Wq, B_Wk, B_Wv, B_Wo, B_seg_len)
    return x
```

```asm
; @launch grid=(256,1,1) block=(256,1,1) lds=163840
.amdgcn_target "amdgcn-amd-amdhsa--gfx950"
.text
.globl interleave_layers__linear_attn_block__memory_aug_recurrent_mem_tr__prompt_kernel
.p2align 8
.type interleave_layers__linear_attn_block__memory_aug_recurrent_mem_tr__prompt_kernel,@function
interleave_layers__linear_attn_block__memory_aug_recurrent_mem_tr__prompt_kernel:
s_cmp_ge_u32 s2, 256
s_cbranch_scc0 START
s_endpgm
START:
s_load_dwordx2 s[4:5], s[0:1], 96
s_mov_b32 s6, 268435456
s_mov_b32 s7, 0x20000
s_waitcnt lgkmcnt(0)
s_load_dwordx2 s[16:17], s[0:1], 88
s_mov_b32 s18, 256
s_mov_b32 s19, 0x20000
s_waitcnt lgkmcnt(0)
v_lshrrev_b32 v1, 6, v0
v_and_b32 v0, 63, v0
v_readfirstlane_b32 s24, v1
v_lshlrev_b32 v1, 4, v0
s_mov_b32 s25, 400000
s_and_b32 s40, s2, 7
s_lshr_b32 s41, s2, 3
s_mov_b32 s34, 0
s_mov_b32 s84, 0
s_mov_b32 s85, 0
s_mov_b32 s86, 0
s_mov_b32 s87, 0
s_mov_b32 s88, 0
s_mov_b32 s89, 0
s_mov_b32 s90, 0
s_mov_b32 s91, 0
s_mov_b32 s52, s41
s_cmp_eq_u32 s40, 0
s_cbranch_scc1 CH
s_load_dwordx2 s[64:65], s[0:1], 8
s_mov_b32 s66, 1990656
s_mov_b32 s67, 0x20000
s_waitcnt lgkmcnt(0)
s_lshl_b32 s42, s41, 2
s_add_u32 s42, s42, s24
s_lshl_b32 s42, s42, 14
v_lshl_add_u32 v6, v0, 7, s42
buffer_load_dword v7, v6, s[64:67], 0 offen
v_add_u32 v6, 8192, v6
buffer_load_dword v7, v6, s[64:67], 0 offen
s_cmp_ge_u32 s40, 6
s_cbranch_scc1 R67
s_sub_u32 s40, s40, 1
s_lshl_b32 s40, s40, 5
s_add_u32 s40, s40, s41
s_lshr_b32 s52, s40, 2
s_and_b32 s53, s40, 3
s_lshr_b32 s32, s40, 3
s_and_b32 s33, s40, 7
s_mov_b32 s34, 1
s_cmp_lt_u32 s40, 128
s_cbranch_scc1 P1
s_cmp_lt_u32 s41, 24
s_cselect_b32 s34, 2, 0
s_cmp_ge_u32 s41, 12
s_cselect_b32 s52, 4, 3
s_cselect_b32 s53, 12, 0
s_sub_u32 s53, s41, s53
s_branch P1
R67:
s_cmp_eq_u32 s40, 7
s_cbranch_scc1 R7
s_mov_b32 s32, 20
s_sub_u32 s33, s41, 24
s_cmp_ge_u32 s41, 24
s_cbranch_scc1 P1
s_cmp_ge_u32 s41, 12
s_cselect_b32 s32, 1, 0
s_mul_i32 s33, s32, 12
s_sub_u32 s33, s41, s33
s_branch P4
R7:
s_mov_b32 s32, 2
s_mov_b32 s33, s41
s_cmp_lt_u32 s41, 12
s_cbranch_scc1 P4
s_mov_b32 s32, 21
s_sub_u32 s33, s41, 12
s_cmp_lt_u32 s41, 20
s_cbranch_scc1 P1
s_sub_u32 s41, s41, 20
s_mul_i32 s32, s41, 86
s_lshr_b32 s32, s32, 8
s_mul_i32 s33, s32, 3
s_sub_u32 s33, s41, s33
s_branch P2
P1:
s_load_dwordx2 s[8:9], s[0:1], 8
s_mov_b32 s10, 1990656
s_mov_b32 s11, 0x20000
s_waitcnt lgkmcnt(0)
s_load_dwordx2 s[12:13], s[0:1], 0
s_mov_b32 s14, 2359296
s_mov_b32 s15, 0x20000
s_waitcnt lgkmcnt(0)
s_mul_i32 s28, s24, 48
s_lshl_b32 s35, s33, 2
s_add_u32 s35, s35, s24
s_mul_i32 s40, s33, 144
s_mul_i32 s42, s24, 27648
s_add_u32 s40, s40, s42
s_mul_i32 s42, s24, 5120
v_lshrrev_b32 v2, 3, v0
s_lshl_b32 s26, s24, 3
v_add_u32 v2, s26, v2
v_and_b32 v3, 3, v0
v_xor_b32 v3, v3, v2
v_and_b32 v3, 15, v3
v_lshlrev_b32 v3, 4, v3
v_mul_u32_u24 v2, 1152, v2
v_and_b32 v4, 7, v0
v_lshl_add_u32 v2, v4, 4, v2
v_lshl_add_u32 v3, v4, 8, v3
s_lshr_b32 s26, s24, 1
s_mul_i32 s26, s26, 18432
v_add_u32 v3, s26, v3
s_mul_i32 s41, s32,36864
buffer_load_dwordx4 v[8:11], v2, s[12:15], s41 offen offset:0
buffer_load_dwordx4 v[12:15], v2, s[12:15], s41 offen offset:128
buffer_load_dwordx4 v[16:19], v2, s[12:15], s41 offen offset:256
buffer_load_dwordx4 v[20:23], v2, s[12:15], s41 offen offset:384
buffer_load_dwordx4 v[24:27], v2, s[12:15], s41 offen offset:512
buffer_load_dwordx4 v[28:31], v2, s[12:15], s41 offen offset:640
buffer_load_dwordx4 v[32:35], v2, s[12:15], s41 offen offset:768
buffer_load_dwordx4 v[36:39], v2, s[12:15], s41 offen offset:896
buffer_load_dwordx4 v[40:43], v2, s[12:15], s41 offen offset:1024
v_add_u32 v50, 0, v0
v_mul_u32_u24 v51, 1639, v50
v_lshrrev_b32 v51, 16, v51
v_mul_u32_u24 v52, 40, v51
v_sub_u32 v52, v50, v52
v_min_u32 v52, 35, v52
v_mul_u32_u24 v53, 5462, v52
v_lshrrev_b32 v53, 16, v53
v_mul_u32_u24 v54, 12, v53
v_sub_u32 v54, v52, v54
v_mul_u32_u24 v55, 21846, v54
v_lshrrev_b32 v55, 16, v55
v_mul_u32_u24 v50, 3, v55
v_sub_u32 v50, v54, v50
v_mul_u32_u24 v51, 3456, v51
v_mul_u32_u24 v53, 1152, v53
v_mul_u32_u24 v55, 36, v55
v_lshl_add_u32 v53, v50, 4, v53
v_add3_u32 v53, v53, v55, s40
v_add_u32 v56, v51, v53
v_add_u32 v50, 64, v0
v_mul_u32_u24 v51, 1639, v50
v_lshrrev_b32 v51, 16, v51
v_mul_u32_u24 v52, 40, v51
v_sub_u32 v52, v50, v52
v_min_u32 v52, 35, v52
v_mul_u32_u24 v53, 5462, v52
v_lshrrev_b32 v53, 16, v53
v_mul_u32_u24 v54, 12, v53
v_sub_u32 v54, v52, v54
v_mul_u32_u24 v55, 21846, v54
v_lshrrev_b32 v55, 16, v55
v_mul_u32_u24 v50, 3, v55
v_sub_u32 v50, v54, v50
v_mul_u32_u24 v51, 3456, v51
v_mul_u32_u24 v53, 1152, v53
v_mul_u32_u24 v55, 36, v55
v_lshl_add_u32 v53, v50, 4, v53
v_add3_u32 v53, v53, v55, s40
v_add_u32 v57, v51, v53
v_add_u32 v50, 128, v0
v_mul_u32_u24 v51, 1639, v50
v_lshrrev_b32 v51, 16, v51
v_mul_u32_u24 v52, 40, v51
v_sub_u32 v52, v50, v52
v_min_u32 v52, 35, v52
v_mul_u32_u24 v53, 5462, v52
v_lshrrev_b32 v53, 16, v53
v_mul_u32_u24 v54, 12, v53
v_sub_u32 v54, v52, v54
v_mul_u32_u24 v55, 21846, v54
v_lshrrev_b32 v55, 16, v55
v_mul_u32_u24 v50, 3, v55
v_sub_u32 v50, v54, v50
v_mul_u32_u24 v51, 3456, v51
v_mul_u32_u24 v53, 1152, v53
v_mul_u32_u24 v55, 36, v55
v_lshl_add_u32 v53, v50, 4, v53
v_add3_u32 v53, v53, v55, s40
v_add_u32 v58, v51, v53
v_add_u32 v50, 192, v0
v_mul_u32_u24 v51, 1639, v50
v_lshrrev_b32 v51, 16, v51
v_mul_u32_u24 v52, 40, v51
v_sub_u32 v52, v50, v52
v_min_u32 v52, 35, v52
v_mul_u32_u24 v53, 5462, v52
v_lshrrev_b32 v53, 16, v53
v_mul_u32_u24 v54, 12, v53
v_sub_u32 v54, v52, v54
v_mul_u32_u24 v55, 21846, v54
v_lshrrev_b32 v55, 16, v55
v_mul_u32_u24 v50, 3, v55
v_sub_u32 v50, v54, v50
v_mul_u32_u24 v51, 3456, v51
v_mul_u32_u24 v53, 1152, v53
v_mul_u32_u24 v55, 36, v55
v_lshl_add_u32 v53, v50, 4, v53
v_add3_u32 v53, v53, v55, s40
v_add_u32 v59, v51, v53
v_add_u32 v50, 256, v0
v_mul_u32_u24 v51, 1639, v50
v_lshrrev_b32 v51, 16, v51
v_mul_u32_u24 v52, 40, v51
v_sub_u32 v52, v50, v52
v_min_u32 v52, 35, v52
v_mul_u32_u24 v53, 5462, v52
v_lshrrev_b32 v53, 16, v53
v_mul_u32_u24 v54, 12, v53
v_sub_u32 v54, v52, v54
v_mul_u32_u24 v55, 21846, v54
v_lshrrev_b32 v55, 16, v55
v_mul_u32_u24 v50, 3, v55
v_sub_u32 v50, v54, v50
v_mul_u32_u24 v51, 3456, v51
v_mul_u32_u24 v53, 1152, v53
v_mul_u32_u24 v55, 36, v55
v_lshl_add_u32 v53, v50, 4, v53
v_add3_u32 v53, v53, v55, s40
v_add_u32 v60, v51, v53
v_lshrrev_b32 v61, 4, v0
v_bfe_u32 v50, v0, 2, 2
v_lshl_add_u32 v61, v61, 3, v50
v_mul_u32_u24 v61, 640, v61
v_and_b32 v50, 3, v0
v_lshl_add_u32 v61, v50, 3, v61
v_add_u32 v61, s28, v61
v_and_b32 v50, 3, v0
v_min_u32 v51, 2, v50
v_mul_u32_u24 v51, 192, v51
v_lshlrev_b32 v50, 3, v50
v_sub_u32 v62, v61, v50
v_add3_u32 v62, v62, v51, 32
v_add_u32 v64, 81920, v61
v_add_u32 v65, 81920, v62
s_add_u32 m0, s42, 0
s_mov_b32 s26, 0
buffer_load_dwordx4 v56, s[8:11], s26 offen lds
s_add_u32 m0, s42, 1024
s_mov_b32 s26, 0
buffer_load_dwordx4 v57, s[8:11], s26 offen lds
s_add_u32 m0, s42, 2048
s_mov_b32 s26, 0
buffer_load_dwordx4 v58, s[8:11], s26 offen lds
s_add_u32 m0, s42, 3072
s_mov_b32 s26, 0
buffer_load_dwordx4 v59, s[8:11], s26 offen lds
s_add_u32 m0, s42, 4096
s_mov_b32 s26, 0
buffer_load_dwordx4 v60, s[8:11], s26 offen lds
s_add_u32 m0, s42, 20480
s_mov_b32 s26, 110592
buffer_load_dwordx4 v56, s[8:11], s26 offen lds
s_add_u32 m0, s42, 21504
s_mov_b32 s26, 110592
buffer_load_dwordx4 v57, s[8:11], s26 offen lds
s_add_u32 m0, s42, 22528
s_mov_b32 s26, 110592
buffer_load_dwordx4 v58, s[8:11], s26 offen lds
s_add_u32 m0, s42, 23552
s_mov_b32 s26, 110592
buffer_load_dwordx4 v59, s[8:11], s26 offen lds
s_add_u32 m0, s42, 24576
s_mov_b32 s26, 110592
buffer_load_dwordx4 v60, s[8:11], s26 offen lds
s_add_u32 m0, s42, 40960
s_mov_b32 s26, 221184
buffer_load_dwordx4 v56, s[8:11], s26 offen lds
s_add_u32 m0, s42, 41984
s_mov_b32 s26, 221184
buffer_load_dwordx4 v57, s[8:11], s26 offen lds
s_add_u32 m0, s42, 43008
s_mov_b32 s26, 221184
buffer_load_dwordx4 v58, s[8:11], s26 offen lds
s_add_u32 m0, s42, 44032
s_mov_b32 s26, 221184
buffer_load_dwordx4 v59, s[8:11], s26 offen lds
s_add_u32 m0, s42, 45056
s_mov_b32 s26, 221184
buffer_load_dwordx4 v60, s[8:11], s26 offen lds
s_add_u32 m0, s42, 61440
s_mov_b32 s26, 331776
buffer_load_dwordx4 v56, s[8:11], s26 offen lds
s_add_u32 m0, s42, 62464
s_mov_b32 s26, 331776
buffer_load_dwordx4 v57, s[8:11], s26 offen lds
s_add_u32 m0, s42, 63488
s_mov_b32 s26, 331776
buffer_load_dwordx4 v58, s[8:11], s26 offen lds
s_add_u32 m0, s42, 64512
s_mov_b32 s26, 331776
buffer_load_dwordx4 v59, s[8:11], s26 offen lds
s_add_u32 m0, s42, 65536
s_mov_b32 s26, 331776
buffer_load_dwordx4 v60, s[8:11], s26 offen lds
s_add_u32 m0, s42, 81920
s_mov_b32 s26, 442368
buffer_load_dwordx4 v56, s[8:11], s26 offen lds
s_add_u32 m0, s42, 82944
s_mov_b32 s26, 442368
buffer_load_dwordx4 v57, s[8:11], s26 offen lds
s_add_u32 m0, s42, 83968
s_mov_b32 s26, 442368
buffer_load_dwordx4 v58, s[8:11], s26 offen lds
s_add_u32 m0, s42, 84992
s_mov_b32 s26, 442368
buffer_load_dwordx4 v59, s[8:11], s26 offen lds
s_add_u32 m0, s42, 86016
s_mov_b32 s26, 442368
buffer_load_dwordx4 v60, s[8:11], s26 offen lds
s_add_u32 m0, s42, 102400
s_mov_b32 s26, 552960
buffer_load_dwordx4 v56, s[8:11], s26 offen lds
s_add_u32 m0, s42, 103424
s_mov_b32 s26, 552960
buffer_load_dwordx4 v57, s[8:11], s26 offen lds
s_add_u32 m0, s42, 104448
s_mov_b32 s26, 552960
buffer_load_dwordx4 v58, s[8:11], s26 offen lds
s_add_u32 m0, s42, 105472
s_mov_b32 s26, 552960
buffer_load_dwordx4 v59, s[8:11], s26 offen lds
s_add_u32 m0, s42, 106496
s_mov_b32 s26, 552960
buffer_load_dwordx4 v60, s[8:11], s26 offen lds
s_add_u32 m0, s42, 122880
s_mov_b32 s26, 663552
buffer_load_dwordx4 v56, s[8:11], s26 offen lds
s_add_u32 m0, s42, 123904
s_mov_b32 s26, 663552
buffer_load_dwordx4 v57, s[8:11], s26 offen lds
s_add_u32 m0, s42, 124928
s_mov_b32 s26, 663552
buffer_load_dwordx4 v58, s[8:11], s26 offen lds
s_add_u32 m0, s42, 125952
s_mov_b32 s26, 663552
buffer_load_dwordx4 v59, s[8:11], s26 offen lds
s_add_u32 m0, s42, 126976
s_mov_b32 s26, 663552
buffer_load_dwordx4 v60, s[8:11], s26 offen lds
s_add_u32 m0, s42, 143360
s_mov_b32 s26, 774144
buffer_load_dwordx4 v56, s[8:11], s26 offen lds
s_add_u32 m0, s42, 144384
s_mov_b32 s26, 774144
buffer_load_dwordx4 v57, s[8:11], s26 offen lds
s_add_u32 m0, s42, 145408
s_mov_b32 s26, 774144
buffer_load_dwordx4 v58, s[8:11], s26 offen lds
s_add_u32 m0, s42, 146432
s_mov_b32 s26, 774144
buffer_load_dwordx4 v59, s[8:11], s26 offen lds
s_add_u32 m0, s42, 147456
s_mov_b32 s26, 774144
buffer_load_dwordx4 v60, s[8:11], s26 offen lds
s_waitcnt vmcnt(20)
s_barrier
ds_read_b64_tr_b16 a[0:1], v61 offset:0
ds_read_b64_tr_b16 a[2:3], v61 offset:2560
ds_read_b64_tr_b16 a[4:5], v61 offset:192
ds_read_b64_tr_b16 a[6:7], v61 offset:2752
ds_read_b64_tr_b16 a[8:9], v61 offset:384
ds_read_b64_tr_b16 a[10:11], v61 offset:2944
ds_read_b64_tr_b16 a[12:13], v62 offset:0
ds_read_b64_tr_b16 a[14:15], v62 offset:2560
ds_read_b64_tr_b16 a[16:17], v61 offset:20480
ds_read_b64_tr_b16 a[18:19], v61 offset:23040
ds_read_b64_tr_b16 a[20:21], v61 offset:20672
ds_read_b64_tr_b16 a[22:23], v61 offset:23232
ds_read_b64_tr_b16 a[24:25], v61 offset:20864
ds_read_b64_tr_b16 a[26:27], v61 offset:23424
ds_read_b64_tr_b16 a[28:29], v62 offset:20480
ds_read_b64_tr_b16 a[30:31], v62 offset:23040
ds_read_b64_tr_b16 a[32:33], v61 offset:40960
ds_read_b64_tr_b16 a[34:35], v61 offset:43520
ds_read_b64_tr_b16 a[36:37], v61 offset:41152
ds_read_b64_tr_b16 a[38:39], v61 offset:43712
ds_read_b64_tr_b16 a[40:41], v61 offset:41344
ds_read_b64_tr_b16 a[42:43], v61 offset:43904
ds_read_b64_tr_b16 a[44:45], v62 offset:40960
ds_read_b64_tr_b16 a[46:47], v62 offset:43520
ds_read_b64_tr_b16 a[48:49], v61 offset:61440
ds_read_b64_tr_b16 a[50:51], v61 offset:64000
ds_read_b64_tr_b16 a[52:53], v61 offset:61632
ds_read_b64_tr_b16 a[54:55], v61 offset:64192
ds_read_b64_tr_b16 a[56:57], v61 offset:61824
ds_read_b64_tr_b16 a[58:59], v61 offset:64384
ds_read_b64_tr_b16 a[60:61], v62 offset:61440
ds_read_b64_tr_b16 a[62:63], v62 offset:64000
s_waitcnt lgkmcnt(0)
s_barrier
s_add_u32 m0, s42, 0
s_mov_b32 s26, 884736
buffer_load_dwordx4 v56, s[8:11], s26 offen lds
s_add_u32 m0, s42, 1024
s_mov_b32 s26, 884736
buffer_load_dwordx4 v57, s[8:11], s26 offen lds
s_add_u32 m0, s42, 2048
s_mov_b32 s26, 884736
buffer_load_dwordx4 v58, s[8:11], s26 offen lds
s_add_u32 m0, s42, 3072
s_mov_b32 s26, 884736
buffer_load_dwordx4 v59, s[8:11], s26 offen lds
s_add_u32 m0, s42, 4096
s_mov_b32 s26, 884736
buffer_load_dwordx4 v60, s[8:11], s26 offen lds
s_add_u32 m0, s42, 20480
s_mov_b32 s26, 995328
buffer_load_dwordx4 v56, s[8:11], s26 offen lds
s_add_u32 m0, s42, 21504
s_mov_b32 s26, 995328
buffer_load_dwordx4 v57, s[8:11], s26 offen lds
s_add_u32 m0, s42, 22528
s_mov_b32 s26, 995328
buffer_load_dwordx4 v58, s[8:11], s26 offen lds
s_add_u32 m0, s42, 23552
s_mov_b32 s26, 995328
buffer_load_dwordx4 v59, s[8:11], s26 offen lds
s_add_u32 m0, s42, 24576
s_mov_b32 s26, 995328
buffer_load_dwordx4 v60, s[8:11], s26 offen lds
s_add_u32 m0, s42, 40960
s_mov_b32 s26, 1105920
buffer_load_dwordx4 v56, s[8:11], s26 offen lds
s_add_u32 m0, s42, 41984
s_mov_b32 s26, 1105920
buffer_load_dwordx4 v57, s[8:11], s26 offen lds
s_add_u32 m0, s42, 43008
s_mov_b32 s26, 1105920
buffer_load_dwordx4 v58, s[8:11], s26 offen lds
s_add_u32 m0, s42, 44032
s_mov_b32 s26, 1105920
buffer_load_dwordx4 v59, s[8:11], s26 offen lds
s_add_u32 m0, s42, 45056
s_mov_b32 s26, 1105920
buffer_load_dwordx4 v60, s[8:11], s26 offen lds
s_add_u32 m0, s42, 61440
s_mov_b32 s26, 1216512
buffer_load_dwordx4 v56, s[8:11], s26 offen lds
s_add_u32 m0, s42, 62464
s_mov_b32 s26, 1216512
buffer_load_dwordx4 v57, s[8:11], s26 offen lds
s_add_u32 m0, s42, 63488
s_mov_b32 s26, 1216512
buffer_load_dwordx4 v58, s[8:11], s26 offen lds
s_add_u32 m0, s42, 64512
s_mov_b32 s26, 1216512
buffer_load_dwordx4 v59, s[8:11], s26 offen lds
s_add_u32 m0, s42, 65536
s_mov_b32 s26, 1216512
buffer_load_dwordx4 v60, s[8:11], s26 offen lds
s_waitcnt vmcnt(20)
s_barrier
ds_read_b64_tr_b16 a[64:65], v64 offset:0
ds_read_b64_tr_b16 a[66:67], v64 offset:2560
ds_read_b64_tr_b16 a[68:69], v64 offset:192
ds_read_b64_tr_b16 a[70:71], v64 offset:2752
ds_read_b64_tr_b16 a[72:73], v64 offset:384
ds_read_b64_tr_b16 a[74:75], v64 offset:2944
ds_read_b64_tr_b16 a[76:77], v65 offset:0
ds_read_b64_tr_b16 a[78:79], v65 offset:2560
ds_read_b64_tr_b16 a[80:81], v64 offset:20480
ds_read_b64_tr_b16 a[82:83], v64 offset:23040
ds_read_b64_tr_b16 a[84:85], v64 offset:20672
ds_read_b64_tr_b16 a[86:87], v64 offset:23232
ds_read_b64_tr_b16 a[88:89], v64 offset:20864
ds_read_b64_tr_b16 a[90:91], v64 offset:23424
ds_read_b64_tr_b16 a[92:93], v65 offset:20480
ds_read_b64_tr_b16 a[94:95], v65 offset:23040
ds_read_b64_tr_b16 a[96:97], v64 offset:40960
ds_read_b64_tr_b16 a[98:99], v64 offset:43520
ds_read_b64_tr_b16 a[100:101], v64 offset:41152
ds_read_b64_tr_b16 a[102:103], v64 offset:43712
ds_read_b64_tr_b16 a[104:105], v64 offset:41344
ds_read_b64_tr_b16 a[106:107], v64 offset:43904
ds_read_b64_tr_b16 a[108:109], v65 offset:40960
ds_read_b64_tr_b16 a[110:111], v65 offset:43520
ds_read_b64_tr_b16 a[112:113], v64 offset:61440
ds_read_b64_tr_b16 a[114:115], v64 offset:64000
ds_read_b64_tr_b16 a[116:117], v64 offset:61632
ds_read_b64_tr_b16 a[118:119], v64 offset:64192
ds_read_b64_tr_b16 a[120:121], v64 offset:61824
ds_read_b64_tr_b16 a[122:123], v64 offset:64384
ds_read_b64_tr_b16 a[124:125], v65 offset:61440
ds_read_b64_tr_b16 a[126:127], v65 offset:64000
s_waitcnt lgkmcnt(0)
s_barrier
s_add_u32 m0, s42, 81920
s_mov_b32 s26, 1327104
buffer_load_dwordx4 v56, s[8:11], s26 offen lds
s_add_u32 m0, s42, 82944
s_mov_b32 s26, 1327104
buffer_load_dwordx4 v57, s[8:11], s26 offen lds
s_add_u32 m0, s42, 83968
s_mov_b32 s26, 1327104
buffer_load_dwordx4 v58, s[8:11], s26 offen lds
s_add_u32 m0, s42, 84992
s_mov_b32 s26, 1327104
buffer_load_dwordx4 v59, s[8:11], s26 offen lds
s_add_u32 m0, s42, 86016
s_mov_b32 s26, 1327104
buffer_load_dwordx4 v60, s[8:11], s26 offen lds
s_add_u32 m0, s42, 102400
s_mov_b32 s26, 1437696
buffer_load_dwordx4 v56, s[8:11], s26 offen lds
s_add_u32 m0, s42, 103424
s_mov_b32 s26, 1437696
buffer_load_dwordx4 v57, s[8:11], s26 offen lds
s_add_u32 m0, s42, 104448
s_mov_b32 s26, 1437696
buffer_load_dwordx4 v58, s[8:11], s26 offen lds
s_add_u32 m0, s42, 105472
s_mov_b32 s26, 1437696
buffer_load_dwordx4 v59, s[8:11], s26 offen lds
s_add_u32 m0, s42, 106496
s_mov_b32 s26, 1437696
buffer_load_dwordx4 v60, s[8:11], s26 offen lds
s_add_u32 m0, s42, 122880
s_mov_b32 s26, 1548288
buffer_load_dwordx4 v56, s[8:11], s26 offen lds
s_add_u32 m0, s42, 123904
s_mov_b32 s26, 1548288
buffer_load_dwordx4 v57, s[8:11], s26 offen lds
s_add_u32 m0, s42, 124928
s_mov_b32 s26, 1548288
buffer_load_dwordx4 v58, s[8:11], s26 offen lds
s_add_u32 m0, s42, 125952
s_mov_b32 s26, 1548288
buffer_load_dwordx4 v59, s[8:11], s26 offen lds
s_add_u32 m0, s42, 126976
s_mov_b32 s26, 1548288
buffer_load_dwordx4 v60, s[8:11], s26 offen lds
s_add_u32 m0, s42, 143360
s_mov_b32 s26, 1658880
buffer_load_dwordx4 v56, s[8:11], s26 offen lds
s_add_u32 m0, s42, 144384
s_mov_b32 s26, 1658880
buffer_load_dwordx4 v57, s[8:11], s26 offen lds
s_add_u32 m0, s42, 145408
s_mov_b32 s26, 1658880
buffer_load_dwordx4 v58, s[8:11], s26 offen lds
s_add_u32 m0, s42, 146432
s_mov_b32 s26, 1658880
buffer_load_dwordx4 v59, s[8:11], s26 offen lds
s_add_u32 m0, s42, 147456
s_mov_b32 s26, 1658880
buffer_load_dwordx4 v60, s[8:11], s26 offen lds
s_waitcnt vmcnt(20)
s_barrier
ds_read_b64_tr_b16 a[128:129], v61 offset:0
ds_read_b64_tr_b16 a[130:131], v61 offset:2560
ds_read_b64_tr_b16 a[132:133], v61 offset:192
ds_read_b64_tr_b16 a[134:135], v61 offset:2752
ds_read_b64_tr_b16 a[136:137], v61 offset:384
ds_read_b64_tr_b16 a[138:139], v61 offset:2944
ds_read_b64_tr_b16 a[140:141], v62 offset:0
ds_read_b64_tr_b16 a[142:143], v62 offset:2560
ds_read_b64_tr_b16 a[144:145], v61 offset:20480
ds_read_b64_tr_b16 a[146:147], v61 offset:23040
ds_read_b64_tr_b16 a[148:149], v61 offset:20672
ds_read_b64_tr_b16 a[150:151], v61 offset:23232
ds_read_b64_tr_b16 a[152:153], v61 offset:20864
ds_read_b64_tr_b16 a[154:155], v61 offset:23424
ds_read_b64_tr_b16 a[156:157], v62 offset:20480
ds_read_b64_tr_b16 a[158:159], v62 offset:23040
ds_read_b64_tr_b16 a[160:161], v61 offset:40960
ds_read_b64_tr_b16 a[162:163], v61 offset:43520
ds_read_b64_tr_b16 a[164:165], v61 offset:41152
ds_read_b64_tr_b16 a[166:167], v61 offset:43712
ds_read_b64_tr_b16 a[168:169], v61 offset:41344
ds_read_b64_tr_b16 a[170:171], v61 offset:43904
ds_read_b64_tr_b16 a[172:173], v62 offset:40960
ds_read_b64_tr_b16 a[174:175], v62 offset:43520
ds_read_b64_tr_b16 a[176:177], v61 offset:61440
ds_read_b64_tr_b16 a[178:179], v61 offset:64000
ds_read_b64_tr_b16 a[180:181], v61 offset:61632
ds_read_b64_tr_b16 a[182:183], v61 offset:64192
ds_read_b64_tr_b16 a[184:185], v61 offset:61824
ds_read_b64_tr_b16 a[186:187], v61 offset:64384
ds_read_b64_tr_b16 a[188:189], v62 offset:61440
ds_read_b64_tr_b16 a[190:191], v62 offset:64000
s_waitcnt lgkmcnt(0)
s_barrier
s_add_u32 m0, s42, 0
s_mov_b32 s26, 1769472
buffer_load_dwordx4 v56, s[8:11], s26 offen lds
s_add_u32 m0, s42, 1024
s_mov_b32 s26, 1769472
buffer_load_dwordx4 v57, s[8:11], s26 offen lds
s_add_u32 m0, s42, 2048
s_mov_b32 s26, 1769472
buffer_load_dwordx4 v58, s[8:11], s26 offen lds
s_add_u32 m0, s42, 3072
s_mov_b32 s26, 1769472
buffer_load_dwordx4 v59, s[8:11], s26 offen lds
s_add_u32 m0, s42, 4096
s_mov_b32 s26, 1769472
buffer_load_dwordx4 v60, s[8:11], s26 offen lds
s_add_u32 m0, s42, 20480
s_mov_b32 s26, 1880064
buffer_load_dwordx4 v56, s[8:11], s26 offen lds
s_add_u32 m0, s42, 21504
s_mov_b32 s26, 1880064
buffer_load_dwordx4 v57, s[8:11], s26 offen lds
s_add_u32 m0, s42, 22528
s_mov_b32 s26, 1880064
buffer_load_dwordx4 v58, s[8:11], s26 offen lds
s_add_u32 m0, s42, 23552
s_mov_b32 s26, 1880064
buffer_load_dwordx4 v59, s[8:11], s26 offen lds
s_add_u32 m0, s42, 24576
s_mov_b32 s26, 1880064
buffer_load_dwordx4 v60, s[8:11], s26 offen lds
s_waitcnt vmcnt(10)
s_barrier
ds_read_b64_tr_b16 a[192:193], v64 offset:0
ds_read_b64_tr_b16 a[194:195], v64 offset:2560
ds_read_b64_tr_b16 a[196:197], v64 offset:192
ds_read_b64_tr_b16 a[198:199], v64 offset:2752
ds_read_b64_tr_b16 a[200:201], v64 offset:384
ds_read_b64_tr_b16 a[202:203], v64 offset:2944
ds_read_b64_tr_b16 a[204:205], v65 offset:0
ds_read_b64_tr_b16 a[206:207], v65 offset:2560
ds_read_b64_tr_b16 a[208:209], v64 offset:20480
ds_read_b64_tr_b16 a[210:211], v64 offset:23040
ds_read_b64_tr_b16 a[212:213], v64 offset:20672
ds_read_b64_tr_b16 a[214:215], v64 offset:23232
ds_read_b64_tr_b16 a[216:217], v64 offset:20864
ds_read_b64_tr_b16 a[218:219], v64 offset:23424
ds_read_b64_tr_b16 a[220:221], v65 offset:20480
ds_read_b64_tr_b16 a[222:223], v65 offset:23040
ds_read_b64_tr_b16 a[224:225], v64 offset:40960
ds_read_b64_tr_b16 a[226:227], v64 offset:43520
ds_read_b64_tr_b16 a[228:229], v64 offset:41152
ds_read_b64_tr_b16 a[230:231], v64 offset:43712
ds_read_b64_tr_b16 a[232:233], v64 offset:41344
ds_read_b64_tr_b16 a[234:235], v64 offset:43904
ds_read_b64_tr_b16 a[236:237], v65 offset:40960
ds_read_b64_tr_b16 a[238:239], v65 offset:43520
ds_read_b64_tr_b16 a[240:241], v64 offset:61440
ds_read_b64_tr_b16 a[242:243], v64 offset:64000
ds_read_b64_tr_b16 a[244:245], v64 offset:61632
ds_read_b64_tr_b16 a[246:247], v64 offset:64192
ds_read_b64_tr_b16 a[248:249], v64 offset:61824
ds_read_b64_tr_b16 a[250:251], v64 offset:64384
ds_read_b64_tr_b16 a[252:253], v65 offset:61440
ds_read_b64_tr_b16 a[254:255], v65 offset:64000
s_waitcnt lgkmcnt(0)
v_mov_b32 v4, 128
s_mov_b32 s29, 0
Lwf1:
buffer_load_dword v5, v4, s[16:19], 0 offen sc1
s_add_u32 s29, s29, 1
s_waitcnt vmcnt(0)
v_cmp_eq_u32 vcc, 0, v5
s_cbranch_vccz Lwd2
s_sleep 2
s_cmp_lt_u32 s29, s25
s_cbranch_scc1 Lwf1
s_mov_b32 s25, 0
Lwd2:
v_lshrrev_b32 v5, 4, v0
v_xor_b32 v7, v5, v0
v_lshlrev_b32 v7, 4, v7
s_waitcnt vmcnt(0)
s_barrier
ds_read_b64_tr_b16 v[224:225], v61 offset:0
ds_read_b64_tr_b16 v[226:227], v61 offset:2560
ds_read_b64_tr_b16 v[228:229], v61 offset:192
ds_read_b64_tr_b16 v[230:231], v61 offset:2752
ds_read_b64_tr_b16 v[232:233], v61 offset:384
ds_read_b64_tr_b16 v[234:235], v61 offset:2944
ds_read_b64_tr_b16 v[236:237], v62 offset:0
ds_read_b64_tr_b16 v[238:239], v62 offset:2560
ds_read_b64_tr_b16 v[240:241], v61 offset:20480
ds_read_b64_tr_b16 v[242:243], v61 offset:23040
ds_read_b64_tr_b16 v[244:245], v61 offset:20672
ds_read_b64_tr_b16 v[246:247], v61 offset:23232
ds_read_b64_tr_b16 v[248:249], v61 offset:20864
ds_read_b64_tr_b16 v[250:251], v61 offset:23424
ds_read_b64_tr_b16 v[252:253], v62 offset:20480
ds_read_b64_tr_b16 v[254:255], v62 offset:23040
s_waitcnt lgkmcnt(0)
v_and_b32 v50, 15, v0
v_lshrrev_b32 v51, 4, v0
v_cmp_gt_u32 s[44:45], 8, v50
v_cmp_eq_u32 s[46:47], 10, v50
v_cmp_gt_u32 s[48:49], 2, v50
v_cmp_eq_u32 s[50:51], 1, v51
s_lshl_b32 s26, s24, 7
s_add_u32 s26, s26, 40960
v_lshlrev_b32 v5, 4, v51
v_lshl_add_u32 v5, v50, 1, v5
v_add_u32 v5, s26, v5
v_lshl_add_u32 v6, v50, 2, s26
v_mul_u32_u24 v63, 12, v0
v_min_u32 v4, 23, v0
v_lshlrev_b32 v4, 8, v4
s_mov_b32 s36, 0
s_mov_b32 s37, s32
s_mov_b32 s38, 22
s_barrier
P1_layer:
v_mov_b32 v112, 0
v_mov_b32 v113, 0
v_mov_b32 v114, 0
v_mov_b32 v115, 0
v_mov_b32 v116, 0
v_mov_b32 v117, 0
v_mov_b32 v118, 0
v_mov_b32 v119, 0
v_mov_b32 v120, 0
v_mov_b32 v121, 0
v_mov_b32 v122, 0
v_mov_b32 v123, 0
v_mov_b32 v124, 0
v_mov_b32 v125, 0
v_mov_b32 v126, 0
v_mov_b32 v127, 0
P1_seg:
s_cmp_eq_u32 s36, 0
s_cbranch_scc1 P1_have
s_lshl_b32 s41, s37, 2
s_add_u32 s41, s41, 55296
s_mov_b32 s29, 0
Lwf3:
buffer_load_dword v50, v4, s[4:7], s41 offen sc1
s_add_u32 s29, s29, 1
s_waitcnt vmcnt(0)
v_cmp_eq_u32 vcc, 0, v50
s_cbranch_vccz Lwd4
s_sleep 2
s_cmp_lt_u32 s29, s25
s_cbranch_scc1 Lwf3
s_mov_b32 s25, 0
Lwd4:
s_mul_i32 s41, s37, 36864
s_add_u32 s41, s41, 21495808
buffer_load_dwordx4 v[8:11], v2, s[4:7], s41 offen offset:0 sc1
buffer_load_dwordx4 v[12:15], v2, s[4:7], s41 offen offset:128 sc1
buffer_load_dwordx4 v[16:19], v2, s[4:7], s41 offen offset:256 sc1
buffer_load_dwordx4 v[20:23], v2, s[4:7], s41 offen offset:384 sc1
buffer_load_dwordx4 v[24:27], v2, s[4:7], s41 offen offset:512 sc1
buffer_load_dwordx4 v[28:31], v2, s[4:7], s41 offen offset:640 sc1
buffer_load_dwordx4 v[32:35], v2, s[4:7], s41 offen offset:768 sc1
buffer_load_dwordx4 v[36:39], v2, s[4:7], s41 offen offset:896 sc1
buffer_load_dwordx4 v[40:43], v2, s[4:7], s41 offen offset:1024 sc1
s_waitcnt vmcnt(0)
P1_have:
s_mov_b32 s26, 0x3f803f80
v_mov_b32 v44, 0
v_mov_b32 v45, 0
v_dot2_f32_bf16 v44, v8, s26, v44
v_dot2_f32_bf16 v45, v8, v8, v45
v_dot2_f32_bf16 v44, v9, s26, v44
v_dot2_f32_bf16 v45, v9, v9, v45
v_dot2_f32_bf16 v44, v10, s26, v44
v_dot2_f32_bf16 v45, v10, v10, v45
v_dot2_f32_bf16 v44, v11, s26, v44
v_dot2_f32_bf16 v45, v11, v11, v45
v_dot2_f32_bf16 v44, v12, s26, v44
v_dot2_f32_bf16 v45, v12, v12, v45
v_dot2_f32_bf16 v44, v13, s26, v44
v_dot2_f32_bf16 v45, v13, v13, v45
v_dot2_f32_bf16 v44, v14, s26, v44
v_dot2_f32_bf16 v45, v14, v14, v45
v_dot2_f32_bf16 v44, v15, s26, v44
v_dot2_f32_bf16 v45, v15, v15, v45
v_dot2_f32_bf16 v44, v16, s26, v44
v_dot2_f32_bf16 v45, v16, v16, v45
v_dot2_f32_bf16 v44, v17, s26, v44
v_dot2_f32_bf16 v45, v17, v17, v45
v_dot2_f32_bf16 v44, v18, s26, v44
v_dot2_f32_bf16 v45, v18, v18, v45
v_dot2_f32_bf16 v44, v19, s26, v44
v_dot2_f32_bf16 v45, v19, v19, v45
v_dot2_f32_bf16 v44, v20, s26, v44
v_dot2_f32_bf16 v45, v20, v20, v45
v_dot2_f32_bf16 v44, v21, s26, v44
v_dot2_f32_bf16 v45, v21, v21, v45
v_dot2_f32_bf16 v44, v22, s26, v44
v_dot2_f32_bf16 v45, v22, v22, v45
v_dot2_f32_bf16 v44, v23, s26, v44
v_dot2_f32_bf16 v45, v23, v23, v45
v_dot2_f32_bf16 v44, v24, s26, v44
v_dot2_f32_bf16 v45, v24, v24, v45
v_dot2_f32_bf16 v44, v25, s26, v44
v_dot2_f32_bf16 v45, v25, v25, v45
v_dot2_f32_bf16 v44, v26, s26, v44
v_dot2_f32_bf16 v45, v26, v26, v45
v_dot2_f32_bf16 v44, v27, s26, v44
v_dot2_f32_bf16 v45, v27, v27, v45
v_dot2_f32_bf16 v44, v28, s26, v44
v_dot2_f32_bf16 v45, v28, v28, v45
v_dot2_f32_bf16 v44, v29, s26, v44
v_dot2_f32_bf16 v45, v29, v29, v45
v_dot2_f32_bf16 v44, v30, s26, v44
v_dot2_f32_bf16 v45, v30, v30, v45
v_dot2_f32_bf16 v44, v31, s26, v44
v_dot2_f32_bf16 v45, v31, v31, v45
v_dot2_f32_bf16 v44, v32, s26, v44
v_dot2_f32_bf16 v45, v32, v32, v45
v_dot2_f32_bf16 v44, v33, s26, v44
v_dot2_f32_bf16 v45, v33, v33, v45
v_dot2_f32_bf16 v44, v34, s26, v44
v_dot2_f32_bf16 v45, v34, v34, v45
v_dot2_f32_bf16 v44, v35, s26, v44
v_dot2_f32_bf16 v45, v35, v35, v45
v_dot2_f32_bf16 v44, v36, s26, v44
v_dot2_f32_bf16 v45, v36, v36, v45
v_dot2_f32_bf16 v44, v37, s26, v44
v_dot2_f32_bf16 v45, v37, v37, v45
v_dot2_f32_bf16 v44, v38, s26, v44
v_dot2_f32_bf16 v45, v38, v38, v45
v_dot2_f32_bf16 v44, v39, s26, v44
v_dot2_f32_bf16 v45, v39, v39, v45
v_dot2_f32_bf16 v44, v40, s26, v44
v_dot2_f32_bf16 v45, v40, v40, v45
v_dot2_f32_bf16 v44, v41, s26, v44
v_dot2_f32_bf16 v45, v41, v41, v45
v_dot2_f32_bf16 v44, v42, s26, v44
v_dot2_f32_bf16 v45, v42, v42, v45
v_dot2_f32_bf16 v44, v43, s26, v44
v_dot2_f32_bf16 v45, v43, v43, v45
s_nop 1
v_add_f32_dpp v44, v44, v44 quad_perm:[1,0,3,2] row_mask:0xf bank_mask:0xf
v_add_f32_dpp v45, v45, v45 quad_perm:[1,0,3,2] row_mask:0xf bank_mask:0xf
s_nop 0
v_add_f32_dpp v44, v44, v44 quad_perm:[2,3,0,1] row_mask:0xf bank_mask:0xf
v_add_f32_dpp v45, v45, v45 quad_perm:[2,3,0,1] row_mask:0xf bank_mask:0xf
s_nop 0
v_add_f32_dpp v44, v44, v44 row_half_mirror row_mask:0xf bank_mask:0xf
v_add_f32_dpp v45, v45, v45 row_half_mirror row_mask:0xf bank_mask:0xf
v_mul_f32 v44, 0x3ae38e39, v44
v_mul_f32 v45, 0x3ae38e39, v45
v_fma_f32 v45, -v44, v44, v45
v_max_f32 v45, 0, v45
v_cvt_pk_bf16_f32 v46, v44, v45
v_lshlrev_b32 v44, 16, v46
v_and_b32 v45, 0xffff0000, v46
v_add_f32 v45, 0x3727c5ac, v45
v_cvt_pk_bf16_f32 v45, v45, v45
v_lshlrev_b32 v45, 16, v45
v_sqrt_f32 v45, v45
s_nop 0
v_cvt_pk_bf16_f32 v45, v45, v45
v_lshlrev_b32 v45, 16, v45
v_rcp_f32 v46, v45
s_nop 0
v_mul_f32 v44, v44, v46
v_sub_f32 v44, 0, v44
v_lshlrev_b32 v48, 16, v8
v_and_b32 v49, 0xffff0000, v8
v_pk_fma_f32 v[48:49], v[48:49], v[46:47], v[44:45] op_sel_hi:[1,0,0]
v_cvt_pk_bf16_f32 v8, v48, v49
v_lshlrev_b32 v50, 16, v9
v_and_b32 v51, 0xffff0000, v9
v_pk_fma_f32 v[50:51], v[50:51], v[46:47], v[44:45] op_sel_hi:[1,0,0]
v_cvt_pk_bf16_f32 v9, v50, v51
v_lshlrev_b32 v48, 16, v10
v_and_b32 v49, 0xffff0000, v10
v_pk_fma_f32 v[48:49], v[48:49], v[46:47], v[44:45] op_sel_hi:[1,0,0]
v_cvt_pk_bf16_f32 v10, v48, v49
v_lshlrev_b32 v50, 16, v11
v_and_b32 v51, 0xffff0000, v11
v_pk_fma_f32 v[50:51], v[50:51], v[46:47], v[44:45] op_sel_hi:[1,0,0]
v_cvt_pk_bf16_f32 v11, v50, v51
v_lshlrev_b32 v48, 16, v12
v_and_b32 v49, 0xffff0000, v12
v_pk_fma_f32 v[48:49], v[48:49], v[46:47], v[44:45] op_sel_hi:[1,0,0]
v_cvt_pk_bf16_f32 v12, v48, v49
v_lshlrev_b32 v50, 16, v13
v_and_b32 v51, 0xffff0000, v13
v_pk_fma_f32 v[50:51], v[50:51], v[46:47], v[44:45] op_sel_hi:[1,0,0]
v_cvt_pk_bf16_f32 v13, v50, v51
v_lshlrev_b32 v48, 16, v14
v_and_b32 v49, 0xffff0000, v14
v_pk_fma_f32 v[48:49], v[48:49], v[46:47], v[44:45] op_sel_hi:[1,0,0]
v_cvt_pk_bf16_f32 v14, v48, v49
v_lshlrev_b32 v50, 16, v15
v_and_b32 v51, 0xffff0000, v15
v_pk_fma_f32 v[50:51], v[50:51], v[46:47], v[44:45] op_sel_hi:[1,0,0]
v_cvt_pk_bf16_f32 v15, v50, v51
v_lshlrev_b32 v48, 16, v16
v_and_b32 v49, 0xffff0000, v16
v_pk_fma_f32 v[48:49], v[48:49], v[46:47], v[44:45] op_sel_hi:[1,0,0]
v_cvt_pk_bf16_f32 v16, v48, v49
v_lshlrev_b32 v50, 16, v17
v_and_b32 v51, 0xffff0000, v17
v_pk_fma_f32 v[50:51], v[50:51], v[46:47], v[44:45] op_sel_hi:[1,0,0]
v_cvt_pk_bf16_f32 v17, v50, v51
v_lshlrev_b32 v48, 16, v18
v_and_b32 v49, 0xffff0000, v18
v_pk_fma_f32 v[48:49], v[48:49], v[46:47], v[44:45] op_sel_hi:[1,0,0]
v_cvt_pk_bf16_f32 v18, v48, v49
v_lshlrev_b32 v50, 16, v19
v_and_b32 v51, 0xffff0000, v19
v_pk_fma_f32 v[50:51], v[50:51], v[46:47], v[44:45] op_sel_hi:[1,0,0]
v_cvt_pk_bf16_f32 v19, v50, v51
v_lshlrev_b32 v48, 16, v20
v_and_b32 v49, 0xffff0000, v20
v_pk_fma_f32 v[48:49], v[48:49], v[46:47], v[44:45] op_sel_hi:[1,0,0]
v_cvt_pk_bf16_f32 v20, v48, v49
v_lshlrev_b32 v50, 16, v21
v_and_b32 v51, 0xffff0000, v21
v_pk_fma_f32 v[50:51], v[50:51], v[46:47], v[44:45] op_sel_hi:[1,0,0]
v_cvt_pk_bf16_f32 v21, v50, v51
v_lshlrev_b32 v48, 16, v22
v_and_b32 v49, 0xffff0000, v22
v_pk_fma_f32 v[48:49], v[48:49], v[46:47], v[44:45] op_sel_hi:[1,0,0]
v_cvt_pk_bf16_f32 v22, v48, v49
v_lshlrev_b32 v50, 16, v23
v_and_b32 v51, 0xffff0000, v23
v_pk_fma_f32 v[50:51], v[50:51], v[46:47], v[44:45] op_sel_hi:[1,0,0]
v_cvt_pk_bf16_f32 v23, v50, v51
v_lshlrev_b32 v48, 16, v24
v_and_b32 v49, 0xffff0000, v24
v_pk_fma_f32 v[48:49], v[48:49], v[46:47], v[44:45] op_sel_hi:[1,0,0]
v_cvt_pk_bf16_f32 v24, v48, v49
v_lshlrev_b32 v50, 16, v25
v_and_b32 v51, 0xffff0000, v25
v_pk_fma_f32 v[50:51], v[50:51], v[46:47], v[44:45] op_sel_hi:[1,0,0]
v_cvt_pk_bf16_f32 v25, v50, v51
v_lshlrev_b32 v48, 16, v26
v_and_b32 v49, 0xffff0000, v26
v_pk_fma_f32 v[48:49], v[48:49], v[46:47], v[44:45] op_sel_hi:[1,0,0]
v_cvt_pk_bf16_f32 v26, v48, v49
v_lshlrev_b32 v50, 16, v27
v_and_b32 v51, 0xffff0000, v27
v_pk_fma_f32 v[50:51], v[50:51], v[46:47], v[44:45] op_sel_hi:[1,0,0]
v_cvt_pk_bf16_f32 v27, v50, v51
v_lshlrev_b32 v48, 16, v28
v_and_b32 v49, 0xffff0000, v28
v_pk_fma_f32 v[48:49], v[48:49], v[46:47], v[44:45] op_sel_hi:[1,0,0]
v_cvt_pk_bf16_f32 v28, v48, v49
v_lshlrev_b32 v50, 16, v29
v_and_b32 v51, 0xffff0000, v29
v_pk_fma_f32 v[50:51], v[50:51], v[46:47], v[44:45] op_sel_hi:[1,0,0]
v_cvt_pk_bf16_f32 v29, v50, v51
v_lshlrev_b32 v48, 16, v30
v_and_b32 v49, 0xffff0000, v30
v_pk_fma_f32 v[48:49], v[48:49], v[46:47], v[44:45] op_sel_hi:[1,0,0]
v_cvt_pk_bf16_f32 v30, v48, v49
v_lshlrev_b32 v50, 16, v31
v_and_b32 v51, 0xffff0000, v31
v_pk_fma_f32 v[50:51], v[50:51], v[46:47], v[44:45] op_sel_hi:[1,0,0]
v_cvt_pk_bf16_f32 v31, v50, v51
v_lshlrev_b32 v48, 16, v32
v_and_b32 v49, 0xffff0000, v32
v_pk_fma_f32 v[48:49], v[48:49], v[46:47], v[44:45] op_sel_hi:[1,0,0]
v_cvt_pk_bf16_f32 v32, v48, v49
v_lshlrev_b32 v50, 16, v33
v_and_b32 v51, 0xffff0000, v33
v_pk_fma_f32 v[50:51], v[50:51], v[46:47], v[44:45] op_sel_hi:[1,0,0]
v_cvt_pk_bf16_f32 v33, v50, v51
v_lshlrev_b32 v48, 16, v34
v_and_b32 v49, 0xffff0000, v34
v_pk_fma_f32 v[48:49], v[48:49], v[46:47], v[44:45] op_sel_hi:[1,0,0]
v_cvt_pk_bf16_f32 v34, v48, v49
v_lshlrev_b32 v50, 16, v35
v_and_b32 v51, 0xffff0000, v35
v_pk_fma_f32 v[50:51], v[50:51], v[46:47], v[44:45] op_sel_hi:[1,0,0]
v_cvt_pk_bf16_f32 v35, v50, v51
v_lshlrev_b32 v48, 16, v36
v_and_b32 v49, 0xffff0000, v36
v_pk_fma_f32 v[48:49], v[48:49], v[46:47], v[44:45] op_sel_hi:[1,0,0]
v_cvt_pk_bf16_f32 v36, v48, v49
v_lshlrev_b32 v50, 16, v37
v_and_b32 v51, 0xffff0000, v37
v_pk_fma_f32 v[50:51], v[50:51], v[46:47], v[44:45] op_sel_hi:[1,0,0]
v_cvt_pk_bf16_f32 v37, v50, v51
v_lshlrev_b32 v48, 16, v38
v_and_b32 v49, 0xffff0000, v38
v_pk_fma_f32 v[48:49], v[48:49], v[46:47], v[44:45] op_sel_hi:[1,0,0]
v_cvt_pk_bf16_f32 v38, v48, v49
v_lshlrev_b32 v50, 16, v39
v_and_b32 v51, 0xffff0000, v39
v_pk_fma_f32 v[50:51], v[50:51], v[46:47], v[44:45] op_sel_hi:[1,0,0]
v_cvt_pk_bf16_f32 v39, v50, v51
v_lshlrev_b32 v48, 16, v40
v_and_b32 v49, 0xffff0000, v40
v_pk_fma_f32 v[48:49], v[48:49], v[46:47], v[44:45] op_sel_hi:[1,0,0]
v_cvt_pk_bf16_f32 v40, v48, v49
v_lshlrev_b32 v50, 16, v41
v_and_b32 v51, 0xffff0000, v41
v_pk_fma_f32 v[50:51], v[50:51], v[46:47], v[44:45] op_sel_hi:[1,0,0]
v_cvt_pk_bf16_f32 v41, v50, v51
v_lshlrev_b32 v48, 16, v42
v_and_b32 v49, 0xffff0000, v42
v_pk_fma_f32 v[48:49], v[48:49], v[46:47], v[44:45] op_sel_hi:[1,0,0]
v_cvt_pk_bf16_f32 v42, v48, v49
v_lshlrev_b32 v50, 16, v43
v_and_b32 v51, 0xffff0000, v43
v_pk_fma_f32 v[50:51], v[50:51], v[46:47], v[44:45] op_sel_hi:[1,0,0]
v_cvt_pk_bf16_f32 v43, v50, v51
ds_write_b128 v3, v[8:11] offset:0
ds_write_b128 v3, v[12:15] offset:2048
ds_write_b128 v3, v[16:19] offset:4096
ds_write_b128 v3, v[20:23] offset:6144
ds_write_b128 v3, v[24:27] offset:8192
ds_write_b128 v3, v[28:31] offset:10240
ds_write_b128 v3, v[32:35] offset:12288
ds_write_b128 v3, v[36:39] offset:14336
ds_write_b128 v3, v[40:43] offset:16384
s_waitcnt lgkmcnt(0)
s_barrier
s_add_u32 s39, s37, s38
s_cmp_lg_u32 s36, 0
s_cbranch_scc1 P1_nopf
s_cmp_ge_u32 s39, 64
s_cbranch_scc1 P1_nopf
s_mul_i32 s41, s39, 36864
buffer_load_dwordx4 v[8:11], v2, s[12:15], s41 offen offset:0
buffer_load_dwordx4 v[12:15], v2, s[12:15], s41 offen offset:128
buffer_load_dwordx4 v[16:19], v2, s[12:15], s41 offen offset:256
buffer_load_dwordx4 v[20:23], v2, s[12:15], s41 offen offset:384
buffer_load_dwordx4 v[24:27], v2, s[12:15], s41 offen offset:512
buffer_load_dwordx4 v[28:31], v2, s[12:15], s41 offen offset:640
buffer_load_dwordx4 v[32:35], v2, s[12:15], s41 offen offset:768
buffer_load_dwordx4 v[36:39], v2, s[12:15], s41 offen offset:896
buffer_load_dwordx4 v[40:43], v2, s[12:15], s41 offen offset:1024
P1_nopf:
ds_read_b128 v[96:99], v7 offset:0
ds_read_b128 v[100:103], v7 offset:18432
ds_read_b128 v[104:107], v7 offset:1024
ds_read_b128 v[108:111], v7 offset:19456
s_waitcnt lgkmcnt(2)
v_mfma_f32_16x16x32_bf16 v[64:67], a[0:3], v[96:99], 0
v_mfma_f32_16x16x32_bf16 v[72:75], v[96:99], a[4:7], 0
v_mfma_f32_16x16x32_bf16 v[80:83], v[96:99], a[8:11], 0
v_mfma_f32_16x16x32_bf16 v[88:91], v[96:99], a[12:15], 0
v_mfma_f32_16x16x32_bf16 v[68:71], a[0:3], v[100:103], 0
v_mfma_f32_16x16x32_bf16 v[76:79], v[100:103], a[4:7], 0
v_mfma_f32_16x16x32_bf16 v[84:87], v[100:103], a[8:11], 0
v_mfma_f32_16x16x32_bf16 v[92:95], v[100:103], a[12:15], 0
ds_read_b128 v[96:99], v7 offset:2048
ds_read_b128 v[100:103], v7 offset:20480
s_waitcnt lgkmcnt(2)
v_mfma_f32_16x16x32_bf16 v[64:67], a[16:19], v[104:107], v[64:67]
v_mfma_f32_16x16x32_bf16 v[72:75], v[104:107], a[20:23], v[72:75]
v_mfma_f32_16x16x32_bf16 v[80:83], v[104:107], a[24:27], v[80:83]
v_mfma_f32_16x16x32_bf16 v[88:91], v[104:107], a[28:31], v[88:91]
v_mfma_f32_16x16x32_bf16 v[68:71], a[16:19], v[108:111], v[68:71]
v_mfma_f32_16x16x32_bf16 v[76:79], v[108:111], a[20:23], v[76:79]
v_mfma_f32_16x16x32_bf16 v[84:87], v[108:111], a[24:27], v[84:87]
v_mfma_f32_16x16x32_bf16 v[92:95], v[108:111], a[28:31], v[92:95]
ds_read_b128 v[104:107], v7 offset:3072
ds_read_b128 v[108:111], v7 offset:21504
s_waitcnt lgkmcnt(2)
v_mfma_f32_16x16x32_bf16 v[64:67], a[32:35], v[96:99], v[64:67]
v_mfma_f32_16x16x32_bf16 v[72:75], v[96:99], a[36:39], v[72:75]
v_mfma_f32_16x16x32_bf16 v[80:83], v[96:99], a[40:43], v[80:83]
v_mfma_f32_16x16x32_bf16 v[88:91], v[96:99], a[44:47], v[88:91]
v_mfma_f32_16x16x32_bf16 v[68:71], a[32:35], v[100:103], v[68:71]
v_mfma_f32_16x16x32_bf16 v[76:79], v[100:103], a[36:39], v[76:79]
v_mfma_f32_16x16x32_bf16 v[84:87], v[100:103], a[40:43], v[84:87]
v_mfma_f32_16x16x32_bf16 v[92:95], v[100:103], a[44:47], v[92:95]
ds_read_b128 v[96:99], v7 offset:4096
ds_read_b128 v[100:103], v7 offset:22528
s_waitcnt lgkmcnt(2)
v_mfma_f32_16x16x32_bf16 v[64:67], a[48:51], v[104:107], v[64:67]
v_mfma_f32_16x16x32_bf16 v[72:75], v[104:107], a[52:55], v[72:75]
v_mfma_f32_16x16x32_bf16 v[80:83], v[104:107], a[56:59], v[80:83]
v_mfma_f32_16x16x32_bf16 v[88:91], v[104:107], a[60:63], v[88:91]
v_mfma_f32_16x16x32_bf16 v[68:71], a[48:51], v[108:111], v[68:71]
v_mfma_f32_16x16x32_bf16 v[76:79], v[108:111], a[52:55], v[76:79]
v_mfma_f32_16x16x32_bf16 v[84:87], v[108:111], a[56:59], v[84:87]
v_mfma_f32_16x16x32_bf16 v[92:95], v[108:111], a[60:63], v[92:95]
ds_read_b128 v[104:107], v7 offset:5120
ds_read_b128 v[108:111], v7 offset:23552
s_waitcnt lgkmcnt(2)
v_mfma_f32_16x16x32_bf16 v[64:67], a[64:67], v[96:99], v[64:67]
v_mfma_f32_16x16x32_bf16 v[72:75], v[96:99], a[68:71], v[72:75]
v_mfma_f32_16x16x32_bf16 v[80:83], v[96:99], a[72:75], v[80:83]
v_mfma_f32_16x16x32_bf16 v[88:91], v[96:99], a[76:79], v[88:91]
v_mfma_f32_16x16x32_bf16 v[68:71], a[64:67], v[100:103], v[68:71]
v_mfma_f32_16x16x32_bf16 v[76:79], v[100:103], a[68:71], v[76:79]
v_mfma_f32_16x16x32_bf16 v[84:87], v[100:103], a[72:75], v[84:87]
v_mfma_f32_16x16x32_bf16 v[92:95], v[100:103], a[76:79], v[92:95]
ds_read_b128 v[96:99], v7 offset:6144
ds_read_b128 v[100:103], v7 offset:24576
s_waitcnt lgkmcnt(2)
v_mfma_f32_16x16x32_bf16 v[64:67], a[80:83], v[104:107], v[64:67]
v_mfma_f32_16x16x32_bf16 v[72:75], v[104:107], a[84:87], v[72:75]
v_mfma_f32_16x16x32_bf16 v[80:83], v[104:107], a[88:91], v[80:83]
v_mfma_f32_16x16x32_bf16 v[88:91], v[104:107], a[92:95], v[88:91]
v_mfma_f32_16x16x32_bf16 v[68:71], a[80:83], v[108:111], v[68:71]
v_mfma_f32_16x16x32_bf16 v[76:79], v[108:111], a[84:87], v[76:79]
v_mfma_f32_16x16x32_bf16 v[84:87], v[108:111], a[88:91], v[84:87]
v_mfma_f32_16x16x32_bf16 v[92:95], v[108:111], a[92:95], v[92:95]
ds_read_b128 v[104:107], v7 offset:7168
ds_read_b128 v[108:111], v7 offset:25600
s_waitcnt lgkmcnt(2)
v_mfma_f32_16x16x32_bf16 v[64:67], a[96:99], v[96:99], v[64:67]
v_mfma_f32_16x16x32_bf16 v[72:75], v[96:99], a[100:103], v[72:75]
v_mfma_f32_16x16x32_bf16 v[80:83], v[96:99], a[104:107], v[80:83]
v_mfma_f32_16x16x32_bf16 v[88:91], v[96:99], a[108:111], v[88:91]
v_mfma_f32_16x16x32_bf16 v[68:71], a[96:99], v[100:103], v[68:71]
v_mfma_f32_16x16x32_bf16 v[76:79], v[100:103], a[100:103], v[76:79]
v_mfma_f32_16x16x32_bf16 v[84:87], v[100:103], a[104:107], v[84:87]
v_mfma_f32_16x16x32_bf16 v[92:95], v[100:103], a[108:111], v[92:95]
ds_read_b128 v[96:99], v7 offset:8192
ds_read_b128 v[100:103], v7 offset:26624
s_waitcnt lgkmcnt(2)
v_mfma_f32_16x16x32_bf16 v[64:67], a[112:115], v[104:107], v[64:67]
v_mfma_f32_16x16x32_bf16 v[72:75], v[104:107], a[116:119], v[72:75]
v_mfma_f32_16x16x32_bf16 v[80:83], v[104:107], a[120:123], v[80:83]
v_mfma_f32_16x16x32_bf16 v[88:91], v[104:107], a[124:127], v[88:91]
v_mfma_f32_16x16x32_bf16 v[68:71], a[112:115], v[108:111], v[68:71]
v_mfma_f32_16x16x32_bf16 v[76:79], v[108:111], a[116:119], v[76:79]
v_mfma_f32_16x16x32_bf16 v[84:87], v[108:111], a[120:123], v[84:87]
v_mfma_f32_16x16x32_bf16 v[92:95], v[108:111], a[124:127], v[92:95]
ds_read_b128 v[104:107], v7 offset:9216
ds_read_b128 v[108:111], v7 offset:27648
s_waitcnt lgkmcnt(2)
v_mfma_f32_16x16x32_bf16 v[64:67], a[128:131], v[96:99], v[64:67]
v_mfma_f32_16x16x32_bf16 v[72:75], v[96:99], a[132:135], v[72:75]
v_mfma_f32_16x16x32_bf16 v[80:83], v[96:99], a[136:139], v[80:83]
v_mfma_f32_16x16x32_bf16 v[88:91], v[96:99], a[140:143], v[88:91]
v_mfma_f32_16x16x32_bf16 v[68:71], a[128:131], v[100:103], v[68:71]
v_mfma_f32_16x16x32_bf16 v[76:79], v[100:103], a[132:135], v[76:79]
v_mfma_f32_16x16x32_bf16 v[84:87], v[100:103], a[136:139], v[84:87]
v_mfma_f32_16x16x32_bf16 v[92:95], v[100:103], a[140:143], v[92:95]
ds_read_b128 v[96:99], v7 offset:10240
ds_read_b128 v[100:103], v7 offset:28672
s_waitcnt lgkmcnt(2)
v_mfma_f32_16x16x32_bf16 v[64:67], a[144:147], v[104:107], v[64:67]
v_mfma_f32_16x16x32_bf16 v[72:75], v[104:107], a[148:151], v[72:75]
v_mfma_f32_16x16x32_bf16 v[80:83], v[104:107], a[152:155], v[80:83]
v_mfma_f32_16x16x32_bf16 v[88:91], v[104:107], a[156:159], v[88:91]
v_mfma_f32_16x16x32_bf16 v[68:71], a[144:147], v[108:111], v[68:71]
v_mfma_f32_16x16x32_bf16 v[76:79], v[108:111], a[148:151], v[76:79]
v_mfma_f32_16x16x32_bf16 v[84:87], v[108:111], a[152:155], v[84:87]
v_mfma_f32_16x16x32_bf16 v[92:95], v[108:111], a[156:159], v[92:95]
ds_read_b128 v[104:107], v7 offset:11264
ds_read_b128 v[108:111], v7 offset:29696
s_waitcnt lgkmcnt(2)
v_mfma_f32_16x16x32_bf16 v[64:67], a[160:163], v[96:99], v[64:67]
v_mfma_f32_16x16x32_bf16 v[72:75], v[96:99], a[164:167], v[72:75]
v_mfma_f32_16x16x32_bf16 v[80:83], v[96:99], a[168:171], v[80:83]
v_mfma_f32_16x16x32_bf16 v[88:91], v[96:99], a[172:175], v[88:91]
v_mfma_f32_16x16x32_bf16 v[68:71], a[160:163], v[100:103], v[68:71]
v_mfma_f32_16x16x32_bf16 v[76:79], v[100:103], a[164:167], v[76:79]
v_mfma_f32_16x16x32_bf16 v[84:87], v[100:103], a[168:171], v[84:87]
v_mfma_f32_16x16x32_bf16 v[92:95], v[100:103], a[172:175], v[92:95]
ds_read_b128 v[96:99], v7 offset:12288
ds_read_b128 v[100:103], v7 offset:30720
s_waitcnt lgkmcnt(2)
v_mfma_f32_16x16x32_bf16 v[64:67], a[176:179], v[104:107], v[64:67]
v_mfma_f32_16x16x32_bf16 v[72:75], v[104:107], a[180:183], v[72:75]
v_mfma_f32_16x16x32_bf16 v[80:83], v[104:107], a[184:187], v[80:83]
v_mfma_f32_16x16x32_bf16 v[88:91], v[104:107], a[188:191], v[88:91]
v_mfma_f32_16x16x32_bf16 v[68:71], a[176:179], v[108:111], v[68:71]
v_mfma_f32_16x16x32_bf16 v[76:79], v[108:111], a[180:183], v[76:79]
v_mfma_f32_16x16x32_bf16 v[84:87], v[108:111], a[184:187], v[84:87]
v_mfma_f32_16x16x32_bf16 v[92:95], v[108:111], a[188:191], v[92:95]
ds_read_b128 v[104:107], v7 offset:13312
ds_read_b128 v[108:111], v7 offset:31744
s_waitcnt lgkmcnt(2)
v_mfma_f32_16x16x32_bf16 v[64:67], a[192:195], v[96:99], v[64:67]
v_mfma_f32_16x16x32_bf16 v[72:75], v[96:99], a[196:199], v[72:75]
v_mfma_f32_16x16x32_bf16 v[80:83], v[96:99], a[200:203], v[80:83]
v_mfma_f32_16x16x32_bf16 v[88:91], v[96:99], a[204:207], v[88:91]
v_mfma_f32_16x16x32_bf16 v[68:71], a[192:195], v[100:103], v[68:71]
v_mfma_f32_16x16x32_bf16 v[76:79], v[100:103], a[196:199], v[76:79]
v_mfma_f32_16x16x32_bf16 v[84:87], v[100:103], a[200:203], v[84:87]
v_mfma_f32_16x16x32_bf16 v[92:95], v[100:103], a[204:207], v[92:95]
ds_read_b128 v[96:99], v7 offset:14336
ds_read_b128 v[100:103], v7 offset:32768
s_waitcnt lgkmcnt(2)
v_mfma_f32_16x16x32_bf16 v[64:67], a[208:211], v[104:107], v[64:67]
v_mfma_f32_16x16x32_bf16 v[72:75], v[104:107], a[212:215], v[72:75]
v_mfma_f32_16x16x32_bf16 v[80:83], v[104:107], a[216:219], v[80:83]
v_mfma_f32_16x16x32_bf16 v[88:91], v[104:107], a[220:223], v[88:91]
v_mfma_f32_16x16x32_bf16 v[68:71], a[208:211], v[108:111], v[68:71]
v_mfma_f32_16x16x32_bf16 v[76:79], v[108:111], a[212:215], v[76:79]
v_mfma_f32_16x16x32_bf16 v[84:87], v[108:111], a[216:219], v[84:87]
v_mfma_f32_16x16x32_bf16 v[92:95], v[108:111], a[220:223], v[92:95]
ds_read_b128 v[104:107], v7 offset:15360
ds_read_b128 v[108:111], v7 offset:33792
s_waitcnt lgkmcnt(2)
v_mfma_f32_16x16x32_bf16 v[64:67], a[224:227], v[96:99], v[64:67]
v_mfma_f32_16x16x32_bf16 v[72:75], v[96:99], a[228:231], v[72:75]
v_mfma_f32_16x16x32_bf16 v[80:83], v[96:99], a[232:235], v[80:83]
v_mfma_f32_16x16x32_bf16 v[88:91], v[96:99], a[236:239], v[88:91]
v_mfma_f32_16x16x32_bf16 v[68:71], a[224:227], v[100:103], v[68:71]
v_mfma_f32_16x16x32_bf16 v[76:79], v[100:103], a[228:231], v[76:79]
v_mfma_f32_16x16x32_bf16 v[84:87], v[100:103], a[232:235], v[84:87]
v_mfma_f32_16x16x32_bf16 v[92:95], v[100:103], a[236:239], v[92:95]
ds_read_b128 v[96:99], v7 offset:16384
ds_read_b128 v[100:103], v7 offset:34816
s_waitcnt lgkmcnt(2)
v_mfma_f32_16x16x32_bf16 v[64:67], a[240:243], v[104:107], v[64:67]
v_mfma_f32_16x16x32_bf16 v[72:75], v[104:107], a[244:247], v[72:75]
v_mfma_f32_16x16x32_bf16 v[80:83], v[104:107], a[248:251], v[80:83]
v_mfma_f32_16x16x32_bf16 v[88:91], v[104:107], a[252:255], v[88:91]
v_mfma_f32_16x16x32_bf16 v[68:71], a[240:243], v[108:111], v[68:71]
v_mfma_f32_16x16x32_bf16 v[76:79], v[108:111], a[244:247], v[76:79]
v_mfma_f32_16x16x32_bf16 v[84:87], v[108:111], a[248:251], v[84:87]
v_mfma_f32_16x16x32_bf16 v[92:95], v[108:111], a[252:255], v[92:95]
ds_read_b128 v[104:107], v7 offset:17408
ds_read_b128 v[108:111], v7 offset:35840
s_waitcnt lgkmcnt(2)
v_mfma_f32_16x16x32_bf16 v[64:67], v[224:227], v[96:99], v[64:67]
v_mfma_f32_16x16x32_bf16 v[72:75], v[96:99], v[228:231], v[72:75]
v_mfma_f32_16x16x32_bf16 v[80:83], v[96:99], v[232:235], v[80:83]
v_mfma_f32_16x16x32_bf16 v[88:91], v[96:99], v[236:239], v[88:91]
v_mfma_f32_16x16x32_bf16 v[68:71], v[224:227], v[100:103], v[68:71]
v_mfma_f32_16x16x32_bf16 v[76:79], v[100:103], v[228:231], v[76:79]
v_mfma_f32_16x16x32_bf16 v[84:87], v[100:103], v[232:235], v[84:87]
v_mfma_f32_16x16x32_bf16 v[92:95], v[100:103], v[236:239], v[92:95]
s_waitcnt lgkmcnt(0)
v_mfma_f32_16x16x32_bf16 v[64:67], v[240:243], v[104:107], v[64:67]
v_mfma_f32_16x16x32_bf16 v[72:75], v[104:107], v[244:247], v[72:75]
v_mfma_f32_16x16x32_bf16 v[80:83], v[104:107], v[248:251], v[80:83]
v_mfma_f32_16x16x32_bf16 v[88:91], v[104:107], v[252:255], v[88:91]
v_mfma_f32_16x16x32_bf16 v[68:71], v[240:243], v[108:111], v[68:71]
v_mfma_f32_16x16x32_bf16 v[76:79], v[108:111], v[244:247], v[76:79]
v_mfma_f32_16x16x32_bf16 v[84:87], v[108:111], v[248:251], v[84:87]
v_mfma_f32_16x16x32_bf16 v[92:95], v[108:111], v[252:255], v[92:95]
s_barrier
s_nop 2
v_cndmask_b32 v96, v88, 1.0, s[46:47]
v_min_f32 v44, 0, v88
v_mul_f32 v44, 0x3fb8aa3b, v44
v_exp_f32 v44, v44
v_max_f32 v88, 0, v88
v_add_f32 v88, 0x358637bd, v88
v_add_f32 v88, v88, v44
v_cndmask_b32 v88, v96, v88, s[44:45]
v_cndmask_b32 v97, v89, 1.0, s[46:47]
v_min_f32 v45, 0, v89
v_mul_f32 v45, 0x3fb8aa3b, v45
v_exp_f32 v45, v45
v_max_f32 v89, 0, v89
v_add_f32 v89, 0x358637bd, v89
v_add_f32 v89, v89, v45
v_cndmask_b32 v89, v97, v89, s[44:45]
v_cndmask_b32 v98, v90, 1.0, s[46:47]
v_min_f32 v44, 0, v90
v_mul_f32 v44, 0x3fb8aa3b, v44
v_exp_f32 v44, v44
v_max_f32 v90, 0, v90
v_add_f32 v90, 0x358637bd, v90
v_add_f32 v90, v90, v44
v_cndmask_b32 v90, v98, v90, s[44:45]
v_cndmask_b32 v99, v91, 1.0, s[46:47]
v_min_f32 v45, 0, v91
v_mul_f32 v45, 0x3fb8aa3b, v45
v_exp_f32 v45, v45
v_max_f32 v91, 0, v91
v_add_f32 v91, 0x358637bd, v91
v_add_f32 v91, v91, v45
v_cndmask_b32 v91, v99, v91, s[44:45]
v_cndmask_b32 v100, v92, 1.0, s[46:47]
v_min_f32 v44, 0, v92
v_mul_f32 v44, 0x3fb8aa3b, v44
v_exp_f32 v44, v44
v_max_f32 v92, 0, v92
v_add_f32 v92, 0x358637bd, v92
v_add_f32 v92, v92, v44
v_cndmask_b32 v92, v100, v92, s[44:45]
v_cndmask_b32 v101, v93, 1.0, s[46:47]
v_min_f32 v45, 0, v93
v_mul_f32 v45, 0x3fb8aa3b, v45
v_exp_f32 v45, v45
v_max_f32 v93, 0, v93
v_add_f32 v93, 0x358637bd, v93
v_add_f32 v93, v93, v45
v_cndmask_b32 v93, v101, v93, s[44:45]
v_cndmask_b32 v102, v94, 1.0, s[46:47]
v_min_f32 v44, 0, v94
v_mul_f32 v44, 0x3fb8aa3b, v44
v_exp_f32 v44, v44
v_max_f32 v94, 0, v94
v_add_f32 v94, 0x358637bd, v94
v_add_f32 v94, v94, v44
v_cndmask_b32 v94, v102, v94, s[44:45]
v_cndmask_b32 v103, v95, 1.0, s[46:47]
v_min_f32 v45, 0, v95
v_mul_f32 v45, 0x3fb8aa3b, v45
v_exp_f32 v45, v45
v_max_f32 v95, 0, v95
v_add_f32 v95, 0x358637bd, v95
v_add_f32 v95, v95, v45
v_cndmask_b32 v95, v103, v95, s[44:45]
v_cvt_pk_bf16_f32 v96, v88, v89
v_cvt_pk_bf16_f32 v97, v90, v91
v_cvt_pk_bf16_f32 v98, v92, v93
v_cvt_pk_bf16_f32 v99, v94, v95
s_mov_b64 exec, s[48:49]
ds_write_b16 v5, v96 offset:0
ds_write_b16_d16_hi v5, v96 offset:4
ds_write_b16 v5, v97 offset:8
ds_write_b16_d16_hi v5, v97 offset:12
ds_write_b16 v5, v98 offset:64
ds_write_b16_d16_hi v5, v98 offset:68
ds_write_b16 v5, v99 offset:72
ds_write_b16_d16_hi v5, v99 offset:76
s_mov_b64 exec, -1
v_min_f32 v44, 0, v72
v_mul_f32 v44, 0x3fb8aa3b, v44
v_exp_f32 v44, v44
v_max_f32 v72, 0, v72
v_add_f32 v72, 0x358637bd, v72
v_add_f32 v72, v72, v44
v_min_f32 v45, 0, v73
v_mul_f32 v45, 0x3fb8aa3b, v45
v_exp_f32 v45, v45
v_max_f32 v73, 0, v73
v_add_f32 v73, 0x358637bd, v73
v_add_f32 v73, v73, v45
v_min_f32 v44, 0, v74
v_mul_f32 v44, 0x3fb8aa3b, v44
v_exp_f32 v44, v44
v_max_f32 v74, 0, v74
v_add_f32 v74, 0x358637bd, v74
v_add_f32 v74, v74, v44
v_min_f32 v45, 0, v75
v_mul_f32 v45, 0x3fb8aa3b, v45
v_exp_f32 v45, v45
v_max_f32 v75, 0, v75
v_add_f32 v75, 0x358637bd, v75
v_add_f32 v75, v75, v45
v_min_f32 v44, 0, v76
v_mul_f32 v44, 0x3fb8aa3b, v44
v_exp_f32 v44, v44
v_max_f32 v76, 0, v76
v_add_f32 v76, 0x358637bd, v76
v_add_f32 v76, v76, v44
v_min_f32 v45, 0, v77
v_mul_f32 v45, 0x3fb8aa3b, v45
v_exp_f32 v45, v45
v_max_f32 v77, 0, v77
v_add_f32 v77, 0x358637bd, v77
v_add_f32 v77, v77, v45
v_min_f32 v44, 0, v78
v_mul_f32 v44, 0x3fb8aa3b, v44
v_exp_f32 v44, v44
v_max_f32 v78, 0, v78
v_add_f32 v78, 0x358637bd, v78
v_add_f32 v78, v78, v44
v_min_f32 v45, 0, v79
v_mul_f32 v45, 0x3fb8aa3b, v45
v_exp_f32 v45, v45
v_max_f32 v79, 0, v79
v_add_f32 v79, 0x358637bd, v79
v_add_f32 v79, v79, v45
v_cvt_pk_bf16_f32 v100, v72, v73
v_cvt_pk_bf16_f32 v104, v80, v81
v_cvt_pk_bf16_f32 v101, v74, v75
v_cvt_pk_bf16_f32 v105, v82, v83
v_cvt_pk_bf16_f32 v102, v76, v77
v_cvt_pk_bf16_f32 v106, v84, v85
v_cvt_pk_bf16_f32 v103, v78, v79
v_cvt_pk_bf16_f32 v107, v86, v87
s_waitcnt lgkmcnt(0)
ds_read_b32 v54, v6
ds_read_b32 v58, v6 offset:64
v_mfma_f32_16x16x32_bf16 v[112:115], v[100:103], v[104:107], v[112:115]
v_mfma_f32_16x16x32_bf16 v[116:119], v[96:99], v[104:107], v[116:119]
v_mfma_f32_16x16x32_bf16 v[120:123], v[100:103], v[96:99], v[120:123]
v_mfma_f32_16x16x32_bf16 v[124:127], v[96:99], v[96:99], v[124:127]
v_min_f32 v44, 0, v64
v_mul_f32 v44, 0x3fb8aa3b, v44
v_exp_f32 v44, v44
v_max_f32 v64, 0, v64
v_add_f32 v64, 0x358637bd, v64
v_add_f32 v64, v64, v44
v_min_f32 v45, 0, v65
v_mul_f32 v45, 0x3fb8aa3b, v45
v_exp_f32 v45, v45
v_max_f32 v65, 0, v65
v_add_f32 v65, 0x358637bd, v65
v_add_f32 v65, v65, v45
v_min_f32 v44, 0, v66
v_mul_f32 v44, 0x3fb8aa3b, v44
v_exp_f32 v44, v44
v_max_f32 v66, 0, v66
v_add_f32 v66, 0x358637bd, v66
v_add_f32 v66, v66, v44
v_min_f32 v45, 0, v67
v_mul_f32 v45, 0x3fb8aa3b, v45
v_exp_f32 v45, v45
v_max_f32 v67, 0, v67
v_add_f32 v67, 0x358637bd, v67
v_add_f32 v67, v67, v45
v_min_f32 v44, 0, v68
v_mul_f32 v44, 0x3fb8aa3b, v44
v_exp_f32 v44, v44
v_max_f32 v68, 0, v68
v_add_f32 v68, 0x358637bd, v68
v_add_f32 v68, v68, v44
v_min_f32 v45, 0, v69
v_mul_f32 v45, 0x3fb8aa3b, v45
v_exp_f32 v45, v45
v_max_f32 v69, 0, v69
v_add_f32 v69, 0x358637bd, v69
v_add_f32 v69, v69, v45
v_min_f32 v44, 0, v70
v_mul_f32 v44, 0x3fb8aa3b, v44
v_exp_f32 v44, v44
v_max_f32 v70, 0, v70
v_add_f32 v70, 0x358637bd, v70
v_add_f32 v70, v70, v44
v_min_f32 v45, 0, v71
v_mul_f32 v45, 0x3fb8aa3b, v45
v_exp_f32 v45, v45
v_max_f32 v71, 0, v71
v_add_f32 v71, 0x358637bd, v71
v_add_f32 v71, v71, v45
v_cvt_pk_bf16_f32 v52, v64, v65
v_cvt_pk_bf16_f32 v53, v66, v67
v_cvt_pk_bf16_f32 v56, v68, v69
v_cvt_pk_bf16_f32 v57, v70, v71
s_lshl_b32 s41, s37, 5
s_add_u32 s41, s41, s35
s_mul_i32 s41, s41, 1536
s_mul_i32 s26, s36, 3145728
s_add_u32 s41, s41, s26
s_add_u32 s41, s41, 10485760
s_waitcnt lgkmcnt(0)
buffer_store_dwordx3 v[52:54], v63, s[4:7], s41 offen sc1
buffer_store_dwordx3 v[56:58], v63, s[4:7], s41 offen offset:768 sc1
s_waitcnt vmcnt(2)
s_mov_b32 s37, s39
s_cmp_lt_u32 s37, 64
s_cbranch_scc1 P1_seg
s_mul_i32 s42, s36, 4194304
s_lshl_b32 s26, s35, 12
s_add_u32 s42, s42, s26
s_add_u32 s42, s42, 1048576
s_lshl_b32 s43, s36, 2
s_mul_i32 s26, s33, 2816
s_add_u32 s43, s43, s26
s_add_u32 s43, s43, 62464
s_cmp_eq_u32 s32, 21
s_cbranch_scc1 P1_fin
s_lshl_b32 s26, s32, 17
s_add_u32 s41, s42, s26
buffer_store_dwordx4 v[112:115], v1, s[4:7], s41 offen offset:0 sc1
buffer_store_dwordx4 v[116:119], v1, s[4:7], s41 offen offset:1024 sc1
buffer_store_dwordx4 v[120:123], v1, s[4:7], s41 offen offset:2048 sc1
buffer_store_dwordx4 v[124:127], v1, s[4:7], s41 offen offset:3072 sc1
s_lshl_b32 s26, s32, 7
s_add_u32 s41, s43, s26
s_waitcnt vmcnt(0)
s_barrier
s_cmp_lg_u32 s24, 0
s_cbranch_scc1 Lsg5
v_mov_b32 v50, 1
s_mov_b64 exec, 1
buffer_store_dword v50, off, s[4:7], s41 sc1
s_mov_b64 exec, -1
Lsg5:
s_cmp_eq_u32 s34, 1
s_cbranch_scc1 P3
s_cmp_eq_u32 s34, 0
s_cbranch_scc1 P1_next
s_mov_b32 s32, s52
s_mov_b32 s33, s53
s_barrier
s_branch P4
P1_fin:
s_cmp_eq_u32 s36, 0
s_cselect_b32 s40, 0, 19
v_max_u32 v50, s40, v0
v_min_u32 v50, 20, v50
v_lshlrev_b32 v50, 7, v50
s_mov_b32 s29, 0
Lwf6:
buffer_load_dword v51, v50, s[4:7], s43 offen sc1
s_add_u32 s29, s29, 1
s_waitcnt vmcnt(0)
v_cmp_eq_u32 vcc, 0, v51
s_cbranch_vccz Lwd7
s_sleep 1
s_cmp_lt_u32 s29, s25
s_cbranch_scc1 Lwf6
s_mov_b32 s25, 0
Lwd7:
v_and_b32 v51, 15, v0
v_subrev_u32 v51, 8, v51
v_cmp_gt_u32 vcc, 3, v51
v_or_b32 v44, 0x40000000, v1
v_cndmask_b32 v45, v44, v1, s[50:51]
v_cndmask_b32 v46, v44, v1, vcc
v_or_b32 v47, v45, v46
v_mov_b32 v44, v1
P1_red11:
s_cmp_lg_u32 s36, 0
s_cbranch_scc1 P1_red2
s_add_u32 s27, s40, 0
s_lshl_b32 s26, s27, 17
s_add_u32 s41, s42, s26
s_cmp_lt_u32 s27, 21
s_cselect_b32 s26, 0, 0x40000000
v_or_b32 v48, s26, v44
buffer_load_dwordx4 v[128:131], v48, s[4:7], s41 offen offset:0 sc1
v_or_b32 v49, s26, v45
buffer_load_dwordx4 v[132:135], v49, s[4:7], s41 offen offset:1024 sc1
v_or_b32 v50, s26, v46
buffer_load_dwordx4 v[136:139], v50, s[4:7], s41 offen offset:2048 sc1
v_or_b32 v51, s26, v47
buffer_load_dwordx4 v[140:143], v51, s[4:7], s41 offen offset:3072 sc1
s_add_u32 s27, s40, 1
s_lshl_b32 s26, s27, 17
s_add_u32 s41, s42, s26
s_cmp_lt_u32 s27, 21
s_cselect_b32 s26, 0, 0x40000000
v_or_b32 v48, s26, v44
buffer_load_dwordx4 v[144:147], v48, s[4:7], s41 offen offset:0 sc1
v_or_b32 v49, s26, v45
buffer_load_dwordx4 v[148:151], v49, s[4:7], s41 offen offset:1024 sc1
v_or_b32 v50, s26, v46
buffer_load_dwordx4 v[152:155], v50, s[4:7], s41 offen offset:2048 sc1
v_or_b32 v51, s26, v47
buffer_load_dwordx4 v[156:159], v51, s[4:7], s41 offen offset:3072 sc1
s_add_u32 s27, s40, 2
s_lshl_b32 s26, s27, 17
s_add_u32 s41, s42, s26
s_cmp_lt_u32 s27, 21
s_cselect_b32 s26, 0, 0x40000000
v_or_b32 v48, s26, v44
buffer_load_dwordx4 v[160:163], v48, s[4:7], s41 offen offset:0 sc1
v_or_b32 v49, s26, v45
buffer_load_dwordx4 v[164:167], v49, s[4:7], s41 offen offset:1024 sc1
v_or_b32 v50, s26, v46
buffer_load_dwordx4 v[168:171], v50, s[4:7], s41 offen offset:2048 sc1
v_or_b32 v51, s26, v47
buffer_load_dwordx4 v[172:175], v51, s[4:7], s41 offen offset:3072 sc1
s_add_u32 s27, s40, 3
s_lshl_b32 s26, s27, 17
s_add_u32 s41, s42, s26
s_cmp_lt_u32 s27, 21
s_cselect_b32 s26, 0, 0x40000000
v_or_b32 v48, s26, v44
buffer_load_dwordx4 v[176:179], v48, s[4:7], s41 offen offset:0 sc1
v_or_b32 v49, s26, v45
buffer_load_dwordx4 v[180:183], v49, s[4:7], s41 offen offset:1024 sc1
v_or_b32 v50, s26, v46
buffer_load_dwordx4 v[184:187], v50, s[4:7], s41 offen offset:2048 sc1
v_or_b32 v51, s26, v47
buffer_load_dwordx4 v[188:191], v51, s[4:7], s41 offen offset:3072 sc1
s_add_u32 s27, s40, 4
s_lshl_b32 s26, s27, 17
s_add_u32 s41, s42, s26
s_cmp_lt_u32 s27, 21
s_cselect_b32 s26, 0, 0x40000000
v_or_b32 v48, s26, v44
buffer_load_dwordx4 v[192:195], v48, s[4:7], s41 offen offset:0 sc1
v_or_b32 v49, s26, v45
buffer_load_dwordx4 v[196:199], v49, s[4:7], s41 offen offset:1024 sc1
v_or_b32 v50, s26, v46
buffer_load_dwordx4 v[200:203], v50, s[4:7], s41 offen offset:2048 sc1
v_or_b32 v51, s26, v47
buffer_load_dwordx4 v[204:207], v51, s[4:7], s41 offen offset:3072 sc1
s_add_u32 s27, s40, 5
s_lshl_b32 s26, s27, 17
s_add_u32 s41, s42, s26
s_cmp_lt_u32 s27, 21
s_cselect_b32 s26, 0, 0x40000000
v_or_b32 v48, s26, v44
buffer_load_dwordx4 v[208:211], v48, s[4:7], s41 offen offset:0 sc1
v_or_b32 v49, s26, v45
buffer_load_dwordx4 v[212:215], v49, s[4:7], s41 offen offset:1024 sc1
v_or_b32 v50, s26, v46
buffer_load_dwordx4 v[216:219], v50, s[4:7], s41 offen offset:2048 sc1
v_or_b32 v51, s26, v47
buffer_load_dwordx4 v[220:223], v51, s[4:7], s41 offen offset:3072 sc1
s_add_u32 s27, s40, 6
s_lshl_b32 s26, s27, 17
s_add_u32 s41, s42, s26
s_cmp_lt_u32 s27, 21
s_cselect_b32 s26, 0, 0x40000000
v_or_b32 v48, s26, v44
buffer_load_dwordx4 v[64:67], v48, s[4:7], s41 offen offset:0 sc1
v_or_b32 v49, s26, v45
buffer_load_dwordx4 v[68:71], v49, s[4:7], s41 offen offset:1024 sc1
v_or_b32 v50, s26, v46
buffer_load_dwordx4 v[72:75], v50, s[4:7], s41 offen offset:2048 sc1
v_or_b32 v51, s26, v47
buffer_load_dwordx4 v[76:79], v51, s[4:7], s41 offen offset:3072 sc1
s_add_u32 s27, s40, 7
s_lshl_b32 s26, s27, 17
s_add_u32 s41, s42, s26
s_cmp_lt_u32 s27, 21
s_cselect_b32 s26, 0, 0x40000000
v_or_b32 v48, s26, v44
buffer_load_dwordx4 v[80:83], v48, s[4:7], s41 offen offset:0 sc1
v_or_b32 v49, s26, v45
buffer_load_dwordx4 v[84:87], v49, s[4:7], s41 offen offset:1024 sc1
v_or_b32 v50, s26, v46
buffer_load_dwordx4 v[88:91], v50, s[4:7], s41 offen offset:2048 sc1
v_or_b32 v51, s26, v47
buffer_load_dwordx4 v[92:95], v51, s[4:7], s41 offen offset:3072 sc1
s_add_u32 s27, s40, 8
s_lshl_b32 s26, s27, 17
s_add_u32 s41, s42, s26
s_cmp_lt_u32 s27, 21
s_cselect_b32 s26, 0, 0x40000000
v_or_b32 v48, s26, v44
buffer_load_dwordx4 v[96:99], v48, s[4:7], s41 offen offset:0 sc1
v_or_b32 v49, s26, v45
buffer_load_dwordx4 v[100:103], v49, s[4:7], s41 offen offset:1024 sc1
v_or_b32 v50, s26, v46
buffer_load_dwordx4 v[104:107], v50, s[4:7], s41 offen offset:2048 sc1
v_or_b32 v51, s26, v47
buffer_load_dwordx4 v[108:111], v51, s[4:7], s41 offen offset:3072 sc1
s_add_u32 s27, s40, 9
s_lshl_b32 s26, s27, 17
s_add_u32 s41, s42, s26
s_cmp_lt_u32 s27, 21
s_cselect_b32 s26, 0, 0x40000000
v_or_b32 v48, s26, v44
buffer_load_dwordx4 v[8:11], v48, s[4:7], s41 offen offset:0 sc1
v_or_b32 v49, s26, v45
buffer_load_dwordx4 v[12:15], v49, s[4:7], s41 offen offset:1024 sc1
v_or_b32 v50, s26, v46
buffer_load_dwordx4 v[16:19], v50, s[4:7], s41 offen offset:2048 sc1
v_or_b32 v51, s26, v47
buffer_load_dwordx4 v[20:23], v51, s[4:7], s41 offen offset:3072 sc1
s_add_u32 s27, s40, 10
s_lshl_b32 s26, s27, 17
s_add_u32 s41, s42, s26
s_cmp_lt_u32 s27, 21
s_cselect_b32 s26, 0, 0x40000000
v_or_b32 v48, s26, v44
buffer_load_dwordx4 v[24:27], v48, s[4:7], s41 offen offset:0 sc1
v_or_b32 v49, s26, v45
buffer_load_dwordx4 v[28:31], v49, s[4:7], s41 offen offset:1024 sc1
v_or_b32 v50, s26, v46
buffer_load_dwordx4 v[32:35], v50, s[4:7], s41 offen offset:2048 sc1
v_or_b32 v51, s26, v47
buffer_load_dwordx4 v[36:39], v51, s[4:7], s41 offen offset:3072 sc1
s_waitcnt vmcnt(40)
v_pk_add_f32 v[112:113], v[112:113], v[128:129]
v_pk_add_f32 v[114:115], v[114:115], v[130:131]
v_pk_add_f32 v[116:117], v[116:117], v[132:133]
v_pk_add_f32 v[118:119], v[118:119], v[134:135]
v_pk_add_f32 v[120:121], v[120:121], v[136:137]
v_pk_add_f32 v[122:123], v[122:123], v[138:139]
v_pk_add_f32 v[124:125], v[124:125], v[140:141]
v_pk_add_f32 v[126:127], v[126:127], v[142:143]
s_waitcnt vmcnt(36)
v_pk_add_f32 v[112:113], v[112:113], v[144:145]
v_pk_add_f32 v[114:115], v[114:115], v[146:147]
v_pk_add_f32 v[116:117], v[116:117], v[148:149]
v_pk_add_f32 v[118:119], v[118:119], v[150:151]
v_pk_add_f32 v[120:121], v[120:121], v[152:153]
v_pk_add_f32 v[122:123], v[122:123], v[154:155]
v_pk_add_f32 v[124:125], v[124:125], v[156:157]
v_pk_add_f32 v[126:127], v[126:127], v[158:159]
s_waitcnt vmcnt(32)
v_pk_add_f32 v[112:113], v[112:113], v[160:161]
v_pk_add_f32 v[114:115], v[114:115], v[162:163]
v_pk_add_f32 v[116:117], v[116:117], v[164:165]
v_pk_add_f32 v[118:119], v[118:119], v[166:167]
v_pk_add_f32 v[120:121], v[120:121], v[168:169]
v_pk_add_f32 v[122:123], v[122:123], v[170:171]
v_pk_add_f32 v[124:125], v[124:125], v[172:173]
v_pk_add_f32 v[126:127], v[126:127], v[174:175]
s_waitcnt vmcnt(28)
v_pk_add_f32 v[112:113], v[112:113], v[176:177]
v_pk_add_f32 v[114:115], v[114:115], v[178:179]
v_pk_add_f32 v[116:117], v[116:117], v[180:181]
v_pk_add_f32 v[118:119], v[118:119], v[182:183]
v_pk_add_f32 v[120:121], v[120:121], v[184:185]
v_pk_add_f32 v[122:123], v[122:123], v[186:187]
v_pk_add_f32 v[124:125], v[124:125], v[188:189]
v_pk_add_f32 v[126:127], v[126:127], v[190:191]
s_waitcnt vmcnt(24)
v_pk_add_f32 v[112:113], v[112:113], v[192:193]
v_pk_add_f32 v[114:115], v[114:115], v[194:195]
v_pk_add_f32 v[116:117], v[116:117], v[196:197]
v_pk_add_f32 v[118:119], v[118:119], v[198:199]
v_pk_add_f32 v[120:121], v[120:121], v[200:201]
v_pk_add_f32 v[122:123], v[122:123], v[202:203]
v_pk_add_f32 v[124:125], v[124:125], v[204:205]
v_pk_add_f32 v[126:127], v[126:127], v[206:207]
s_waitcnt vmcnt(20)
v_pk_add_f32 v[112:113], v[112:113], v[208:209]
v_pk_add_f32 v[114:115], v[114:115], v[210:211]
v_pk_add_f32 v[116:117], v[116:117], v[212:213]
v_pk_add_f32 v[118:119], v[118:119], v[214:215]
v_pk_add_f32 v[120:121], v[120:121], v[216:217]
v_pk_add_f32 v[122:123], v[122:123], v[218:219]
v_pk_add_f32 v[124:125], v[124:125], v[220:221]
v_pk_add_f32 v[126:127], v[126:127], v[222:223]
s_waitcnt vmcnt(16)
v_pk_add_f32 v[112:113], v[112:113], v[64:65]
v_pk_add_f32 v[114:115], v[114:115], v[66:67]
v_pk_add_f32 v[116:117], v[116:117], v[68:69]
v_pk_add_f32 v[118:119], v[118:119], v[70:71]
v_pk_add_f32 v[120:121], v[120:121], v[72:73]
v_pk_add_f32 v[122:123], v[122:123], v[74:75]
v_pk_add_f32 v[124:125], v[124:125], v[76:77]
v_pk_add_f32 v[126:127], v[126:127], v[78:79]
s_waitcnt vmcnt(12)
v_pk_add_f32 v[112:113], v[112:113], v[80:81]
v_pk_add_f32 v[114:115], v[114:115], v[82:83]
v_pk_add_f32 v[116:117], v[116:117], v[84:85]
v_pk_add_f32 v[118:119], v[118:119], v[86:87]
v_pk_add_f32 v[120:121], v[120:121], v[88:89]
v_pk_add_f32 v[122:123], v[122:123], v[90:91]
v_pk_add_f32 v[124:125], v[124:125], v[92:93]
v_pk_add_f32 v[126:127], v[126:127], v[94:95]
s_waitcnt vmcnt(8)
v_pk_add_f32 v[112:113], v[112:113], v[96:97]
v_pk_add_f32 v[114:115], v[114:115], v[98:99]
v_pk_add_f32 v[116:117], v[116:117], v[100:101]
v_pk_add_f32 v[118:119], v[118:119], v[102:103]
v_pk_add_f32 v[120:121], v[120:121], v[104:105]
v_pk_add_f32 v[122:123], v[122:123], v[106:107]
v_pk_add_f32 v[124:125], v[124:125], v[108:109]
v_pk_add_f32 v[126:127], v[126:127], v[110:111]
s_waitcnt vmcnt(4)
v_pk_add_f32 v[112:113], v[112:113], v[8:9]
v_pk_add_f32 v[114:115], v[114:115], v[10:11]
v_pk_add_f32 v[116:117], v[116:117], v[12:13]
v_pk_add_f32 v[118:119], v[118:119], v[14:15]
v_pk_add_f32 v[120:121], v[120:121], v[16:17]
v_pk_add_f32 v[122:123], v[122:123], v[18:19]
v_pk_add_f32 v[124:125], v[124:125], v[20:21]
v_pk_add_f32 v[126:127], v[126:127], v[22:23]
s_waitcnt vmcnt(0)
v_pk_add_f32 v[112:113], v[112:113], v[24:25]
v_pk_add_f32 v[114:115], v[114:115], v[26:27]
v_pk_add_f32 v[116:117], v[116:117], v[28:29]
v_pk_add_f32 v[118:119], v[118:119], v[30:31]
v_pk_add_f32 v[120:121], v[120:121], v[32:33]
v_pk_add_f32 v[122:123], v[122:123], v[34:35]
v_pk_add_f32 v[124:125], v[124:125], v[36:37]
v_pk_add_f32 v[126:127], v[126:127], v[38:39]
s_add_u32 s40, s40, 11
s_cmp_lt_u32 s40, 21
s_cbranch_scc1 P1_red11
s_branch P1_rd
P1_red2:
s_add_u32 s27, s40, 0
s_lshl_b32 s26, s27, 17
s_add_u32 s41, s42, s26
s_cmp_lt_u32 s27, 21
s_cselect_b32 s26, 0, 0x40000000
v_or_b32 v48, s26, v44
buffer_load_dwordx4 v[128:131], v48, s[4:7], s41 offen offset:0 sc1
v_or_b32 v49, s26, v45
buffer_load_dwordx4 v[132:135], v49, s[4:7], s41 offen offset:1024 sc1
v_or_b32 v50, s26, v46
buffer_load_dwordx4 v[136:139], v50, s[4:7], s41 offen offset:2048 sc1
v_or_b32 v51, s26, v47
buffer_load_dwordx4 v[140:143], v51, s[4:7], s41 offen offset:3072 sc1
s_add_u32 s27, s40, 1
s_lshl_b32 s26, s27, 17
s_add_u32 s41, s42, s26
s_cmp_lt_u32 s27, 21
s_cselect_b32 s26, 0, 0x40000000
v_or_b32 v48, s26, v44
buffer_load_dwordx4 v[144:147], v48, s[4:7], s41 offen offset:0 sc1
v_or_b32 v49, s26, v45
buffer_load_dwordx4 v[148:151], v49, s[4:7], s41 offen offset:1024 sc1
v_or_b32 v50, s26, v46
buffer_load_dwordx4 v[152:155], v50, s[4:7], s41 offen offset:2048 sc1
v_or_b32 v51, s26, v47
buffer_load_dwordx4 v[156:159], v51, s[4:7], s41 offen offset:3072 sc1
s_waitcnt vmcnt(4)
v_pk_add_f32 v[112:113], v[112:113], v[128:129]
v_pk_add_f32 v[114:115], v[114:115], v[130:131]
v_pk_add_f32 v[116:117], v[116:117], v[132:133]
v_pk_add_f32 v[118:119], v[118:119], v[134:135]
v_pk_add_f32 v[120:121], v[120:121], v[136:137]
v_pk_add_f32 v[122:123], v[122:123], v[138:139]
v_pk_add_f32 v[124:125], v[124:125], v[140:141]
v_pk_add_f32 v[126:127], v[126:127], v[142:143]
s_waitcnt vmcnt(0)
v_pk_add_f32 v[112:113], v[112:113], v[144:145]
v_pk_add_f32 v[114:115], v[114:115], v[146:147]
v_pk_add_f32 v[116:117], v[116:117], v[148:149]
v_pk_add_f32 v[118:119], v[118:119], v[150:151]
v_pk_add_f32 v[120:121], v[120:121], v[152:153]
v_pk_add_f32 v[122:123], v[122:123], v[154:155]
v_pk_add_f32 v[124:125], v[124:125], v[156:157]
v_pk_add_f32 v[126:127], v[126:127], v[158:159]
s_add_u32 s40, s40, 2
s_cmp_lt_u32 s40, 21
s_cbranch_scc1 P1_red2
P1_rd:
v_cvt_pk_bf16_f32 v52, v112, v113
v_cvt_pk_bf16_f32 v53, v114, v115
v_cvt_pk_bf16_f32 v54, v116, v117
v_cndmask_b32 v54, 0, v54, s[50:51]
v_mov_b32 v55, 0
v_cvt_pk_bf16_f32 v56, v120, v121
v_cvt_pk_bf16_f32 v57, v122, v123
v_cvt_pk_bf16_f32 v58, v124, v125
v_cndmask_b32 v58, 0, v58, s[50:51]
v_mov_b32 v59, 0
v_and_b32 v50, 3, v0
v_lshlrev_b32 v50, 2, v50
s_mov_b32 s26, 0xa98a
v_lshrrev_b32 v50, v50, s26
v_and_b32 v50, 15, v50
v_and_b32 v51, 48, v0
v_add_lshl_u32 v50, v50, v51, 2
ds_bpermute_b32 v56, v50, v56
ds_bpermute_b32 v57, v50, v57
ds_bpermute_b32 v58, v50, v58
s_mul_i32 s41, s36, 65536
s_lshl_b32 s26, s35, 11
s_add_u32 s41, s41, s26
s_add_u32 s41, s41, 9437184
buffer_store_dwordx4 v[52:55], v1, s[4:7], s41 offen sc1
s_waitcnt lgkmcnt(0)
buffer_store_dwordx4 v[56:59], v1, s[4:7], s41 offen offset:1024 sc1
s_lshl_b32 s41, s36, 2
s_lshl_b32 s26, s33, 7
s_add_u32 s41, s41, s26
s_add_u32 s41, s41, 61440
s_waitcnt vmcnt(0)
s_barrier
s_cmp_lg_u32 s24, 0
s_cbranch_scc1 Lsg8
v_mov_b32 v50, 1
s_mov_b64 exec, 1
buffer_store_dword v50, off, s[4:7], s41 sc1
s_mov_b64 exec, -1
Lsg8:
P1_next:
s_cmp_eq_u32 s36, 1
s_cbranch_scc1 END
s_mov_b32 s36, 1
s_sub_u32 s37, s32, 19
s_add_u32 s37, s37, 1
s_cmp_ge_u32 s37, 3
s_cselect_b32 s26, 3, 0
s_sub_u32 s37, s37, s26
s_mov_b32 s38, 3
s_branch P1_layer
P3:
s_barrier
s_load_dwordx2 s[8:9], s[0:1], 48
s_mov_b32 s10, 4718592
s_mov_b32 s11, 0x20000
s_waitcnt lgkmcnt(0)
s_load_dwordx2 s[12:13], s[0:1], 56
s_mov_b32 s14, 4718592
s_mov_b32 s15, 0x20000
s_waitcnt lgkmcnt(0)
s_load_dwordx2 s[20:21], s[0:1], 40
s_mov_b32 s22, 4718592
s_mov_b32 s23, 0x20000
s_waitcnt lgkmcnt(0)
s_mul_i32 s28, s24, 40960
s_lshl_b32 s27, s52, 8
s_lshl_b32 s26, s24, 6
s_add_u32 s27, s27, s26
v_lshrrev_b32 v50, 2, v0
v_and_b32 v51, 3, v0
v_lshlrev_b32 v50, 13, v50
v_lshl_add_u32 v50, v51, 4, v50
v_add_u32 v56, s27, v50
v_lshrrev_b32 v61, 4, v0
v_bfe_u32 v50, v0, 2, 2
v_lshl_add_u32 v61, v61, 3, v50
v_mul_u32_u24 v61, 64, v61
v_and_b32 v50, 3, v0
v_lshl_add_u32 v61, v50, 3, v61
v_add_u32 v61, s28, v61
s_add_u32 m0, s28, 0
s_mov_b32 s26, 0
buffer_load_dwordx4 v56, s[8:11], s26 offen lds
s_add_u32 m0, s28, 1024
s_mov_b32 s26, 131072
buffer_load_dwordx4 v56, s[8:11], s26 offen lds
s_add_u32 m0, s28, 2048
s_mov_b32 s26, 262144
buffer_load_dwordx4 v56, s[8:11], s26 offen lds
s_add_u32 m0, s28, 3072
s_mov_b32 s26, 393216
buffer_load_dwordx4 v56, s[8:11], s26 offen lds
s_add_u32 m0, s28, 4096
s_mov_b32 s26, 524288
buffer_load_dwordx4 v56, s[8:11], s26 offen lds
s_add_u32 m0, s28, 5120
s_mov_b32 s26, 655360
buffer_load_dwordx4 v56, s[8:11], s26 offen lds
s_add_u32 m0, s28, 6144
s_mov_b32 s26, 786432
buffer_load_dwordx4 v56, s[8:11], s26 offen lds
s_add_u32 m0, s28, 7168
s_mov_b32 s26, 917504
buffer_load_dwordx4 v56, s[8:11], s26 offen lds
s_add_u32 m0, s28, 8192
s_mov_b32 s26, 1048576
buffer_load_dwordx4 v56, s[8:11], s26 offen lds
s_add_u32 m0, s28, 9216
s_mov_b32 s26, 1179648
buffer_load_dwordx4 v56, s[8:11], s26 offen lds
s_add_u32 m0, s28, 10240
s_mov_b32 s26, 1310720
buffer_load_dwordx4 v56, s[8:11], s26 offen lds
s_add_u32 m0, s28, 11264
s_mov_b32 s26, 1441792
buffer_load_dwordx4 v56, s[8:11], s26 offen lds
s_add_u32 m0, s28, 12288
s_mov_b32 s26, 1572864
buffer_load_dwordx4 v56, s[8:11], s26 offen lds
s_add_u32 m0, s28, 13312
s_mov_b32 s26, 1703936
buffer_load_dwordx4 v56, s[8:11], s26 offen lds
s_add_u32 m0, s28, 14336
s_mov_b32 s26, 1835008
buffer_load_dwordx4 v56, s[8:11], s26 offen lds
s_add_u32 m0, s28, 15360
s_mov_b32 s26, 1966080
buffer_load_dwordx4 v56, s[8:11], s26 offen lds
s_add_u32 m0, s28, 16384
s_mov_b32 s26, 2097152
buffer_load_dwordx4 v56, s[8:11], s26 offen lds
s_add_u32 m0, s28, 17408
s_mov_b32 s26, 2228224
buffer_load_dwordx4 v56, s[8:11], s26 offen lds
s_add_u32 m0, s28, 18432
s_mov_b32 s26, 2359296
buffer_load_dwordx4 v56, s[8:11], s26 offen lds
s_add_u32 m0, s28, 19456
s_mov_b32 s26, 2490368
buffer_load_dwordx4 v56, s[8:11], s26 offen lds
s_add_u32 m0, s28, 20480
s_mov_b32 s26, 2621440
buffer_load_dwordx4 v56, s[8:11], s26 offen lds
s_add_u32 m0, s28, 21504
s_mov_b32 s26, 2752512
buffer_load_dwordx4 v56, s[8:11], s26 offen lds
s_add_u32 m0, s28, 22528
s_mov_b32 s26, 2883584
buffer_load_dwordx4 v56, s[8:11], s26 offen lds
s_add_u32 m0, s28, 23552
s_mov_b32 s26, 3014656
buffer_load_dwordx4 v56, s[8:11], s26 offen lds
s_add_u32 m0, s28, 24576
s_mov_b32 s26, 3145728
buffer_load_dwordx4 v56, s[8:11], s26 offen lds
s_add_u32 m0, s28, 25600
s_mov_b32 s26, 3276800
buffer_load_dwordx4 v56, s[8:11], s26 offen lds
s_add_u32 m0, s28, 26624
s_mov_b32 s26, 3407872
buffer_load_dwordx4 v56, s[8:11], s26 offen lds
s_add_u32 m0, s28, 27648
s_mov_b32 s26, 3538944
buffer_load_dwordx4 v56, s[8:11], s26 offen lds
s_add_u32 m0, s28, 28672
s_mov_b32 s26, 3670016
buffer_load_dwordx4 v56, s[8:11], s26 offen lds
s_add_u32 m0, s28, 29696
s_mov_b32 s26, 3801088
buffer_load_dwordx4 v56, s[8:11], s26 offen lds
s_add_u32 m0, s28, 30720
s_mov_b32 s26, 3932160
buffer_load_dwordx4 v56, s[8:11], s26 offen lds
s_add_u32 m0, s28, 31744
s_mov_b32 s26, 4063232
buffer_load_dwordx4 v56, s[8:11], s26 offen lds
s_add_u32 m0, s28, 32768
s_mov_b32 s26, 4194304
buffer_load_dwordx4 v56, s[8:11], s26 offen lds
s_add_u32 m0, s28, 33792
s_mov_b32 s26, 4325376
buffer_load_dwordx4 v56, s[8:11], s26 offen lds
s_add_u32 m0, s28, 34816
s_mov_b32 s26, 4456448
buffer_load_dwordx4 v56, s[8:11], s26 offen lds
s_add_u32 m0, s28, 35840
s_mov_b32 s26, 4587520
buffer_load_dwordx4 v56, s[8:11], s26 offen lds
s_add_u32 m0, s28, 36864
s_mov_b32 s26, 0
buffer_load_dwordx4 v56, s[12:15], s26 offen lds
s_add_u32 m0, s28, 37888
s_mov_b32 s26, 131072
buffer_load_dwordx4 v56, s[12:15], s26 offen lds
s_add_u32 m0, s28, 38912
s_mov_b32 s26, 262144
buffer_load_dwordx4 v56, s[12:15], s26 offen lds
s_add_u32 m0, s28, 39936
s_mov_b32 s26, 393216
buffer_load_dwordx4 v56, s[12:15], s26 offen lds
s_waitcnt vmcnt(20)
ds_read_b64_tr_b16 a[0:1], v61 offset:0
ds_read_b64_tr_b16 a[2:3], v61 offset:256
ds_read_b64_tr_b16 a[4:5], v61 offset:32
ds_read_b64_tr_b16 a[6:7], v61 offset:288
ds_read_b64_tr_b16 a[8:9], v61 offset:2048
ds_read_b64_tr_b16 a[10:11], v61 offset:2304
ds_read_b64_tr_b16 a[12:13], v61 offset:2080
ds_read_b64_tr_b16 a[14:15], v61 offset:2336
ds_read_b64_tr_b16 a[16:17], v61 offset:4096
ds_read_b64_tr_b16 a[18:19], v61 offset:4352
ds_read_b64_tr_b16 a[20:21], v61 offset:4128
ds_read_b64_tr_b16 a[22:23], v61 offset:4384
ds_read_b64_tr_b16 a[24:25], v61 offset:6144
ds_read_b64_tr_b16 a[26:27], v61 offset:6400
ds_read_b64_tr_b16 a[28:29], v61 offset:6176
ds_read_b64_tr_b16 a[30:31], v61 offset:6432
ds_read_b64_tr_b16 a[32:33], v61 offset:8192
ds_read_b64_tr_b16 a[34:35], v61 offset:8448
ds_read_b64_tr_b16 a[36:37], v61 offset:8224
ds_read_b64_tr_b16 a[38:39], v61 offset:8480
ds_read_b64_tr_b16 a[40:41], v61 offset:10240
ds_read_b64_tr_b16 a[42:43], v61 offset:10496
ds_read_b64_tr_b16 a[44:45], v61 offset:10272
ds_read_b64_tr_b16 a[46:47], v61 offset:10528
ds_read_b64_tr_b16 a[48:49], v61 offset:12288
ds_read_b64_tr_b16 a[50:51], v61 offset:12544
ds_read_b64_tr_b16 a[52:53], v61 offset:12320
ds_read_b64_tr_b16 a[54:55], v61 offset:12576
ds_read_b64_tr_b16 a[56:57], v61 offset:14336
ds_read_b64_tr_b16 a[58:59], v61 offset:14592
ds_read_b64_tr_b16 a[60:61], v61 offset:14368
ds_read_b64_tr_b16 a[62:63], v61 offset:14624
ds_read_b64_tr_b16 a[64:65], v61 offset:16384
ds_read_b64_tr_b16 a[66:67], v61 offset:16640
ds_read_b64_tr_b16 a[68:69], v61 offset:16416
ds_read_b64_tr_b16 a[70:71], v61 offset:16672
ds_read_b64_tr_b16 a[72:73], v61 offset:18432
ds_read_b64_tr_b16 a[74:75], v61 offset:18688
ds_read_b64_tr_b16 a[76:77], v61 offset:18464
ds_read_b64_tr_b16 a[78:79], v61 offset:18720
s_waitcnt lgkmcnt(0)
s_add_u32 m0, s28, 0
s_mov_b32 s26, 524288
buffer_load_dwordx4 v56, s[12:15], s26 offen lds
s_add_u32 m0, s28, 1024
s_mov_b32 s26, 655360
buffer_load_dwordx4 v56, s[12:15], s26 offen lds
s_add_u32 m0, s28, 2048
s_mov_b32 s26, 786432
buffer_load_dwordx4 v56, s[12:15], s26 offen lds
s_add_u32 m0, s28, 3072
s_mov_b32 s26, 917504
buffer_load_dwordx4 v56, s[12:15], s26 offen lds
s_add_u32 m0, s28, 4096
s_mov_b32 s26, 1048576
buffer_load_dwordx4 v56, s[12:15], s26 offen lds
s_add_u32 m0, s28, 5120
s_mov_b32 s26, 1179648
buffer_load_dwordx4 v56, s[12:15], s26 offen lds
s_add_u32 m0, s28, 6144
s_mov_b32 s26, 1310720
buffer_load_dwordx4 v56, s[12:15], s26 offen lds
s_add_u32 m0, s28, 7168
s_mov_b32 s26, 1441792
buffer_load_dwordx4 v56, s[12:15], s26 offen lds
s_add_u32 m0, s28, 8192
s_mov_b32 s26, 1572864
buffer_load_dwordx4 v56, s[12:15], s26 offen lds
s_add_u32 m0, s28, 9216
s_mov_b32 s26, 1703936
buffer_load_dwordx4 v56, s[12:15], s26 offen lds
s_add_u32 m0, s28, 10240
s_mov_b32 s26, 1835008
buffer_load_dwordx4 v56, s[12:15], s26 offen lds
s_add_u32 m0, s28, 11264
s_mov_b32 s26, 1966080
buffer_load_dwordx4 v56, s[12:15], s26 offen lds
s_add_u32 m0, s28, 12288
s_mov_b32 s26, 2097152
buffer_load_dwordx4 v56, s[12:15], s26 offen lds
s_add_u32 m0, s28, 13312
s_mov_b32 s26, 2228224
buffer_load_dwordx4 v56, s[12:15], s26 offen lds
s_add_u32 m0, s28, 14336
s_mov_b32 s26, 2359296
buffer_load_dwordx4 v56, s[12:15], s26 offen lds
s_add_u32 m0, s28, 15360
s_mov_b32 s26, 2490368
buffer_load_dwordx4 v56, s[12:15], s26 offen lds
s_add_u32 m0, s28, 16384
s_mov_b32 s26, 2621440
buffer_load_dwordx4 v56, s[12:15], s26 offen lds
s_add_u32 m0, s28, 17408
s_mov_b32 s26, 2752512
buffer_load_dwordx4 v56, s[12:15], s26 offen lds
s_add_u32 m0, s28, 18432
s_mov_b32 s26, 2883584
buffer_load_dwordx4 v56, s[12:15], s26 offen lds
s_add_u32 m0, s28, 19456
s_mov_b32 s26, 3014656
buffer_load_dwordx4 v56, s[12:15], s26 offen lds
s_waitcnt vmcnt(20)
ds_read_b64_tr_b16 a[80:81], v61 offset:20480
ds_read_b64_tr_b16 a[82:83], v61 offset:20736
ds_read_b64_tr_b16 a[84:85], v61 offset:20512
ds_read_b64_tr_b16 a[86:87], v61 offset:20768
ds_read_b64_tr_b16 a[88:89], v61 offset:22528
ds_read_b64_tr_b16 a[90:91], v61 offset:22784
ds_read_b64_tr_b16 a[92:93], v61 offset:22560
ds_read_b64_tr_b16 a[94:95], v61 offset:22816
ds_read_b64_tr_b16 a[96:97], v61 offset:24576
ds_read_b64_tr_b16 a[98:99], v61 offset:24832
ds_read_b64_tr_b16 a[100:101], v61 offset:24608
ds_read_b64_tr_b16 a[102:103], v61 offset:24864
ds_read_b64_tr_b16 a[104:105], v61 offset:26624
ds_read_b64_tr_b16 a[106:107], v61 offset:26880
ds_read_b64_tr_b16 a[108:109], v61 offset:26656
ds_read_b64_tr_b16 a[110:111], v61 offset:26912
ds_read_b64_tr_b16 a[112:113], v61 offset:28672
ds_read_b64_tr_b16 a[114:115], v61 offset:28928
ds_read_b64_tr_b16 a[116:117], v61 offset:28704
ds_read_b64_tr_b16 a[118:119], v61 offset:28960
ds_read_b64_tr_b16 a[120:121], v61 offset:30720
ds_read_b64_tr_b16 a[122:123], v61 offset:30976
ds_read_b64_tr_b16 a[124:125], v61 offset:30752
ds_read_b64_tr_b16 a[126:127], v61 offset:31008
ds_read_b64_tr_b16 a[128:129], v61 offset:32768
ds_read_b64_tr_b16 a[130:131], v61 offset:33024
ds_read_b64_tr_b16 a[132:133], v61 offset:32800
ds_read_b64_tr_b16 a[134:135], v61 offset:33056
ds_read_b64_tr_b16 a[136:137], v61 offset:34816
ds_read_b64_tr_b16 a[138:139], v61 offset:35072
ds_read_b64_tr_b16 a[140:141], v61 offset:34848
ds_read_b64_tr_b16 a[142:143], v61 offset:35104
ds_read_b64_tr_b16 a[144:145], v61 offset:36864
ds_read_b64_tr_b16 a[146:147], v61 offset:37120
ds_read_b64_tr_b16 a[148:149], v61 offset:36896
ds_read_b64_tr_b16 a[150:151], v61 offset:37152
ds_read_b64_tr_b16 a[152:153], v61 offset:38912
ds_read_b64_tr_b16 a[154:155], v61 offset:39168
ds_read_b64_tr_b16 a[156:157], v61 offset:38944
ds_read_b64_tr_b16 a[158:159], v61 offset:39200
s_waitcnt lgkmcnt(0)
s_add_u32 m0, s28, 20480
s_mov_b32 s26, 3145728
buffer_load_dwordx4 v56, s[12:15], s26 offen lds
s_add_u32 m0, s28, 21504
s_mov_b32 s26, 3276800
buffer_load_dwordx4 v56, s[12:15], s26 offen lds
s_add_u32 m0, s28, 22528
s_mov_b32 s26, 3407872
buffer_load_dwordx4 v56, s[12:15], s26 offen lds
s_add_u32 m0, s28, 23552
s_mov_b32 s26, 3538944
buffer_load_dwordx4 v56, s[12:15], s26 offen lds
s_add_u32 m0, s28, 24576
s_mov_b32 s26, 3670016
buffer_load_dwordx4 v56, s[12:15], s26 offen lds
s_add_u32 m0, s28, 25600
s_mov_b32 s26, 3801088
buffer_load_dwordx4 v56, s[12:15], s26 offen lds
s_add_u32 m0, s28, 26624
s_mov_b32 s26, 3932160
buffer_load_dwordx4 v56, s[12:15], s26 offen lds
s_add_u32 m0, s28, 27648
s_mov_b32 s26, 4063232
buffer_load_dwordx4 v56, s[12:15], s26 offen lds
s_add_u32 m0, s28, 28672
s_mov_b32 s26, 4194304
buffer_load_dwordx4 v56, s[12:15], s26 offen lds
s_add_u32 m0, s28, 29696
s_mov_b32 s26, 4325376
buffer_load_dwordx4 v56, s[12:15], s26 offen lds
s_add_u32 m0, s28, 30720
s_mov_b32 s26, 4456448
buffer_load_dwordx4 v56, s[12:15], s26 offen lds
s_add_u32 m0, s28, 31744
s_mov_b32 s26, 4587520
buffer_load_dwordx4 v56, s[12:15], s26 offen lds
s_add_u32 m0, s28, 32768
s_mov_b32 s26, 0
buffer_load_dwordx4 v56, s[20:23], s26 offen lds
s_add_u32 m0, s28, 33792
s_mov_b32 s26, 131072
buffer_load_dwordx4 v56, s[20:23], s26 offen lds
s_add_u32 m0, s28, 34816
s_mov_b32 s26, 262144
buffer_load_dwordx4 v56, s[20:23], s26 offen lds
s_add_u32 m0, s28, 35840
s_mov_b32 s26, 393216
buffer_load_dwordx4 v56, s[20:23], s26 offen lds
s_add_u32 m0, s28, 36864
s_mov_b32 s26, 524288
buffer_load_dwordx4 v56, s[20:23], s26 offen lds
s_add_u32 m0, s28, 37888
s_mov_b32 s26, 655360
buffer_load_dwordx4 v56, s[20:23], s26 offen lds
s_add_u32 m0, s28, 38912
s_mov_b32 s26, 786432
buffer_load_dwordx4 v56, s[20:23], s26 offen lds
s_add_u32 m0, s28, 39936
s_mov_b32 s26, 917504
buffer_load_dwordx4 v56, s[20:23], s26 offen lds
s_waitcnt vmcnt(20)
ds_read_b64_tr_b16 a[160:161], v61 offset:0
ds_read_b64_tr_b16 a[162:163], v61 offset:256
ds_read_b64_tr_b16 a[164:165], v61 offset:32
ds_read_b64_tr_b16 a[166:167], v61 offset:288
ds_read_b64_tr_b16 a[168:169], v61 offset:2048
ds_read_b64_tr_b16 a[170:171], v61 offset:2304
ds_read_b64_tr_b16 a[172:173], v61 offset:2080
ds_read_b64_tr_b16 a[174:175], v61 offset:2336
ds_read_b64_tr_b16 a[176:177], v61 offset:4096
ds_read_b64_tr_b16 a[178:179], v61 offset:4352
ds_read_b64_tr_b16 a[180:181], v61 offset:4128
ds_read_b64_tr_b16 a[182:183], v61 offset:4384
ds_read_b64_tr_b16 a[184:185], v61 offset:6144
ds_read_b64_tr_b16 a[186:187], v61 offset:6400
ds_read_b64_tr_b16 a[188:189], v61 offset:6176
ds_read_b64_tr_b16 a[190:191], v61 offset:6432
ds_read_b64_tr_b16 a[192:193], v61 offset:8192
ds_read_b64_tr_b16 a[194:195], v61 offset:8448
ds_read_b64_tr_b16 a[196:197], v61 offset:8224
ds_read_b64_tr_b16 a[198:199], v61 offset:8480
ds_read_b64_tr_b16 a[200:201], v61 offset:10240
ds_read_b64_tr_b16 a[202:203], v61 offset:10496
ds_read_b64_tr_b16 a[204:205], v61 offset:10272
ds_read_b64_tr_b16 a[206:207], v61 offset:10528
ds_read_b64_tr_b16 a[208:209], v61 offset:12288
ds_read_b64_tr_b16 a[210:211], v61 offset:12544
ds_read_b64_tr_b16 a[212:213], v61 offset:12320
ds_read_b64_tr_b16 a[214:215], v61 offset:12576
ds_read_b64_tr_b16 a[216:217], v61 offset:14336
ds_read_b64_tr_b16 a[218:219], v61 offset:14592
ds_read_b64_tr_b16 a[220:221], v61 offset:14368
ds_read_b64_tr_b16 a[222:223], v61 offset:14624
ds_read_b64_tr_b16 a[224:225], v61 offset:16384
ds_read_b64_tr_b16 a[226:227], v61 offset:16640
ds_read_b64_tr_b16 a[228:229], v61 offset:16416
ds_read_b64_tr_b16 a[230:231], v61 offset:16672
ds_read_b64_tr_b16 a[232:233], v61 offset:18432
ds_read_b64_tr_b16 a[234:235], v61 offset:18688
ds_read_b64_tr_b16 a[236:237], v61 offset:18464
ds_read_b64_tr_b16 a[238:239], v61 offset:18720
s_waitcnt lgkmcnt(0)
s_add_u32 m0, s28, 0
s_mov_b32 s26, 1048576
buffer_load_dwordx4 v56, s[20:23], s26 offen lds
s_add_u32 m0, s28, 1024
s_mov_b32 s26, 1179648
buffer_load_dwordx4 v56, s[20:23], s26 offen lds
s_add_u32 m0, s28, 2048
s_mov_b32 s26, 1310720
buffer_load_dwordx4 v56, s[20:23], s26 offen lds
s_add_u32 m0, s28, 3072
s_mov_b32 s26, 1441792
buffer_load_dwordx4 v56, s[20:23], s26 offen lds
s_add_u32 m0, s28, 4096
s_mov_b32 s26, 1572864
buffer_load_dwordx4 v56, s[20:23], s26 offen lds
s_add_u32 m0, s28, 5120
s_mov_b32 s26, 1703936
buffer_load_dwordx4 v56, s[20:23], s26 offen lds
s_add_u32 m0, s28, 6144
s_mov_b32 s26, 1835008
buffer_load_dwordx4 v56, s[20:23], s26 offen lds
s_add_u32 m0, s28, 7168
s_mov_b32 s26, 1966080
buffer_load_dwordx4 v56, s[20:23], s26 offen lds
s_add_u32 m0, s28, 8192
s_mov_b32 s26, 2097152
buffer_load_dwordx4 v56, s[20:23], s26 offen lds
s_add_u32 m0, s28, 9216
s_mov_b32 s26, 2228224
buffer_load_dwordx4 v56, s[20:23], s26 offen lds
s_add_u32 m0, s28, 10240
s_mov_b32 s26, 2359296
buffer_load_dwordx4 v56, s[20:23], s26 offen lds
s_add_u32 m0, s28, 11264
s_mov_b32 s26, 2490368
buffer_load_dwordx4 v56, s[20:23], s26 offen lds
s_add_u32 m0, s28, 12288
s_mov_b32 s26, 2621440
buffer_load_dwordx4 v56, s[20:23], s26 offen lds
s_add_u32 m0, s28, 13312
s_mov_b32 s26, 2752512
buffer_load_dwordx4 v56, s[20:23], s26 offen lds
s_add_u32 m0, s28, 14336
s_mov_b32 s26, 2883584
buffer_load_dwordx4 v56, s[20:23], s26 offen lds
s_add_u32 m0, s28, 15360
s_mov_b32 s26, 3014656
buffer_load_dwordx4 v56, s[20:23], s26 offen lds
s_add_u32 m0, s28, 16384
s_mov_b32 s26, 3145728
buffer_load_dwordx4 v56, s[20:23], s26 offen lds
s_add_u32 m0, s28, 17408
s_mov_b32 s26, 3276800
buffer_load_dwordx4 v56, s[20:23], s26 offen lds
s_add_u32 m0, s28, 18432
s_mov_b32 s26, 3407872
buffer_load_dwordx4 v56, s[20:23], s26 offen lds
s_add_u32 m0, s28, 19456
s_mov_b32 s26, 3538944
buffer_load_dwordx4 v56, s[20:23], s26 offen lds
s_waitcnt vmcnt(20)
ds_read_b64_tr_b16 a[240:241], v61 offset:20480
ds_read_b64_tr_b16 a[242:243], v61 offset:20736
ds_read_b64_tr_b16 a[244:245], v61 offset:20512
ds_read_b64_tr_b16 a[246:247], v61 offset:20768
ds_read_b64_tr_b16 a[248:249], v61 offset:22528
ds_read_b64_tr_b16 a[250:251], v61 offset:22784
ds_read_b64_tr_b16 a[252:253], v61 offset:22560
ds_read_b64_tr_b16 a[254:255], v61 offset:22816
ds_read_b64_tr_b16 v[80:81], v61 offset:24576
ds_read_b64_tr_b16 v[82:83], v61 offset:24832
ds_read_b64_tr_b16 v[84:85], v61 offset:24608
ds_read_b64_tr_b16 v[86:87], v61 offset:24864
ds_read_b64_tr_b16 v[88:89], v61 offset:26624
ds_read_b64_tr_b16 v[90:91], v61 offset:26880
ds_read_b64_tr_b16 v[92:93], v61 offset:26656
ds_read_b64_tr_b16 v[94:95], v61 offset:26912
ds_read_b64_tr_b16 v[96:97], v61 offset:28672
ds_read_b64_tr_b16 v[98:99], v61 offset:28928
ds_read_b64_tr_b16 v[100:101], v61 offset:28704
ds_read_b64_tr_b16 v[102:103], v61 offset:28960
ds_read_b64_tr_b16 v[104:105], v61 offset:30720
ds_read_b64_tr_b16 v[106:107], v61 offset:30976
ds_read_b64_tr_b16 v[108:109], v61 offset:30752
ds_read_b64_tr_b16 v[110:111], v61 offset:31008
ds_read_b64_tr_b16 v[112:113], v61 offset:32768
ds_read_b64_tr_b16 v[114:115], v61 offset:33024
ds_read_b64_tr_b16 v[116:117], v61 offset:32800
ds_read_b64_tr_b16 v[118:119], v61 offset:33056
ds_read_b64_tr_b16 v[120:121], v61 offset:34816
ds_read_b64_tr_b16 v[122:123], v61 offset:35072
ds_read_b64_tr_b16 v[124:125], v61 offset:34848
ds_read_b64_tr_b16 v[126:127], v61 offset:35104
ds_read_b64_tr_b16 v[128:129], v61 offset:36864
ds_read_b64_tr_b16 v[130:131], v61 offset:37120
ds_read_b64_tr_b16 v[132:133], v61 offset:36896
ds_read_b64_tr_b16 v[134:135], v61 offset:37152
ds_read_b64_tr_b16 v[136:137], v61 offset:38912
ds_read_b64_tr_b16 v[138:139], v61 offset:39168
ds_read_b64_tr_b16 v[140:141], v61 offset:38944
ds_read_b64_tr_b16 v[142:143], v61 offset:39200
s_waitcnt lgkmcnt(0)
s_add_u32 m0, s28, 20480
s_mov_b32 s26, 3670016
buffer_load_dwordx4 v56, s[20:23], s26 offen lds
s_add_u32 m0, s28, 21504
s_mov_b32 s26, 3801088
buffer_load_dwordx4 v56, s[20:23], s26 offen lds
s_add_u32 m0, s28, 22528
s_mov_b32 s26, 3932160
buffer_load_dwordx4 v56, s[20:23], s26 offen lds
s_add_u32 m0, s28, 23552
s_mov_b32 s26, 4063232
buffer_load_dwordx4 v56, s[20:23], s26 offen lds
s_add_u32 m0, s28, 24576
s_mov_b32 s26, 4194304
buffer_load_dwordx4 v56, s[20:23], s26 offen lds
s_add_u32 m0, s28, 25600
s_mov_b32 s26, 4325376
buffer_load_dwordx4 v56, s[20:23], s26 offen lds
s_add_u32 m0, s28, 26624
s_mov_b32 s26, 4456448
buffer_load_dwordx4 v56, s[20:23], s26 offen lds
s_add_u32 m0, s28, 27648
s_mov_b32 s26, 4587520
buffer_load_dwordx4 v56, s[20:23], s26 offen lds
s_waitcnt vmcnt(8)
ds_read_b64_tr_b16 v[144:145], v61 offset:0
ds_read_b64_tr_b16 v[146:147], v61 offset:256
ds_read_b64_tr_b16 v[148:149], v61 offset:32
ds_read_b64_tr_b16 v[150:151], v61 offset:288
ds_read_b64_tr_b16 v[152:153], v61 offset:2048
ds_read_b64_tr_b16 v[154:155], v61 offset:2304
ds_read_b64_tr_b16 v[156:157], v61 offset:2080
ds_read_b64_tr_b16 v[158:159], v61 offset:2336
ds_read_b64_tr_b16 v[160:161], v61 offset:4096
ds_read_b64_tr_b16 v[162:163], v61 offset:4352
ds_read_b64_tr_b16 v[164:165], v61 offset:4128
ds_read_b64_tr_b16 v[166:167], v61 offset:4384
ds_read_b64_tr_b16 v[168:169], v61 offset:6144
ds_read_b64_tr_b16 v[170:171], v61 offset:6400
ds_read_b64_tr_b16 v[172:173], v61 offset:6176
ds_read_b64_tr_b16 v[174:175], v61 offset:6432
ds_read_b64_tr_b16 v[176:177], v61 offset:8192
ds_read_b64_tr_b16 v[178:179], v61 offset:8448
ds_read_b64_tr_b16 v[180:181], v61 offset:8224
ds_read_b64_tr_b16 v[182:183], v61 offset:8480
ds_read_b64_tr_b16 v[184:185], v61 offset:10240
ds_read_b64_tr_b16 v[186:187], v61 offset:10496
ds_read_b64_tr_b16 v[188:189], v61 offset:10272
ds_read_b64_tr_b16 v[190:191], v61 offset:10528
ds_read_b64_tr_b16 v[192:193], v61 offset:12288
ds_read_b64_tr_b16 v[194:195], v61 offset:12544
ds_read_b64_tr_b16 v[196:197], v61 offset:12320
ds_read_b64_tr_b16 v[198:199], v61 offset:12576
ds_read_b64_tr_b16 v[200:201], v61 offset:14336
ds_read_b64_tr_b16 v[202:203], v61 offset:14592
ds_read_b64_tr_b16 v[204:205], v61 offset:14368
ds_read_b64_tr_b16 v[206:207], v61 offset:14624
ds_read_b64_tr_b16 v[208:209], v61 offset:16384
ds_read_b64_tr_b16 v[210:211], v61 offset:16640
ds_read_b64_tr_b16 v[212:213], v61 offset:16416
ds_read_b64_tr_b16 v[214:215], v61 offset:16672
ds_read_b64_tr_b16 v[216:217], v61 offset:18432
ds_read_b64_tr_b16 v[218:219], v61 offset:18688
ds_read_b64_tr_b16 v[220:221], v61 offset:18464
ds_read_b64_tr_b16 v[222:223], v61 offset:18720
s_waitcnt lgkmcnt(0)
s_waitcnt vmcnt(0)
ds_read_b64_tr_b16 v[224:225], v61 offset:20480
ds_read_b64_tr_b16 v[226:227], v61 offset:20736
ds_read_b64_tr_b16 v[228:229], v61 offset:20512
ds_read_b64_tr_b16 v[230:231], v61 offset:20768
ds_read_b64_tr_b16 v[232:233], v61 offset:22528
ds_read_b64_tr_b16 v[234:235], v61 offset:22784
ds_read_b64_tr_b16 v[236:237], v61 offset:22560
ds_read_b64_tr_b16 v[238:239], v61 offset:22816
ds_read_b64_tr_b16 v[240:241], v61 offset:24576
ds_read_b64_tr_b16 v[242:243], v61 offset:24832
ds_read_b64_tr_b16 v[244:245], v61 offset:24608
ds_read_b64_tr_b16 v[246:247], v61 offset:24864
ds_read_b64_tr_b16 v[248:249], v61 offset:26624
ds_read_b64_tr_b16 v[250:251], v61 offset:26880
ds_read_b64_tr_b16 v[252:253], v61 offset:26656
ds_read_b64_tr_b16 v[254:255], v61 offset:26912
s_waitcnt lgkmcnt(0)
v_lshrrev_b32 v2, 3, v0
s_lshl_b32 s26, s24, 3
v_add_u32 v2, s26, v2
v_and_b32 v3, 3, v0
v_xor_b32 v3, v3, v2
v_and_b32 v3, 15, v3
v_lshlrev_b32 v3, 4, v3
v_mul_u32_u24 v2, 1152, v2
v_and_b32 v4, 7, v0
v_lshl_add_u32 v2, v4, 4, v2
v_lshl_add_u32 v3, v4, 8, v3
s_lshr_b32 s26, s24, 1
s_mul_i32 s26, s26, 18432
v_add_u32 v3, s26, v3
v_and_b32 v50, 15, v0
v_lshrrev_b32 v51, 4, v0
v_lshlrev_b32 v51, 2, v51
v_sub_u32 v50, v50, v51
v_cmp_le_i32 s[44:45], 0, v50
v_cmp_le_i32 s[46:47], 1, v50
v_cmp_le_i32 s[48:49], 2, v50
v_cmp_le_i32 s[50:51], 3, v50
v_min_u32 v4, 2, v0
v_lshlrev_b32 v4, 9, v4
v_mov_b32 v5, 0
s_mov_b32 s30, 0x3e0293ee
s_mov_b32 s36, 0
s_barrier
v_bfe_u32 v50, v0, 2, 2
v_bfe_u32 v51, v0, 4, 1
v_lshl_add_u32 v50, v50, 1, v51
v_and_b32 v51, 1, v0
v_lshl_add_u32 v50, v50, 1, v51
v_lshlrev_b32 v50, 4, v50
v_lshrrev_b32 v51, 5, v0
v_lshl_add_u32 v0, v51, 8, v50
P3_layer:
s_mov_b32 s37, s53
s_mov_b32 s38, 36864
s_mov_b32 s39, 61440
P3_loop:
s_cmp_ge_u32 s37, 64
s_cbranch_scc1 P3_att
s_lshl_b32 s40, s36, 6
s_add_u32 s40, s40, s37
s_and_b32 s41, s37, 3
s_mul_i32 s41, s41, 384
s_add_u32 s41, s41, s40
s_lshl_b32 s41, s41, 2
s_add_u32 s41, s41, 49152
s_mov_b32 s29, 0
Lwf9:
buffer_load_dword v50, v4, s[4:7], s41 offen sc1
s_add_u32 s29, s29, 1
s_waitcnt vmcnt(0)
v_cmp_eq_u32 vcc, 0, v50
s_cbranch_vccz Lwd10
s_sleep 2
s_cmp_lt_u32 s29, s25
s_cbranch_scc1 Lwf9
s_mov_b32 s25, 0
Lwd10:
s_mul_i32 s41, s40, 36864
s_add_u32 s41, s41, 16777216
buffer_load_dwordx4 v[8:11], v2, s[4:7], s41 offen offset:0 sc1
buffer_load_dwordx4 v[12:15], v2, s[4:7], s41 offen offset:128 sc1
buffer_load_dwordx4 v[16:19], v2, s[4:7], s41 offen offset:256 sc1
buffer_load_dwordx4 v[20:23], v2, s[4:7], s41 offen offset:384 sc1
buffer_load_dwordx4 v[24:27], v2, s[4:7], s41 offen offset:512 sc1
buffer_load_dwordx4 v[28:31], v2, s[4:7], s41 offen offset:640 sc1
buffer_load_dwordx4 v[32:35], v2, s[4:7], s41 offen offset:768 sc1
buffer_load_dwordx4 v[36:39], v2, s[4:7], s41 offen offset:896 sc1
buffer_load_dwordx4 v[40:43], v2, s[4:7], s41 offen offset:1024 sc1
s_mov_b32 s26, 0x3f803f80
v_mov_b32 v44, 0
v_mov_b32 v45, 0
s_waitcnt vmcnt(8)
v_dot2_f32_bf16 v44, v8, s26, v44
v_dot2_f32_bf16 v45, v8, v8, v45
v_dot2_f32_bf16 v44, v9, s26, v44
v_dot2_f32_bf16 v45, v9, v9, v45
v_dot2_f32_bf16 v44, v10, s26, v44
v_dot2_f32_bf16 v45, v10, v10, v45
v_dot2_f32_bf16 v44, v11, s26, v44
v_dot2_f32_bf16 v45, v11, v11, v45
s_waitcnt vmcnt(7)
v_dot2_f32_bf16 v44, v12, s26, v44
v_dot2_f32_bf16 v45, v12, v12, v45
v_dot2_f32_bf16 v44, v13, s26, v44
v_dot2_f32_bf16 v45, v13, v13, v45
v_dot2_f32_bf16 v44, v14, s26, v44
v_dot2_f32_bf16 v45, v14, v14, v45
v_dot2_f32_bf16 v44, v15, s26, v44
v_dot2_f32_bf16 v45, v15, v15, v45
s_waitcnt vmcnt(6)
v_dot2_f32_bf16 v44, v16, s26, v44
v_dot2_f32_bf16 v45, v16, v16, v45
v_dot2_f32_bf16 v44, v17, s26, v44
v_dot2_f32_bf16 v45, v17, v17, v45
v_dot2_f32_bf16 v44, v18, s26, v44
v_dot2_f32_bf16 v45, v18, v18, v45
v_dot2_f32_bf16 v44, v19, s26, v44
v_dot2_f32_bf16 v45, v19, v19, v45
s_waitcnt vmcnt(5)
v_dot2_f32_bf16 v44, v20, s26, v44
v_dot2_f32_bf16 v45, v20, v20, v45
v_dot2_f32_bf16 v44, v21, s26, v44
v_dot2_f32_bf16 v45, v21, v21, v45
v_dot2_f32_bf16 v44, v22, s26, v44
v_dot2_f32_bf16 v45, v22, v22, v45
v_dot2_f32_bf16 v44, v23, s26, v44
v_dot2_f32_bf16 v45, v23, v23, v45
s_waitcnt vmcnt(4)
v_dot2_f32_bf16 v44, v24, s26, v44
v_dot2_f32_bf16 v45, v24, v24, v45
v_dot2_f32_bf16 v44, v25, s26, v44
v_dot2_f32_bf16 v45, v25, v25, v45
v_dot2_f32_bf16 v44, v26, s26, v44
v_dot2_f32_bf16 v45, v26, v26, v45
v_dot2_f32_bf16 v44, v27, s26, v44
v_dot2_f32_bf16 v45, v27, v27, v45
s_waitcnt vmcnt(3)
v_dot2_f32_bf16 v44, v28, s26, v44
v_dot2_f32_bf16 v45, v28, v28, v45
v_dot2_f32_bf16 v44, v29, s26, v44
v_dot2_f32_bf16 v45, v29, v29, v45
v_dot2_f32_bf16 v44, v30, s26, v44
v_dot2_f32_bf16 v45, v30, v30, v45
v_dot2_f32_bf16 v44, v31, s26, v44
v_dot2_f32_bf16 v45, v31, v31, v45
s_waitcnt vmcnt(2)
v_dot2_f32_bf16 v44, v32, s26, v44
v_dot2_f32_bf16 v45, v32, v32, v45
v_dot2_f32_bf16 v44, v33, s26, v44
v_dot2_f32_bf16 v45, v33, v33, v45
v_dot2_f32_bf16 v44, v34, s26, v44
v_dot2_f32_bf16 v45, v34, v34, v45
v_dot2_f32_bf16 v44, v35, s26, v44
v_dot2_f32_bf16 v45, v35, v35, v45
s_waitcnt vmcnt(1)
v_dot2_f32_bf16 v44, v36, s26, v44
v_dot2_f32_bf16 v45, v36, v36, v45
v_dot2_f32_bf16 v44, v37, s26, v44
v_dot2_f32_bf16 v45, v37, v37, v45
v_dot2_f32_bf16 v44, v38, s26, v44
v_dot2_f32_bf16 v45, v38, v38, v45
v_dot2_f32_bf16 v44, v39, s26, v44
v_dot2_f32_bf16 v45, v39, v39, v45
s_waitcnt vmcnt(0)
v_dot2_f32_bf16 v44, v40, s26, v44
v_dot2_f32_bf16 v45, v40, v40, v45
v_dot2_f32_bf16 v44, v41, s26, v44
v_dot2_f32_bf16 v45, v41, v41, v45
v_dot2_f32_bf16 v44, v42, s26, v44
v_dot2_f32_bf16 v45, v42, v42, v45
v_dot2_f32_bf16 v44, v43, s26, v44
v_dot2_f32_bf16 v45, v43, v43, v45
s_nop 1
v_add_f32_dpp v44, v44, v44 quad_perm:[1,0,3,2] row_mask:0xf bank_mask:0xf
v_add_f32_dpp v45, v45, v45 quad_perm:[1,0,3,2] row_mask:0xf bank_mask:0xf
s_nop 0
v_add_f32_dpp v44, v44, v44 quad_perm:[2,3,0,1] row_mask:0xf bank_mask:0xf
v_add_f32_dpp v45, v45, v45 quad_perm:[2,3,0,1] row_mask:0xf bank_mask:0xf
s_nop 0
v_add_f32_dpp v44, v44, v44 row_half_mirror row_mask:0xf bank_mask:0xf
v_add_f32_dpp v45, v45, v45 row_half_mirror row_mask:0xf bank_mask:0xf
v_mul_f32 v44, 0x3ae38e39, v44
v_mul_f32 v45, 0x3ae38e39, v45
v_fma_f32 v45, -v44, v44, v45
v_max_f32 v45, 0, v45
v_cvt_pk_bf16_f32 v46, v44, v45
v_lshlrev_b32 v44, 16, v46
v_and_b32 v45, 0xffff0000, v46
v_add_f32 v45, 0x3727c5ac, v45
v_cvt_pk_bf16_f32 v45, v45, v45
v_lshlrev_b32 v45, 16, v45
v_sqrt_f32 v45, v45
s_nop 0
v_cvt_pk_bf16_f32 v45, v45, v45
v_lshlrev_b32 v45, 16, v45
v_rcp_f32 v46, v45
s_nop 0
v_mul_f32 v44, v44, v46
v_sub_f32 v44, 0, v44
v_lshlrev_b32 v48, 16, v8
v_and_b32 v49, 0xffff0000, v8
v_pk_fma_f32 v[48:49], v[48:49], v[46:47], v[44:45] op_sel_hi:[1,0,0]
v_cvt_pk_bf16_f32 v8, v48, v49
v_lshlrev_b32 v50, 16, v9
v_and_b32 v51, 0xffff0000, v9
v_pk_fma_f32 v[50:51], v[50:51], v[46:47], v[44:45] op_sel_hi:[1,0,0]
v_cvt_pk_bf16_f32 v9, v50, v51
v_lshlrev_b32 v48, 16, v10
v_and_b32 v49, 0xffff0000, v10
v_pk_fma_f32 v[48:49], v[48:49], v[46:47], v[44:45] op_sel_hi:[1,0,0]
v_cvt_pk_bf16_f32 v10, v48, v49
v_lshlrev_b32 v50, 16, v11
v_and_b32 v51, 0xffff0000, v11
v_pk_fma_f32 v[50:51], v[50:51], v[46:47], v[44:45] op_sel_hi:[1,0,0]
v_cvt_pk_bf16_f32 v11, v50, v51
v_lshlrev_b32 v48, 16, v12
v_and_b32 v49, 0xffff0000, v12
v_pk_fma_f32 v[48:49], v[48:49], v[46:47], v[44:45] op_sel_hi:[1,0,0]
v_cvt_pk_bf16_f32 v12, v48, v49
v_lshlrev_b32 v50, 16, v13
v_and_b32 v51, 0xffff0000, v13
v_pk_fma_f32 v[50:51], v[50:51], v[46:47], v[44:45] op_sel_hi:[1,0,0]
v_cvt_pk_bf16_f32 v13, v50, v51
v_lshlrev_b32 v48, 16, v14
v_and_b32 v49, 0xffff0000, v14
v_pk_fma_f32 v[48:49], v[48:49], v[46:47], v[44:45] op_sel_hi:[1,0,0]
v_cvt_pk_bf16_f32 v14, v48, v49
v_lshlrev_b32 v50, 16, v15
v_and_b32 v51, 0xffff0000, v15
v_pk_fma_f32 v[50:51], v[50:51], v[46:47], v[44:45] op_sel_hi:[1,0,0]
v_cvt_pk_bf16_f32 v15, v50, v51
v_lshlrev_b32 v48, 16, v16
v_and_b32 v49, 0xffff0000, v16
v_pk_fma_f32 v[48:49], v[48:49], v[46:47], v[44:45] op_sel_hi:[1,0,0]
v_cvt_pk_bf16_f32 v16, v48, v49
v_lshlrev_b32 v50, 16, v17
v_and_b32 v51, 0xffff0000, v17
v_pk_fma_f32 v[50:51], v[50:51], v[46:47], v[44:45] op_sel_hi:[1,0,0]
v_cvt_pk_bf16_f32 v17, v50, v51
v_lshlrev_b32 v48, 16, v18
v_and_b32 v49, 0xffff0000, v18
v_pk_fma_f32 v[48:49], v[48:49], v[46:47], v[44:45] op_sel_hi:[1,0,0]
v_cvt_pk_bf16_f32 v18, v48, v49
v_lshlrev_b32 v50, 16, v19
v_and_b32 v51, 0xffff0000, v19
v_pk_fma_f32 v[50:51], v[50:51], v[46:47], v[44:45] op_sel_hi:[1,0,0]
v_cvt_pk_bf16_f32 v19, v50, v51
v_lshlrev_b32 v48, 16, v20
v_and_b32 v49, 0xffff0000, v20
v_pk_fma_f32 v[48:49], v[48:49], v[46:47], v[44:45] op_sel_hi:[1,0,0]
v_cvt_pk_bf16_f32 v20, v48, v49
v_lshlrev_b32 v50, 16, v21
v_and_b32 v51, 0xffff0000, v21
v_pk_fma_f32 v[50:51], v[50:51], v[46:47], v[44:45] op_sel_hi:[1,0,0]
v_cvt_pk_bf16_f32 v21, v50, v51
v_lshlrev_b32 v48, 16, v22
v_and_b32 v49, 0xffff0000, v22
v_pk_fma_f32 v[48:49], v[48:49], v[46:47], v[44:45] op_sel_hi:[1,0,0]
v_cvt_pk_bf16_f32 v22, v48, v49
v_lshlrev_b32 v50, 16, v23
v_and_b32 v51, 0xffff0000, v23
v_pk_fma_f32 v[50:51], v[50:51], v[46:47], v[44:45] op_sel_hi:[1,0,0]
v_cvt_pk_bf16_f32 v23, v50, v51
v_lshlrev_b32 v48, 16, v24
v_and_b32 v49, 0xffff0000, v24
v_pk_fma_f32 v[48:49], v[48:49], v[46:47], v[44:45] op_sel_hi:[1,0,0]
v_cvt_pk_bf16_f32 v24, v48, v49
v_lshlrev_b32 v50, 16, v25
v_and_b32 v51, 0xffff0000, v25
v_pk_fma_f32 v[50:51], v[50:51], v[46:47], v[44:45] op_sel_hi:[1,0,0]
v_cvt_pk_bf16_f32 v25, v50, v51
v_lshlrev_b32 v48, 16, v26
v_and_b32 v49, 0xffff0000, v26
v_pk_fma_f32 v[48:49], v[48:49], v[46:47], v[44:45] op_sel_hi:[1,0,0]
v_cvt_pk_bf16_f32 v26, v48, v49
v_lshlrev_b32 v50, 16, v27
v_and_b32 v51, 0xffff0000, v27
v_pk_fma_f32 v[50:51], v[50:51], v[46:47], v[44:45] op_sel_hi:[1,0,0]
v_cvt_pk_bf16_f32 v27, v50, v51
v_lshlrev_b32 v48, 16, v28
v_and_b32 v49, 0xffff0000, v28
v_pk_fma_f32 v[48:49], v[48:49], v[46:47], v[44:45] op_sel_hi:[1,0,0]
v_cvt_pk_bf16_f32 v28, v48, v49
v_lshlrev_b32 v50, 16, v29
v_and_b32 v51, 0xffff0000, v29
v_pk_fma_f32 v[50:51], v[50:51], v[46:47], v[44:45] op_sel_hi:[1,0,0]
v_cvt_pk_bf16_f32 v29, v50, v51
v_lshlrev_b32 v48, 16, v30
v_and_b32 v49, 0xffff0000, v30
v_pk_fma_f32 v[48:49], v[48:49], v[46:47], v[44:45] op_sel_hi:[1,0,0]
v_cvt_pk_bf16_f32 v30, v48, v49
v_lshlrev_b32 v50, 16, v31
v_and_b32 v51, 0xffff0000, v31
v_pk_fma_f32 v[50:51], v[50:51], v[46:47], v[44:45] op_sel_hi:[1,0,0]
v_cvt_pk_bf16_f32 v31, v50, v51
v_lshlrev_b32 v48, 16, v32
v_and_b32 v49, 0xffff0000, v32
v_pk_fma_f32 v[48:49], v[48:49], v[46:47], v[44:45] op_sel_hi:[1,0,0]
v_cvt_pk_bf16_f32 v32, v48, v49
v_lshlrev_b32 v50, 16, v33
v_and_b32 v51, 0xffff0000, v33
v_pk_fma_f32 v[50:51], v[50:51], v[46:47], v[44:45] op_sel_hi:[1,0,0]
v_cvt_pk_bf16_f32 v33, v50, v51
v_lshlrev_b32 v48, 16, v34
v_and_b32 v49, 0xffff0000, v34
v_pk_fma_f32 v[48:49], v[48:49], v[46:47], v[44:45] op_sel_hi:[1,0,0]
v_cvt_pk_bf16_f32 v34, v48, v49
v_lshlrev_b32 v50, 16, v35
v_and_b32 v51, 0xffff0000, v35
v_pk_fma_f32 v[50:51], v[50:51], v[46:47], v[44:45] op_sel_hi:[1,0,0]
v_cvt_pk_bf16_f32 v35, v50, v51
v_lshlrev_b32 v48, 16, v36
v_and_b32 v49, 0xffff0000, v36
v_pk_fma_f32 v[48:49], v[48:49], v[46:47], v[44:45] op_sel_hi:[1,0,0]
v_cvt_pk_bf16_f32 v36, v48, v49
v_lshlrev_b32 v50, 16, v37
v_and_b32 v51, 0xffff0000, v37
v_pk_fma_f32 v[50:51], v[50:51], v[46:47], v[44:45] op_sel_hi:[1,0,0]
v_cvt_pk_bf16_f32 v37, v50, v51
v_lshlrev_b32 v48, 16, v38
v_and_b32 v49, 0xffff0000, v38
v_pk_fma_f32 v[48:49], v[48:49], v[46:47], v[44:45] op_sel_hi:[1,0,0]
v_cvt_pk_bf16_f32 v38, v48, v49
v_lshlrev_b32 v50, 16, v39
v_and_b32 v51, 0xffff0000, v39
v_pk_fma_f32 v[50:51], v[50:51], v[46:47], v[44:45] op_sel_hi:[1,0,0]
v_cvt_pk_bf16_f32 v39, v50, v51
v_lshlrev_b32 v48, 16, v40
v_and_b32 v49, 0xffff0000, v40
v_pk_fma_f32 v[48:49], v[48:49], v[46:47], v[44:45] op_sel_hi:[1,0,0]
v_cvt_pk_bf16_f32 v40, v48, v49
v_lshlrev_b32 v50, 16, v41
v_and_b32 v51, 0xffff0000, v41
v_pk_fma_f32 v[50:51], v[50:51], v[46:47], v[44:45] op_sel_hi:[1,0,0]
v_cvt_pk_bf16_f32 v41, v50, v51
v_lshlrev_b32 v48, 16, v42
v_and_b32 v49, 0xffff0000, v42
v_pk_fma_f32 v[48:49], v[48:49], v[46:47], v[44:45] op_sel_hi:[1,0,0]
v_cvt_pk_bf16_f32 v42, v48, v49
v_lshlrev_b32 v50, 16, v43
v_and_b32 v51, 0xffff0000, v43
v_pk_fma_f32 v[50:51], v[50:51], v[46:47], v[44:45] op_sel_hi:[1,0,0]
v_cvt_pk_bf16_f32 v43, v50, v51
s_barrier
ds_write_b128 v3, v[8:11] offset:0
ds_write_b128 v3, v[12:15] offset:2048
ds_write_b128 v3, v[16:19] offset:4096
ds_write_b128 v3, v[20:23] offset:6144
ds_write_b128 v3, v[24:27] offset:8192
ds_write_b128 v3, v[28:31] offset:10240
ds_write_b128 v3, v[32:35] offset:12288
ds_write_b128 v3, v[36:39] offset:14336
ds_write_b128 v3, v[40:43] offset:16384
s_waitcnt lgkmcnt(0)
s_barrier
ds_read_b128 v[60:63], v7 offset:0
ds_read_b128 v[64:67], v7 offset:18432
ds_read_b128 v[68:71], v7 offset:1024
ds_read_b128 v[72:75], v7 offset:19456
s_waitcnt lgkmcnt(2)
v_mfma_f32_16x16x32_bf16 v[8:11], a[0:3], v[60:63], 0
v_mfma_f32_16x16x32_bf16 v[24:27], v[60:63], a[144:147], 0
v_mfma_f32_16x16x32_bf16 v[12:15], a[4:7], v[60:63], 0
v_mfma_f32_16x16x32_bf16 v[32:35], v[60:63], a[148:151], 0
v_mfma_f32_16x16x32_bf16 v[16:19], a[0:3], v[64:67], 0
v_mfma_f32_16x16x32_bf16 v[28:31], v[64:67], a[144:147], 0
v_mfma_f32_16x16x32_bf16 v[20:23], a[4:7], v[64:67], 0
v_mfma_f32_16x16x32_bf16 v[36:39], v[64:67], a[148:151], 0
ds_read_b128 v[60:63], v7 offset:2048
ds_read_b128 v[64:67], v7 offset:20480
s_waitcnt lgkmcnt(2)
v_mfma_f32_16x16x32_bf16 v[8:11], a[8:11], v[68:71], v[8:11]
v_mfma_f32_16x16x32_bf16 v[24:27], v[68:71], a[152:155], v[24:27]
v_mfma_f32_16x16x32_bf16 v[12:15], a[12:15], v[68:71], v[12:15]
v_mfma_f32_16x16x32_bf16 v[32:35], v[68:71], a[156:159], v[32:35]
v_mfma_f32_16x16x32_bf16 v[16:19], a[8:11], v[72:75], v[16:19]
v_mfma_f32_16x16x32_bf16 v[28:31], v[72:75], a[152:155], v[28:31]
v_mfma_f32_16x16x32_bf16 v[20:23], a[12:15], v[72:75], v[20:23]
v_mfma_f32_16x16x32_bf16 v[36:39], v[72:75], a[156:159], v[36:39]
ds_read_b128 v[68:71], v7 offset:3072
ds_read_b128 v[72:75], v7 offset:21504
s_waitcnt lgkmcnt(2)
v_mfma_f32_16x16x32_bf16 v[8:11], a[16:19], v[60:63], v[8:11]
v_mfma_f32_16x16x32_bf16 v[24:27], v[60:63], a[160:163], v[24:27]
v_mfma_f32_16x16x32_bf16 v[12:15], a[20:23], v[60:63], v[12:15]
v_mfma_f32_16x16x32_bf16 v[32:35], v[60:63], a[164:167], v[32:35]
v_mfma_f32_16x16x32_bf16 v[16:19], a[16:19], v[64:67], v[16:19]
v_mfma_f32_16x16x32_bf16 v[28:31], v[64:67], a[160:163], v[28:31]
v_mfma_f32_16x16x32_bf16 v[20:23], a[20:23], v[64:67], v[20:23]
v_mfma_f32_16x16x32_bf16 v[36:39], v[64:67], a[164:167], v[36:39]
ds_read_b128 v[60:63], v7 offset:4096
ds_read_b128 v[64:67], v7 offset:22528
s_waitcnt lgkmcnt(2)
v_mfma_f32_16x16x32_bf16 v[8:11], a[24:27], v[68:71], v[8:11]
v_mfma_f32_16x16x32_bf16 v[24:27], v[68:71], a[168:171], v[24:27]
v_mfma_f32_16x16x32_bf16 v[12:15], a[28:31], v[68:71], v[12:15]
v_mfma_f32_16x16x32_bf16 v[32:35], v[68:71], a[172:175], v[32:35]
v_mfma_f32_16x16x32_bf16 v[16:19], a[24:27], v[72:75], v[16:19]
v_mfma_f32_16x16x32_bf16 v[28:31], v[72:75], a[168:171], v[28:31]
v_mfma_f32_16x16x32_bf16 v[20:23], a[28:31], v[72:75], v[20:23]
v_mfma_f32_16x16x32_bf16 v[36:39], v[72:75], a[172:175], v[36:39]
ds_read_b128 v[68:71], v7 offset:5120
ds_read_b128 v[72:75], v7 offset:23552
s_waitcnt lgkmcnt(2)
v_mfma_f32_16x16x32_bf16 v[8:11], a[32:35], v[60:63], v[8:11]
v_mfma_f32_16x16x32_bf16 v[24:27], v[60:63], a[176:179], v[24:27]
v_mfma_f32_16x16x32_bf16 v[12:15], a[36:39], v[60:63], v[12:15]
v_mfma_f32_16x16x32_bf16 v[32:35], v[60:63], a[180:183], v[32:35]
v_mfma_f32_16x16x32_bf16 v[16:19], a[32:35], v[64:67], v[16:19]
v_mfma_f32_16x16x32_bf16 v[28:31], v[64:67], a[176:179], v[28:31]
v_mfma_f32_16x16x32_bf16 v[20:23], a[36:39], v[64:67], v[20:23]
v_mfma_f32_16x16x32_bf16 v[36:39], v[64:67], a[180:183], v[36:39]
ds_read_b128 v[60:63], v7 offset:6144
ds_read_b128 v[64:67], v7 offset:24576
s_waitcnt lgkmcnt(2)
v_mfma_f32_16x16x32_bf16 v[8:11], a[40:43], v[68:71], v[8:11]
v_mfma_f32_16x16x32_bf16 v[24:27], v[68:71], a[184:187], v[24:27]
v_mfma_f32_16x16x32_bf16 v[12:15], a[44:47], v[68:71], v[12:15]
v_mfma_f32_16x16x32_bf16 v[32:35], v[68:71], a[188:191], v[32:35]
v_mfma_f32_16x16x32_bf16 v[16:19], a[40:43], v[72:75], v[16:19]
v_mfma_f32_16x16x32_bf16 v[28:31], v[72:75], a[184:187], v[28:31]
v_mfma_f32_16x16x32_bf16 v[20:23], a[44:47], v[72:75], v[20:23]
v_mfma_f32_16x16x32_bf16 v[36:39], v[72:75], a[188:191], v[36:39]
ds_read_b128 v[68:71], v7 offset:7168
ds_read_b128 v[72:75], v7 offset:25600
s_waitcnt lgkmcnt(2)
v_mfma_f32_16x16x32_bf16 v[8:11], a[48:51], v[60:63], v[8:11]
v_mfma_f32_16x16x32_bf16 v[24:27], v[60:63], a[192:195], v[24:27]
v_mfma_f32_16x16x32_bf16 v[12:15], a[52:55], v[60:63], v[12:15]
v_mfma_f32_16x16x32_bf16 v[32:35], v[60:63], a[196:199], v[32:35]
v_mfma_f32_16x16x32_bf16 v[16:19], a[48:51], v[64:67], v[16:19]
v_mfma_f32_16x16x32_bf16 v[28:31], v[64:67], a[192:195], v[28:31]
v_mfma_f32_16x16x32_bf16 v[20:23], a[52:55], v[64:67], v[20:23]
v_mfma_f32_16x16x32_bf16 v[36:39], v[64:67], a[196:199], v[36:39]
ds_read_b128 v[60:63], v7 offset:8192
ds_read_b128 v[64:67], v7 offset:26624
s_waitcnt lgkmcnt(2)
v_mfma_f32_16x16x32_bf16 v[8:11], a[56:59], v[68:71], v[8:11]
v_mfma_f32_16x16x32_bf16 v[24:27], v[68:71], a[200:203], v[24:27]
v_mfma_f32_16x16x32_bf16 v[12:15], a[60:63], v[68:71], v[12:15]
v_mfma_f32_16x16x32_bf16 v[32:35], v[68:71], a[204:207], v[32:35]
v_mfma_f32_16x16x32_bf16 v[16:19], a[56:59], v[72:75], v[16:19]
v_mfma_f32_16x16x32_bf16 v[28:31], v[72:75], a[200:203], v[28:31]
v_mfma_f32_16x16x32_bf16 v[20:23], a[60:63], v[72:75], v[20:23]
v_mfma_f32_16x16x32_bf16 v[36:39], v[72:75], a[204:207], v[36:39]
ds_read_b128 v[68:71], v7 offset:9216
ds_read_b128 v[72:75], v7 offset:27648
s_waitcnt lgkmcnt(2)
v_mfma_f32_16x16x32_bf16 v[8:11], a[64:67], v[60:63], v[8:11]
v_mfma_f32_16x16x32_bf16 v[24:27], v[60:63], a[208:211], v[24:27]
v_mfma_f32_16x16x32_bf16 v[12:15], a[68:71], v[60:63], v[12:15]
v_mfma_f32_16x16x32_bf16 v[32:35], v[60:63], a[212:215], v[32:35]
v_mfma_f32_16x16x32_bf16 v[16:19], a[64:67], v[64:67], v[16:19]
v_mfma_f32_16x16x32_bf16 v[28:31], v[64:67], a[208:211], v[28:31]
v_mfma_f32_16x16x32_bf16 v[20:23], a[68:71], v[64:67], v[20:23]
v_mfma_f32_16x16x32_bf16 v[36:39], v[64:67], a[212:215], v[36:39]
ds_read_b128 v[60:63], v7 offset:10240
ds_read_b128 v[64:67], v7 offset:28672
s_waitcnt lgkmcnt(2)
v_mfma_f32_16x16x32_bf16 v[8:11], a[72:75], v[68:71], v[8:11]
v_mfma_f32_16x16x32_bf16 v[24:27], v[68:71], a[216:219], v[24:27]
v_mfma_f32_16x16x32_bf16 v[12:15], a[76:79], v[68:71], v[12:15]
v_mfma_f32_16x16x32_bf16 v[32:35], v[68:71], a[220:223], v[32:35]
v_mfma_f32_16x16x32_bf16 v[16:19], a[72:75], v[72:75], v[16:19]
v_mfma_f32_16x16x32_bf16 v[28:31], v[72:75], a[216:219], v[28:31]
v_mfma_f32_16x16x32_bf16 v[20:23], a[76:79], v[72:75], v[20:23]
v_mfma_f32_16x16x32_bf16 v[36:39], v[72:75], a[220:223], v[36:39]
ds_read_b128 v[68:71], v7 offset:11264
ds_read_b128 v[72:75], v7 offset:29696
s_waitcnt lgkmcnt(2)
v_mfma_f32_16x16x32_bf16 v[8:11], a[80:83], v[60:63], v[8:11]
v_mfma_f32_16x16x32_bf16 v[24:27], v[60:63], a[224:227], v[24:27]
v_mfma_f32_16x16x32_bf16 v[12:15], a[84:87], v[60:63], v[12:15]
v_mfma_f32_16x16x32_bf16 v[32:35], v[60:63], a[228:231], v[32:35]
v_mfma_f32_16x16x32_bf16 v[16:19], a[80:83], v[64:67], v[16:19]
v_mfma_f32_16x16x32_bf16 v[28:31], v[64:67], a[224:227], v[28:31]
v_mfma_f32_16x16x32_bf16 v[20:23], a[84:87], v[64:67], v[20:23]
v_mfma_f32_16x16x32_bf16 v[36:39], v[64:67], a[228:231], v[36:39]
ds_read_b128 v[60:63], v7 offset:12288
ds_read_b128 v[64:67], v7 offset:30720
s_waitcnt lgkmcnt(2)
v_mfma_f32_16x16x32_bf16 v[8:11], a[88:91], v[68:71], v[8:11]
v_mfma_f32_16x16x32_bf16 v[24:27], v[68:71], a[232:235], v[24:27]
v_mfma_f32_16x16x32_bf16 v[12:15], a[92:95], v[68:71], v[12:15]
v_mfma_f32_16x16x32_bf16 v[32:35], v[68:71], a[236:239], v[32:35]
v_mfma_f32_16x16x32_bf16 v[16:19], a[88:91], v[72:75], v[16:19]
v_mfma_f32_16x16x32_bf16 v[28:31], v[72:75], a[232:235], v[28:31]
v_mfma_f32_16x16x32_bf16 v[20:23], a[92:95], v[72:75], v[20:23]
v_mfma_f32_16x16x32_bf16 v[36:39], v[72:75], a[236:239], v[36:39]
ds_read_b128 v[68:71], v7 offset:13312
ds_read_b128 v[72:75], v7 offset:31744
s_waitcnt lgkmcnt(2)
v_mfma_f32_16x16x32_bf16 v[8:11], a[96:99], v[60:63], v[8:11]
v_mfma_f32_16x16x32_bf16 v[24:27], v[60:63], a[240:243], v[24:27]
v_mfma_f32_16x16x32_bf16 v[12:15], a[100:103], v[60:63], v[12:15]
v_mfma_f32_16x16x32_bf16 v[32:35], v[60:63], a[244:247], v[32:35]
v_mfma_f32_16x16x32_bf16 v[16:19], a[96:99], v[64:67], v[16:19]
v_mfma_f32_16x16x32_bf16 v[28:31], v[64:67], a[240:243], v[28:31]
v_mfma_f32_16x16x32_bf16 v[20:23], a[100:103], v[64:67], v[20:23]
v_mfma_f32_16x16x32_bf16 v[36:39], v[64:67], a[244:247], v[36:39]
ds_read_b128 v[60:63], v7 offset:14336
ds_read_b128 v[64:67], v7 offset:32768
s_waitcnt lgkmcnt(2)
v_mfma_f32_16x16x32_bf16 v[8:11], a[104:107], v[68:71], v[8:11]
v_mfma_f32_16x16x32_bf16 v[24:27], v[68:71], a[248:251], v[24:27]
v_mfma_f32_16x16x32_bf16 v[12:15], a[108:111], v[68:71], v[12:15]
v_mfma_f32_16x16x32_bf16 v[32:35], v[68:71], a[252:255], v[32:35]
v_mfma_f32_16x16x32_bf16 v[16:19], a[104:107], v[72:75], v[16:19]
v_mfma_f32_16x16x32_bf16 v[28:31], v[72:75], a[248:251], v[28:31]
v_mfma_f32_16x16x32_bf16 v[20:23], a[108:111], v[72:75], v[20:23]
v_mfma_f32_16x16x32_bf16 v[36:39], v[72:75], a[252:255], v[36:39]
ds_read_b128 v[68:71], v7 offset:15360
ds_read_b128 v[72:75], v7 offset:33792
s_waitcnt lgkmcnt(2)
v_mfma_f32_16x16x32_bf16 v[8:11], a[112:115], v[60:63], v[8:11]
v_mfma_f32_16x16x32_bf16 v[24:27], v[60:63], v[80:83], v[24:27]
v_mfma_f32_16x16x32_bf16 v[12:15], a[116:119], v[60:63], v[12:15]
v_mfma_f32_16x16x32_bf16 v[32:35], v[60:63], v[84:87], v[32:35]
v_mfma_f32_16x16x32_bf16 v[16:19], a[112:115], v[64:67], v[16:19]
v_mfma_f32_16x16x32_bf16 v[28:31], v[64:67], v[80:83], v[28:31]
v_mfma_f32_16x16x32_bf16 v[20:23], a[116:119], v[64:67], v[20:23]
v_mfma_f32_16x16x32_bf16 v[36:39], v[64:67], v[84:87], v[36:39]
ds_read_b128 v[60:63], v7 offset:16384
ds_read_b128 v[64:67], v7 offset:34816
s_waitcnt lgkmcnt(2)
v_mfma_f32_16x16x32_bf16 v[8:11], a[120:123], v[68:71], v[8:11]
v_mfma_f32_16x16x32_bf16 v[24:27], v[68:71], v[88:91], v[24:27]
v_mfma_f32_16x16x32_bf16 v[12:15], a[124:127], v[68:71], v[12:15]
v_mfma_f32_16x16x32_bf16 v[32:35], v[68:71], v[92:95], v[32:35]
v_mfma_f32_16x16x32_bf16 v[16:19], a[120:123], v[72:75], v[16:19]
v_mfma_f32_16x16x32_bf16 v[28:31], v[72:75], v[88:91], v[28:31]
v_mfma_f32_16x16x32_bf16 v[20:23], a[124:127], v[72:75], v[20:23]
v_mfma_f32_16x16x32_bf16 v[36:39], v[72:75], v[92:95], v[36:39]
ds_read_b128 v[68:71], v7 offset:17408
ds_read_b128 v[72:75], v7 offset:35840
s_waitcnt lgkmcnt(2)
v_mfma_f32_16x16x32_bf16 v[8:11], a[128:131], v[60:63], v[8:11]
v_mfma_f32_16x16x32_bf16 v[24:27], v[60:63], v[96:99], v[24:27]
v_mfma_f32_16x16x32_bf16 v[12:15], a[132:135], v[60:63], v[12:15]
v_mfma_f32_16x16x32_bf16 v[32:35], v[60:63], v[100:103], v[32:35]
v_mfma_f32_16x16x32_bf16 v[16:19], a[128:131], v[64:67], v[16:19]
v_mfma_f32_16x16x32_bf16 v[28:31], v[64:67], v[96:99], v[28:31]
v_mfma_f32_16x16x32_bf16 v[20:23], a[132:135], v[64:67], v[20:23]
v_mfma_f32_16x16x32_bf16 v[36:39], v[64:67], v[100:103], v[36:39]
s_waitcnt lgkmcnt(0)
v_mfma_f32_16x16x32_bf16 v[8:11], a[136:139], v[68:71], v[8:11]
v_mfma_f32_16x16x32_bf16 v[24:27], v[68:71], v[104:107], v[24:27]
v_mfma_f32_16x16x32_bf16 v[12:15], a[140:143], v[68:71], v[12:15]
v_mfma_f32_16x16x32_bf16 v[32:35], v[68:71], v[108:111], v[32:35]
v_mfma_f32_16x16x32_bf16 v[16:19], a[136:139], v[72:75], v[16:19]
v_mfma_f32_16x16x32_bf16 v[28:31], v[72:75], v[104:107], v[28:31]
v_mfma_f32_16x16x32_bf16 v[20:23], a[140:143], v[72:75], v[20:23]
v_mfma_f32_16x16x32_bf16 v[36:39], v[72:75], v[108:111], v[36:39]
s_lshl_b32 s41, s52, 7
s_add_u32 s40, s40, s41
s_lshl_b32 s41, s36, 5
s_add_u32 s41, s41, s52
s_lshl_b32 s41, s41, 6
s_add_u32 s41, s41, s37
s_lshl_b32 s41, s41, 14
s_add_u32 s41, s41, 58720256
s_lshl_b32 s26, s24, 10
s_add_u32 s41, s41, s26
s_add_u32 s42, s41, 4096
s_add_u32 s43, s41, s26
s_add_u32 s43, s43, 8192
s_add_u32 s27, s26, s38
v_add_u32 v6, s27, v1
v_add_u32 v76, s26, v6
v_cvt_pk_bf16_f32 v40, v8, v12
v_cvt_pk_bf16_f32 v41, v9, v13
v_cvt_pk_bf16_f32 v42, v10, v14
v_cvt_pk_bf16_f32 v43, v11, v15
buffer_store_dwordx4 v[40:43], v1, s[4:7], s41 offen sc1
ds_write_b128 v6, v[40:43] offset:0
v_cvt_pk_bf16_f32 v44, v16, v20
v_cvt_pk_bf16_f32 v45, v17, v21
v_cvt_pk_bf16_f32 v46, v18, v22
v_cvt_pk_bf16_f32 v47, v19, v23
buffer_store_dwordx4 v[44:47], v1, s[4:7], s42 offen sc1
ds_write_b128 v6, v[44:47] offset:4096
v_cvt_pk_bf16_f32 v48, v24, v25
v_cvt_pk_bf16_f32 v49, v26, v27
v_cvt_pk_bf16_f32 v50, v28, v29
v_cvt_pk_bf16_f32 v51, v30, v31
buffer_store_dwordx4 v[48:51], v1, s[4:7], s43 offen offset:0 sc1
ds_write_b128 v76, v[48:51] offset:16384
v_cvt_pk_bf16_f32 v52, v32, v33
v_cvt_pk_bf16_f32 v53, v34, v35
v_cvt_pk_bf16_f32 v54, v36, v37
v_cvt_pk_bf16_f32 v55, v38, v39
buffer_store_dwordx4 v[52:55], v1, s[4:7], s43 offen offset:1024 sc1
ds_write_b128 v76, v[52:55] offset:17408
s_lshl_b32 s41, s40, 2
s_waitcnt lgkmcnt(0)
ds_read_b128 v[60:63], v7 offset:0
ds_read_b128 v[64:67], v7 offset:18432
ds_read_b128 v[68:71], v7 offset:1024
ds_read_b128 v[72:75], v7 offset:19456
s_waitcnt lgkmcnt(2)
v_mfma_f32_16x16x32_bf16 v[8:11], v[112:115], v[60:63], 0
v_mfma_f32_16x16x32_bf16 v[12:15], v[116:119], v[60:63], 0
v_mfma_f32_16x16x32_bf16 v[16:19], v[112:115], v[64:67], 0
v_mfma_f32_16x16x32_bf16 v[20:23], v[116:119], v[64:67], 0
ds_read_b128 v[60:63], v7 offset:2048
ds_read_b128 v[64:67], v7 offset:20480
s_waitcnt lgkmcnt(2)
v_mfma_f32_16x16x32_bf16 v[8:11], v[120:123], v[68:71], v[8:11]
v_mfma_f32_16x16x32_bf16 v[12:15], v[124:127], v[68:71], v[12:15]
v_mfma_f32_16x16x32_bf16 v[16:19], v[120:123], v[72:75], v[16:19]
v_mfma_f32_16x16x32_bf16 v[20:23], v[124:127], v[72:75], v[20:23]
ds_read_b128 v[68:71], v7 offset:3072
ds_read_b128 v[72:75], v7 offset:21504
s_waitcnt lgkmcnt(2)
v_mfma_f32_16x16x32_bf16 v[8:11], v[128:131], v[60:63], v[8:11]
v_mfma_f32_16x16x32_bf16 v[12:15], v[132:135], v[60:63], v[12:15]
v_mfma_f32_16x16x32_bf16 v[16:19], v[128:131], v[64:67], v[16:19]
v_mfma_f32_16x16x32_bf16 v[20:23], v[132:135], v[64:67], v[20:23]
ds_read_b128 v[60:63], v7 offset:4096
ds_read_b128 v[64:67], v7 offset:22528
s_waitcnt lgkmcnt(2)
v_mfma_f32_16x16x32_bf16 v[8:11], v[136:139], v[68:71], v[8:11]
v_mfma_f32_16x16x32_bf16 v[12:15], v[140:143], v[68:71], v[12:15]
v_mfma_f32_16x16x32_bf16 v[16:19], v[136:139], v[72:75], v[16:19]
v_mfma_f32_16x16x32_bf16 v[20:23], v[140:143], v[72:75], v[20:23]
ds_read_b128 v[68:71], v7 offset:5120
ds_read_b128 v[72:75], v7 offset:23552
s_waitcnt lgkmcnt(2)
v_mfma_f32_16x16x32_bf16 v[8:11], v[144:147], v[60:63], v[8:11]
v_mfma_f32_16x16x32_bf16 v[12:15], v[148:151], v[60:63], v[12:15]
v_mfma_f32_16x16x32_bf16 v[16:19], v[144:147], v[64:67], v[16:19]
v_mfma_f32_16x16x32_bf16 v[20:23], v[148:151], v[64:67], v[20:23]
ds_read_b128 v[60:63], v7 offset:6144
ds_read_b128 v[64:67], v7 offset:24576
s_waitcnt lgkmcnt(2)
s_waitcnt vmcnt(0)
s_barrier
s_cmp_lg_u32 s24, 0
s_cbranch_scc1 Lsg11
v_mov_b32 v56, 1
s_mov_b64 exec, 1
buffer_store_dword v56, off, s[4:7], s41 sc1
s_mov_b64 exec, -1
Lsg11:
v_mfma_f32_16x16x32_bf16 v[8:11], v[152:155], v[68:71], v[8:11]
v_mfma_f32_16x16x32_bf16 v[12:15], v[156:159], v[68:71], v[12:15]
v_mfma_f32_16x16x32_bf16 v[16:19], v[152:155], v[72:75], v[16:19]
v_mfma_f32_16x16x32_bf16 v[20:23], v[156:159], v[72:75], v[20:23]
ds_read_b128 v[68:71], v7 offset:7168
ds_read_b128 v[72:75], v7 offset:25600
s_waitcnt lgkmcnt(2)
v_mfma_f32_16x16x32_bf16 v[8:11], v[160:163], v[60:63], v[8:11]
v_mfma_f32_16x16x32_bf16 v[12:15], v[164:167], v[60:63], v[12:15]
v_mfma_f32_16x16x32_bf16 v[16:19], v[160:163], v[64:67], v[16:19]
v_mfma_f32_16x16x32_bf16 v[20:23], v[164:167], v[64:67], v[20:23]
ds_read_b128 v[60:63], v7 offset:8192
ds_read_b128 v[64:67], v7 offset:26624
s_waitcnt lgkmcnt(2)
v_mfma_f32_16x16x32_bf16 v[8:11], v[168:171], v[68:71], v[8:11]
v_mfma_f32_16x16x32_bf16 v[12:15], v[172:175], v[68:71], v[12:15]
v_mfma_f32_16x16x32_bf16 v[16:19], v[168:171], v[72:75], v[16:19]
v_mfma_f32_16x16x32_bf16 v[20:23], v[172:175], v[72:75], v[20:23]
ds_read_b128 v[68:71], v7 offset:9216
ds_read_b128 v[72:75], v7 offset:27648
s_waitcnt lgkmcnt(2)
v_mfma_f32_16x16x32_bf16 v[8:11], v[176:179], v[60:63], v[8:11]
v_mfma_f32_16x16x32_bf16 v[12:15], v[180:183], v[60:63], v[12:15]
v_mfma_f32_16x16x32_bf16 v[16:19], v[176:179], v[64:67], v[16:19]
v_mfma_f32_16x16x32_bf16 v[20:23], v[180:183], v[64:67], v[20:23]
ds_read_b128 v[60:63], v7 offset:10240
ds_read_b128 v[64:67], v7 offset:28672
s_waitcnt lgkmcnt(2)
v_mfma_f32_16x16x32_bf16 v[8:11], v[184:187], v[68:71], v[8:11]
v_mfma_f32_16x16x32_bf16 v[12:15], v[188:191], v[68:71], v[12:15]
v_mfma_f32_16x16x32_bf16 v[16:19], v[184:187], v[72:75], v[16:19]
v_mfma_f32_16x16x32_bf16 v[20:23], v[188:191], v[72:75], v[20:23]
ds_read_b128 v[68:71], v7 offset:11264
ds_read_b128 v[72:75], v7 offset:29696
s_waitcnt lgkmcnt(2)
v_mfma_f32_16x16x32_bf16 v[8:11], v[192:195], v[60:63], v[8:11]
v_mfma_f32_16x16x32_bf16 v[12:15], v[196:199], v[60:63], v[12:15]
v_mfma_f32_16x16x32_bf16 v[16:19], v[192:195], v[64:67], v[16:19]
v_mfma_f32_16x16x32_bf16 v[20:23], v[196:199], v[64:67], v[20:23]
ds_read_b128 v[60:63], v7 offset:12288
ds_read_b128 v[64:67], v7 offset:30720
s_waitcnt lgkmcnt(2)
v_mfma_f32_16x16x32_bf16 v[8:11], v[200:203], v[68:71], v[8:11]
v_mfma_f32_16x16x32_bf16 v[12:15], v[204:207], v[68:71], v[12:15]
v_mfma_f32_16x16x32_bf16 v[16:19], v[200:203], v[72:75], v[16:19]
v_mfma_f32_16x16x32_bf16 v[20:23], v[204:207], v[72:75], v[20:23]
ds_read_b128 v[68:71], v7 offset:13312
ds_read_b128 v[72:75], v7 offset:31744
s_waitcnt lgkmcnt(2)
v_mfma_f32_16x16x32_bf16 v[8:11], v[208:211], v[60:63], v[8:11]
v_mfma_f32_16x16x32_bf16 v[12:15], v[212:215], v[60:63], v[12:15]
v_mfma_f32_16x16x32_bf16 v[16:19], v[208:211], v[64:67], v[16:19]
v_mfma_f32_16x16x32_bf16 v[20:23], v[212:215], v[64:67], v[20:23]
ds_read_b128 v[60:63], v7 offset:14336
ds_read_b128 v[64:67], v7 offset:32768
s_waitcnt lgkmcnt(2)
v_mfma_f32_16x16x32_bf16 v[8:11], v[216:219], v[68:71], v[8:11]
v_mfma_f32_16x16x32_bf16 v[12:15], v[220:223], v[68:71], v[12:15]
v_mfma_f32_16x16x32_bf16 v[16:19], v[216:219], v[72:75], v[16:19]
v_mfma_f32_16x16x32_bf16 v[20:23], v[220:223], v[72:75], v[20:23]
ds_read_b128 v[68:71], v7 offset:15360
ds_read_b128 v[72:75], v7 offset:33792
s_waitcnt lgkmcnt(2)
v_mfma_f32_16x16x32_bf16 v[8:11], v[224:227], v[60:63], v[8:11]
v_mfma_f32_16x16x32_bf16 v[12:15], v[228:231], v[60:63], v[12:15]
v_mfma_f32_16x16x32_bf16 v[16:19], v[224:227], v[64:67], v[16:19]
v_mfma_f32_16x16x32_bf16 v[20:23], v[228:231], v[64:67], v[20:23]
ds_read_b128 v[60:63], v7 offset:16384
ds_read_b128 v[64:67], v7 offset:34816
s_waitcnt lgkmcnt(2)
v_mfma_f32_16x16x32_bf16 v[8:11], v[232:235], v[68:71], v[8:11]
v_mfma_f32_16x16x32_bf16 v[12:15], v[236:239], v[68:71], v[12:15]
v_mfma_f32_16x16x32_bf16 v[16:19], v[232:235], v[72:75], v[16:19]
v_mfma_f32_16x16x32_bf16 v[20:23], v[236:239], v[72:75], v[20:23]
ds_read_b128 v[68:71], v7 offset:17408
ds_read_b128 v[72:75], v7 offset:35840
s_waitcnt lgkmcnt(2)
v_mfma_f32_16x16x32_bf16 v[8:11], v[240:243], v[60:63], v[8:11]
v_mfma_f32_16x16x32_bf16 v[12:15], v[244:247], v[60:63], v[12:15]
v_mfma_f32_16x16x32_bf16 v[16:19], v[240:243], v[64:67], v[16:19]
v_mfma_f32_16x16x32_bf16 v[20:23], v[244:247], v[64:67], v[20:23]
s_waitcnt lgkmcnt(0)
v_mfma_f32_16x16x32_bf16 v[8:11], v[248:251], v[68:71], v[8:11]
v_mfma_f32_16x16x32_bf16 v[12:15], v[252:255], v[68:71], v[12:15]
v_mfma_f32_16x16x32_bf16 v[16:19], v[248:251], v[72:75], v[16:19]
v_mfma_f32_16x16x32_bf16 v[20:23], v[252:255], v[72:75], v[20:23]
s_nop 5
v_cvt_pk_bf16_f32 v40, v8, v12
v_cvt_pk_bf16_f32 v41, v9, v13
v_cvt_pk_bf16_f32 v42, v10, v14
v_cvt_pk_bf16_f32 v43, v11, v15
ds_write_b128 v6, v[40:43] offset:8192
v_cvt_pk_bf16_f32 v44, v16, v20
v_cvt_pk_bf16_f32 v45, v17, v21
v_cvt_pk_bf16_f32 v46, v18, v22
v_cvt_pk_bf16_f32 v47, v19, v23
ds_write_b128 v6, v[44:47] offset:12288
s_waitcnt lgkmcnt(0)
P3_att:
s_cmp_lt_u32 s37, 4
s_cbranch_scc1 P3_next
s_barrier
v_add_u32 v6, s39, v1
s_lshl_b32 s26, s24, 11
v_add_u32 v76, s26, v6
ds_read_b128 v[8:11], v6 offset:8192
ds_read_b128 v[12:15], v6 offset:9216
ds_read_b128 v[16:19], v6 offset:10240
ds_read_b128 v[20:23], v6 offset:11264
ds_read_b128 v[24:27], v6 offset:12288
ds_read_b128 v[28:31], v6 offset:13312
ds_read_b128 v[32:35], v6 offset:14336
ds_read_b128 v[36:39], v6 offset:15360
ds_read_b128 v[40:43], v6 offset:0
ds_read_b128 v[44:47], v6 offset:1024
ds_read_b128 v[48:51], v6 offset:2048
ds_read_b128 v[52:55], v6 offset:3072
s_waitcnt lgkmcnt(0)
v_mfma_f32_16x16x32_bf16 v[56:59], v[40:43], v[8:11], 0
v_mfma_f32_16x16x32_bf16 v[60:63], v[40:43], v[24:27], 0
v_mfma_f32_16x16x32_bf16 v[56:59], v[44:47], v[12:15], v[56:59]
v_mfma_f32_16x16x32_bf16 v[60:63], v[44:47], v[28:31], v[60:63]
v_mfma_f32_16x16x32_bf16 v[56:59], v[48:51], v[16:19], v[56:59]
v_mfma_f32_16x16x32_bf16 v[60:63], v[48:51], v[32:35], v[60:63]
v_mfma_f32_16x16x32_bf16 v[56:59], v[52:55], v[20:23], v[56:59]
v_mfma_f32_16x16x32_bf16 v[60:63], v[52:55], v[36:39], v[60:63]
ds_read_b128 v[40:43], v6 offset:4096
ds_read_b128 v[44:47], v6 offset:5120
ds_read_b128 v[48:51], v6 offset:6144
ds_read_b128 v[52:55], v6 offset:7168
s_waitcnt lgkmcnt(0)
v_mfma_f32_16x16x32_bf16 v[64:67], v[40:43], v[24:27], 0
v_mfma_f32_16x16x32_bf16 v[64:67], v[44:47], v[28:31], v[64:67]
v_mfma_f32_16x16x32_bf16 v[64:67], v[48:51], v[32:35], v[64:67]
v_mfma_f32_16x16x32_bf16 v[64:67], v[52:55], v[36:39], v[64:67]
s_lshl_b32 s40, s36, 6
s_add_u32 s40, s40, s37
s_sub_u32 s40, s40, 4
s_lshl_b32 s43, s52, 7
s_add_u32 s43, s43, s40
s_lshl_b32 s41, s36, 5
s_add_u32 s41, s41, s52
s_lshl_b32 s41, s41, 6
s_add_u32 s41, s41, s37
s_lshl_b32 s42, s41, 2
s_add_u32 s42, s42, 16368
s_mov_b32 s29, 0
Lwf12:
buffer_load_dword v77, v5, s[4:7], s42 offen sc1
s_add_u32 s29, s29, 1
s_waitcnt vmcnt(0)
v_cmp_eq_u32 vcc, 0, v77
s_cbranch_vccz Lwd13
s_sleep 1
s_cmp_lt_u32 s29, s25
s_cbranch_scc1 Lwf12
s_mov_b32 s25, 0
Lwd13:
s_lshl_b32 s41, s41, 12
s_add_u32 s41, s41, 25149440
s_lshl_b32 s42, s24, 9
s_add_u32 s42, s42, s41
v_lshrrev_b32 v77, 1, v1
buffer_load_dwordx4 v[40:43], v0, s[4:7], s41 offen offset:0 sc1
buffer_load_dwordx4 v[44:47], v0, s[4:7], s41 offen offset:512 sc1
buffer_load_dwordx4 v[48:51], v0, s[4:7], s41 offen offset:1024 sc1
buffer_load_dwordx4 v[52:55], v0, s[4:7], s41 offen offset:1536 sc1
buffer_load_dwordx2 v[78:79], v77, s[4:7], s42 offen offset:2048 sc1
v_mov_b32 v77, 0xff800000
v_cndmask_b32 v56, v77, v56, s[44:45]
v_cndmask_b32 v64, v77, v64, s[44:45]
v_cndmask_b32 v57, v77, v57, s[46:47]
v_cndmask_b32 v65, v77, v65, s[46:47]
v_cndmask_b32 v58, v77, v58, s[48:49]
v_cndmask_b32 v66, v77, v66, s[48:49]
v_cndmask_b32 v59, v77, v59, s[50:51]
v_cndmask_b32 v67, v77, v67, s[50:51]
s_waitcnt vmcnt(4)
v_mfma_f32_16x16x32_bf16 v[68:71], v[40:43], v[8:11], 0
v_mfma_f32_16x16x32_bf16 v[72:75], v[40:43], v[24:27], 0
s_waitcnt vmcnt(3)
v_mfma_f32_16x16x32_bf16 v[68:71], v[44:47], v[12:15], v[68:71]
v_mfma_f32_16x16x32_bf16 v[72:75], v[44:47], v[28:31], v[72:75]
s_waitcnt vmcnt(2)
v_mfma_f32_16x16x32_bf16 v[68:71], v[48:51], v[16:19], v[68:71]
v_mfma_f32_16x16x32_bf16 v[72:75], v[48:51], v[32:35], v[72:75]
s_waitcnt vmcnt(1)
v_mfma_f32_16x16x32_bf16 v[68:71], v[52:55], v[20:23], v[68:71]
v_mfma_f32_16x16x32_bf16 v[72:75], v[52:55], v[36:39], v[72:75]
ds_read_b128 v[8:11], v76 offset:16384
ds_read_b128 v[12:15], v76 offset:17408
v_mov_b32 v16, 0x3f803f80
v_mov_b32 v17, 0x3f803f80
v_mov_b32 v18, 0x3f803f80
v_mov_b32 v19, 0x3f803f80
v_mov_b32 v22, 0
v_mov_b32 v23, 0
v_mov_b32 v29, 0
v_mov_b32 v30, 0
v_mov_b32 v33, 0
v_mov_b32 v34, 0
v_max3_f32 v36, v56, v57, v58
v_max3_f32 v36, v36, v59, v68
v_max_f32 v36, v36, v69
v_mov_b32 v37, v36
s_nop 1
v_permlane16_swap_b32 v36, v37
v_max_f32 v36, v36, v37
v_mov_b32 v37, v36
s_nop 1
v_permlane32_swap_b32 v36, v37
v_max_f32 v36, v36, v37
v_mul_f32 v36, s30, v36
v_fma_f32 v56, v56, s30, -v36
v_fma_f32 v57, v57, s30, -v36
v_fma_f32 v58, v58, s30, -v36
v_fma_f32 v59, v59, s30, -v36
v_fma_f32 v68, v68, s30, -v36
v_fma_f32 v69, v69, s30, -v36
v_exp_f32 v56, v56
v_exp_f32 v57, v57
v_exp_f32 v58, v58
v_exp_f32 v59, v59
v_exp_f32 v68, v68
v_exp_f32 v69, v69
v_max3_f32 v36, v60, v61, v62
v_max3_f32 v36, v36, v63, v64
v_max3_f32 v36, v36, v65, v66
v_max3_f32 v36, v36, v67, v72
v_max_f32 v36, v36, v73
v_mov_b32 v37, v36
s_nop 1
v_permlane16_swap_b32 v36, v37
v_max_f32 v36, v36, v37
v_mov_b32 v37, v36
s_nop 1
v_permlane32_swap_b32 v36, v37
v_max_f32 v36, v36, v37
v_mul_f32 v36, s30, v36
v_fma_f32 v60, v60, s30, -v36
v_fma_f32 v61, v61, s30, -v36
v_fma_f32 v62, v62, s30, -v36
v_fma_f32 v63, v63, s30, -v36
v_fma_f32 v64, v64, s30, -v36
v_fma_f32 v65, v65, s30, -v36
v_fma_f32 v66, v66, s30, -v36
v_fma_f32 v67, v67, s30, -v36
v_fma_f32 v72, v72, s30, -v36
v_fma_f32 v73, v73, s30, -v36
v_exp_f32 v60, v60
v_exp_f32 v61, v61
v_exp_f32 v62, v62
v_exp_f32 v63, v63
v_exp_f32 v64, v64
v_exp_f32 v65, v65
v_exp_f32 v66, v66
v_exp_f32 v67, v67
v_exp_f32 v72, v72
v_exp_f32 v73, v73
v_cvt_pk_bf16_f32 v20, v56, v57
v_cvt_pk_bf16_f32 v21, v58, v59
v_cvt_pk_bf16_f32 v24, v60, v61
v_cvt_pk_bf16_f32 v25, v62, v63
v_cvt_pk_bf16_f32 v26, v64, v65
v_cvt_pk_bf16_f32 v27, v66, v67
v_cvt_pk_bf16_f32 v28, v68, v69
v_cvt_pk_bf16_f32 v31, v68, v69
v_cvt_pk_bf16_f32 v32, v72, v73
v_cvt_pk_bf16_f32 v35, v72, v73
s_waitcnt vmcnt(0) lgkmcnt(0)
v_mfma_f32_16x16x16_bf16 v[56:59], v[16:17], v[28:29], 0
v_mfma_f32_16x16x16_bf16 v[60:63], v[16:17], v[32:33], 0
v_mfma_f32_16x16x16_bf16 v[40:43], v[78:79], v[28:29], 0
v_mfma_f32_16x16x16_bf16 v[44:47], v[78:79], v[30:31], 0
v_mfma_f32_16x16x16_bf16 v[48:51], v[78:79], v[32:33], 0
v_mfma_f32_16x16x16_bf16 v[52:55], v[78:79], v[34:35], 0
s_nop 0
v_mfma_f32_16x16x32_bf16 v[56:59], v[16:19], v[20:23], v[56:59]
v_mfma_f32_16x16x32_bf16 v[60:63], v[16:19], v[24:27], v[60:63]
v_mfma_f32_16x16x32_bf16 v[40:43], v[8:11], v[20:23], v[40:43]
v_mfma_f32_16x16x32_bf16 v[44:47], v[12:15], v[20:23], v[44:47]
v_mfma_f32_16x16x32_bf16 v[48:51], v[8:11], v[24:27], v[48:51]
v_mfma_f32_16x16x32_bf16 v[52:55], v[12:15], v[24:27], v[52:55]
s_nop 2
v_rcp_f32 v56, v56
v_rcp_f32 v60, v60
s_lshl_b32 s41, s40, 6
s_add_u32 s41, s41, s52
s_lshl_b32 s41, s41, 2
s_add_u32 s41, s41, s24
s_lshl_b32 s41, s41, 10
s_add_u32 s41, s41, 125829120
s_add_u32 s42, s41, 0x20000
v_mul_f32 v40, v40, v56
v_mul_f32 v41, v41, v56
v_mul_f32 v42, v42, v56
v_mul_f32 v43, v43, v56
v_mul_f32 v44, v44, v56
v_mul_f32 v45, v45, v56
v_mul_f32 v46, v46, v56
v_mul_f32 v47, v47, v56
v_cvt_pk_bf16_f32 v64, v40, v41
v_cvt_pk_bf16_f32 v65, v42, v43
v_cvt_pk_bf16_f32 v66, v44, v45
v_cvt_pk_bf16_f32 v67, v46, v47
buffer_store_dwordx4 v[64:67], v1, s[4:7], s41 offen sc1
v_mul_f32 v48, v48, v60
v_mul_f32 v49, v49, v60
v_mul_f32 v50, v50, v60
v_mul_f32 v51, v51, v60
v_mul_f32 v52, v52, v60
v_mul_f32 v53, v53, v60
v_mul_f32 v54, v54, v60
v_mul_f32 v55, v55, v60
v_cvt_pk_bf16_f32 v68, v48, v49
v_cvt_pk_bf16_f32 v69, v50, v51
v_cvt_pk_bf16_f32 v70, v52, v53
v_cvt_pk_bf16_f32 v71, v54, v55
buffer_store_dwordx4 v[68:71], v1, s[4:7], s42 offen sc1
s_lshl_b32 s41, s43, 2
s_add_u32 s41, s41, 32768
s_waitcnt vmcnt(0)
s_barrier
s_cmp_lg_u32 s24, 0
s_cbranch_scc1 Lsg14
v_mov_b32 v77, 1
s_mov_b64 exec, 1
buffer_store_dword v77, off, s[4:7], s41 sc1
s_mov_b64 exec, -1
Lsg14:
P3_next:
s_mov_b32 s26, s38
s_mov_b32 s38, s39
s_mov_b32 s39, s26
s_add_u32 s37, s37, 4
s_cmp_lt_u32 s37, 68
s_cbranch_scc1 P3_loop
s_add_u32 s36, s36, 1
s_cmp_lt_u32 s36, 2
s_cbranch_scc1 P3_layer
s_branch END
P2:
s_load_dwordx2 s[8:9], s[0:1], 16
s_mov_b32 s10, 663552
s_mov_b32 s11, 0x20000
s_waitcnt lgkmcnt(0)
s_load_dwordx2 s[12:13], s[0:1], 0
s_mov_b32 s14, 2359296
s_mov_b32 s15, 0x20000
s_waitcnt lgkmcnt(0)
s_cmp_lg_u32 s2, 255
s_cbranch_scc1 P2_noinit
v_mov_b32 v8, 0
v_mov_b32 v9, 0
v_mov_b32 v10, 0
v_mov_b32 v11, 0
s_lshl_b32 s41, s24, 10
buffer_store_dwordx4 v[8:11], v1, s[4:7], s41 offen sc1
s_add_u32 s41, s41, 4096
buffer_store_dwordx4 v[8:11], v1, s[4:7], s41 offen sc1
s_add_u32 s41, s41, 4096
buffer_store_dwordx4 v[8:11], v1, s[4:7], s41 offen sc1
s_add_u32 s41, s41, 4096
buffer_store_dwordx4 v[8:11], v1, s[4:7], s41 offen sc1
s_add_u32 s41, s41, 4096
buffer_store_dwordx4 v[8:11], v1, s[4:7], s41 offen sc1
s_add_u32 s41, s41, 4096
buffer_store_dwordx4 v[8:11], v1, s[4:7], s41 offen sc1
s_add_u32 s41, s41, 4096
buffer_store_dwordx4 v[8:11], v1, s[4:7], s41 offen sc1
s_add_u32 s41, s41, 4096
buffer_store_dwordx4 v[8:11], v1, s[4:7], s41 offen sc1
s_add_u32 s41, s41, 4096
buffer_store_dwordx4 v[8:11], v1, s[4:7], s41 offen sc1
s_add_u32 s41, s41, 4096
buffer_store_dwordx4 v[8:11], v1, s[4:7], s41 offen sc1
s_add_u32 s41, s41, 4096
buffer_store_dwordx4 v[8:11], v1, s[4:7], s41 offen sc1
s_add_u32 s41, s41, 4096
buffer_store_dwordx4 v[8:11], v1, s[4:7], s41 offen sc1
s_add_u32 s41, s41, 4096
buffer_store_dwordx4 v[8:11], v1, s[4:7], s41 offen sc1
s_add_u32 s41, s41, 4096
buffer_store_dwordx4 v[8:11], v1, s[4:7], s41 offen sc1
s_add_u32 s41, s41, 4096
buffer_store_dwordx4 v[8:11], v1, s[4:7], s41 offen sc1
s_add_u32 s41, s41, 4096
buffer_store_dwordx4 v[8:11], v1, s[4:7], s41 offen sc1
s_add_u32 s41, s41, 4096
buffer_store_dwordx4 v[8:11], v1, s[4:7], s41 offen sc1
s_add_u32 s41, s41, 4096
buffer_store_dwordx4 v[8:11], v1, s[4:7], s41 offen sc1
s_add_u32 s41, s41, 4096
buffer_store_dwordx4 v[8:11], v1, s[4:7], s41 offen sc1
s_add_u32 s41, s41, 4096
buffer_store_dwordx4 v[8:11], v1, s[4:7], s41 offen sc1
s_add_u32 s41, s41, 4096
buffer_store_dwordx4 v[8:11], v1, s[4:7], s41 offen sc1
s_add_u32 s41, s41, 4096
s_mov_b32 s41, 128
s_waitcnt vmcnt(0)
s_barrier
s_cmp_lg_u32 s24, 0
s_cbranch_scc1 Lsg15
v_mov_b32 v50, 1
s_mov_b64 exec, 1
buffer_store_dword v50, off, s[16:19], s41 sc1
s_mov_b64 exec, -1
Lsg15:
s_mov_b32 s36, 0
P2_noinit:
s_mul_i32 s28, s24, 40960
s_mul_i32 s35, s33, 384
s_mul_i32 s26, s24, 96
s_add_u32 s35, s35, s26
v_add_u32 v50, 0, v0
v_mul_u32_u24 v51, 10923, v50
v_lshrrev_b32 v51, 16, v51
v_mul_u32_u24 v52, 6, v51
v_sub_u32 v52, v50, v52
v_lshrrev_b32 v53, 3, v51
v_and_b32 v54, 7, v51
v_lshrrev_b32 v51, 2, v54
v_mul_u32_u24 v51, 18, v51
v_lshl_add_u32 v51, v53, 2, v51
v_and_b32 v54, 3, v54
v_add_u32 v51, v51, v54
v_mul_u32_u24 v51, 1152, v51
v_lshl_add_u32 v51, v52, 4, v51
v_add_u32 v56, s35, v51
v_add_u32 v50, 64, v0
v_mul_u32_u24 v51, 10923, v50
v_lshrrev_b32 v51, 16, v51
v_mul_u32_u24 v52, 6, v51
v_sub_u32 v52, v50, v52
v_lshrrev_b32 v53, 3, v51
v_and_b32 v54, 7, v51
v_lshrrev_b32 v51, 2, v54
v_mul_u32_u24 v51, 18, v51
v_lshl_add_u32 v51, v53, 2, v51
v_and_b32 v54, 3, v54
v_add_u32 v51, v51, v54
v_mul_u32_u24 v51, 1152, v51
v_lshl_add_u32 v51, v52, 4, v51
v_add_u32 v57, s35, v51
v_add_u32 v50, 128, v0
v_mul_u32_u24 v51, 10923, v50
v_lshrrev_b32 v51, 16, v51
v_mul_u32_u24 v52, 6, v51
v_sub_u32 v52, v50, v52
v_lshrrev_b32 v53, 3, v51
v_and_b32 v54, 7, v51
v_lshrrev_b32 v51, 2, v54
v_mul_u32_u24 v51, 18, v51
v_lshl_add_u32 v51, v53, 2, v51
v_and_b32 v54, 3, v54
v_add_u32 v51, v51, v54
v_mul_u32_u24 v51, 1152, v51
v_lshl_add_u32 v51, v52, 4, v51
v_add_u32 v58, s35, v51
v_add_u32 v50, 0, v0
v_mul_u32_u24 v51, 10923, v50
v_lshrrev_b32 v51, 16, v51
v_mul_u32_u24 v52, 6, v51
v_sub_u32 v52, v50, v52
v_lshrrev_b32 v53, 3, v51
v_and_b32 v54, 7, v51
v_lshrrev_b32 v51, 1, v54
v_lshl_add_u32 v51, v53, 2, v51
v_mul_u32_u24 v51, 18, v51
v_and_b32 v54, 1, v54
v_add3_u32 v51, v51, v54, 16
v_mul_u32_u24 v51, 1152, v51
v_lshl_add_u32 v51, v52, 4, v51
v_add_u32 v64, s35, v51
v_add_u32 v50, 64, v0
v_mul_u32_u24 v51, 10923, v50
v_lshrrev_b32 v51, 16, v51
v_mul_u32_u24 v52, 6, v51
v_sub_u32 v52, v50, v52
v_lshrrev_b32 v53, 3, v51
v_and_b32 v54, 7, v51
v_lshrrev_b32 v51, 1, v54
v_lshl_add_u32 v51, v53, 2, v51
v_mul_u32_u24 v51, 18, v51
v_and_b32 v54, 1, v54
v_add3_u32 v51, v51, v54, 16
v_mul_u32_u24 v51, 1152, v51
v_lshl_add_u32 v51, v52, 4, v51
v_add_u32 v65, s35, v51
v_add_u32 v50, 128, v0
v_mul_u32_u24 v51, 10923, v50
v_lshrrev_b32 v51, 16, v51
v_mul_u32_u24 v52, 6, v51
v_sub_u32 v52, v50, v52
v_lshrrev_b32 v53, 3, v51
v_and_b32 v54, 7, v51
v_lshrrev_b32 v51, 1, v54
v_lshl_add_u32 v51, v53, 2, v51
v_mul_u32_u24 v51, 18, v51
v_and_b32 v54, 1, v54
v_add3_u32 v51, v51, v54, 16
v_mul_u32_u24 v51, 1152, v51
v_lshl_add_u32 v51, v52, 4, v51
v_add_u32 v66, s35, v51
v_lshrrev_b32 v61, 4, v0
v_bfe_u32 v50, v0, 2, 2
v_lshl_add_u32 v61, v61, 3, v50
v_mul_u32_u24 v61, 96, v61
v_and_b32 v50, 3, v0
v_lshl_add_u32 v61, v50, 3, v61
v_add_u32 v61, s28, v61
s_add_u32 m0, s28, 0
s_mov_b32 s26, 0
buffer_load_dwordx4 v56, s[8:11], s26 offen lds
s_add_u32 m0, s28, 1024
s_mov_b32 s26, 0
buffer_load_dwordx4 v57, s[8:11], s26 offen lds
s_add_u32 m0, s28, 2048
s_mov_b32 s26, 0
buffer_load_dwordx4 v58, s[8:11], s26 offen lds
s_add_u32 m0, s28, 3072
s_mov_b32 s26, 41472
buffer_load_dwordx4 v56, s[8:11], s26 offen lds
s_add_u32 m0, s28, 4096
s_mov_b32 s26, 41472
buffer_load_dwordx4 v57, s[8:11], s26 offen lds
s_add_u32 m0, s28, 5120
s_mov_b32 s26, 41472
buffer_load_dwordx4 v58, s[8:11], s26 offen lds
s_add_u32 m0, s28, 6144
s_mov_b32 s26, 82944
buffer_load_dwordx4 v56, s[8:11], s26 offen lds
s_add_u32 m0, s28, 7168
s_mov_b32 s26, 82944
buffer_load_dwordx4 v57, s[8:11], s26 offen lds
s_add_u32 m0, s28, 8192
s_mov_b32 s26, 82944
buffer_load_dwordx4 v58, s[8:11], s26 offen lds
s_add_u32 m0, s28, 9216
s_mov_b32 s26, 124416
buffer_load_dwordx4 v56, s[8:11], s26 offen lds
s_add_u32 m0, s28, 10240
s_mov_b32 s26, 124416
buffer_load_dwordx4 v57, s[8:11], s26 offen lds
s_add_u32 m0, s28, 11264
s_mov_b32 s26, 124416
buffer_load_dwordx4 v58, s[8:11], s26 offen lds
s_add_u32 m0, s28, 12288
s_mov_b32 s26, 165888
buffer_load_dwordx4 v56, s[8:11], s26 offen lds
s_add_u32 m0, s28, 13312
s_mov_b32 s26, 165888
buffer_load_dwordx4 v57, s[8:11], s26 offen lds
s_add_u32 m0, s28, 14336
s_mov_b32 s26, 165888
buffer_load_dwordx4 v58, s[8:11], s26 offen lds
s_add_u32 m0, s28, 15360
s_mov_b32 s26, 207360
buffer_load_dwordx4 v56, s[8:11], s26 offen lds
s_add_u32 m0, s28, 16384
s_mov_b32 s26, 207360
buffer_load_dwordx4 v57, s[8:11], s26 offen lds
s_add_u32 m0, s28, 17408
s_mov_b32 s26, 207360
buffer_load_dwordx4 v58, s[8:11], s26 offen lds
s_add_u32 m0, s28, 18432
s_mov_b32 s26, 248832
buffer_load_dwordx4 v56, s[8:11], s26 offen lds
s_add_u32 m0, s28, 19456
s_mov_b32 s26, 248832
buffer_load_dwordx4 v57, s[8:11], s26 offen lds
s_add_u32 m0, s28, 20480
s_mov_b32 s26, 248832
buffer_load_dwordx4 v58, s[8:11], s26 offen lds
s_add_u32 m0, s28, 21504
s_mov_b32 s26, 290304
buffer_load_dwordx4 v56, s[8:11], s26 offen lds
s_add_u32 m0, s28, 22528
s_mov_b32 s26, 290304
buffer_load_dwordx4 v57, s[8:11], s26 offen lds
s_add_u32 m0, s28, 23552
s_mov_b32 s26, 290304
buffer_load_dwordx4 v58, s[8:11], s26 offen lds
s_add_u32 m0, s28, 24576
s_mov_b32 s26, 331776
buffer_load_dwordx4 v56, s[8:11], s26 offen lds
s_add_u32 m0, s28, 25600
s_mov_b32 s26, 331776
buffer_load_dwordx4 v57, s[8:11], s26 offen lds
s_add_u32 m0, s28, 26624
s_mov_b32 s26, 331776
buffer_load_dwordx4 v58, s[8:11], s26 offen lds
s_add_u32 m0, s28, 27648
s_mov_b32 s26, 373248
buffer_load_dwordx4 v56, s[8:11], s26 offen lds
s_add_u32 m0, s28, 28672
s_mov_b32 s26, 373248
buffer_load_dwordx4 v57, s[8:11], s26 offen lds
s_add_u32 m0, s28, 29696
s_mov_b32 s26, 373248
buffer_load_dwordx4 v58, s[8:11], s26 offen lds
s_add_u32 m0, s28, 30720
s_mov_b32 s26, 414720
buffer_load_dwordx4 v56, s[8:11], s26 offen lds
s_add_u32 m0, s28, 31744
s_mov_b32 s26, 414720
buffer_load_dwordx4 v57, s[8:11], s26 offen lds
s_add_u32 m0, s28, 32768
s_mov_b32 s26, 414720
buffer_load_dwordx4 v58, s[8:11], s26 offen lds
s_add_u32 m0, s28, 33792
s_mov_b32 s26, 456192
buffer_load_dwordx4 v56, s[8:11], s26 offen lds
s_add_u32 m0, s28, 34816
s_mov_b32 s26, 456192
buffer_load_dwordx4 v57, s[8:11], s26 offen lds
s_add_u32 m0, s28, 35840
s_mov_b32 s26, 456192
buffer_load_dwordx4 v58, s[8:11], s26 offen lds
s_waitcnt vmcnt(18)
ds_read_b64_tr_b16 a[0:1], v61 offset:0
ds_read_b64_tr_b16 a[2:3], v61 offset:384
ds_read_b64_tr_b16 a[4:5], v61 offset:32
ds_read_b64_tr_b16 a[6:7], v61 offset:416
ds_read_b64_tr_b16 a[8:9], v61 offset:64
ds_read_b64_tr_b16 a[10:11], v61 offset:448
ds_read_b64_tr_b16 a[12:13], v61 offset:3072
ds_read_b64_tr_b16 a[14:15], v61 offset:3456
ds_read_b64_tr_b16 a[16:17], v61 offset:3104
ds_read_b64_tr_b16 a[18:19], v61 offset:3488
ds_read_b64_tr_b16 a[20:21], v61 offset:3136
ds_read_b64_tr_b16 a[22:23], v61 offset:3520
ds_read_b64_tr_b16 a[24:25], v61 offset:6144
ds_read_b64_tr_b16 a[26:27], v61 offset:6528
ds_read_b64_tr_b16 a[28:29], v61 offset:6176
ds_read_b64_tr_b16 a[30:31], v61 offset:6560
ds_read_b64_tr_b16 a[32:33], v61 offset:6208
ds_read_b64_tr_b16 a[34:35], v61 offset:6592
ds_read_b64_tr_b16 a[36:37], v61 offset:9216
ds_read_b64_tr_b16 a[38:39], v61 offset:9600
ds_read_b64_tr_b16 a[40:41], v61 offset:9248
ds_read_b64_tr_b16 a[42:43], v61 offset:9632
ds_read_b64_tr_b16 a[44:45], v61 offset:9280
ds_read_b64_tr_b16 a[46:47], v61 offset:9664
ds_read_b64_tr_b16 a[48:49], v61 offset:12288
ds_read_b64_tr_b16 a[50:51], v61 offset:12672
ds_read_b64_tr_b16 a[52:53], v61 offset:12320
ds_read_b64_tr_b16 a[54:55], v61 offset:12704
ds_read_b64_tr_b16 a[56:57], v61 offset:12352
ds_read_b64_tr_b16 a[58:59], v61 offset:12736
ds_read_b64_tr_b16 a[60:61], v61 offset:15360
ds_read_b64_tr_b16 a[62:63], v61 offset:15744
ds_read_b64_tr_b16 a[64:65], v61 offset:15392
ds_read_b64_tr_b16 a[66:67], v61 offset:15776
ds_read_b64_tr_b16 a[68:69], v61 offset:15424
ds_read_b64_tr_b16 a[70:71], v61 offset:15808
s_waitcnt lgkmcnt(0)
s_add_u32 m0, s28, 0
s_mov_b32 s26, 497664
buffer_load_dwordx4 v56, s[8:11], s26 offen lds
s_add_u32 m0, s28, 1024
s_mov_b32 s26, 497664
buffer_load_dwordx4 v57, s[8:11], s26 offen lds
s_add_u32 m0, s28, 2048
s_mov_b32 s26, 497664
buffer_load_dwordx4 v58, s[8:11], s26 offen lds
s_add_u32 m0, s28, 3072
s_mov_b32 s26, 539136
buffer_load_dwordx4 v56, s[8:11], s26 offen lds
s_add_u32 m0, s28, 4096
s_mov_b32 s26, 539136
buffer_load_dwordx4 v57, s[8:11], s26 offen lds
s_add_u32 m0, s28, 5120
s_mov_b32 s26, 539136
buffer_load_dwordx4 v58, s[8:11], s26 offen lds
s_add_u32 m0, s28, 6144
s_mov_b32 s26, 580608
buffer_load_dwordx4 v56, s[8:11], s26 offen lds
s_add_u32 m0, s28, 7168
s_mov_b32 s26, 580608
buffer_load_dwordx4 v57, s[8:11], s26 offen lds
s_add_u32 m0, s28, 8192
s_mov_b32 s26, 580608
buffer_load_dwordx4 v58, s[8:11], s26 offen lds
s_add_u32 m0, s28, 9216
s_mov_b32 s26, 622080
buffer_load_dwordx4 v56, s[8:11], s26 offen lds
s_add_u32 m0, s28, 10240
s_mov_b32 s26, 622080
buffer_load_dwordx4 v57, s[8:11], s26 offen lds
s_add_u32 m0, s28, 11264
s_mov_b32 s26, 622080
buffer_load_dwordx4 v58, s[8:11], s26 offen lds
s_add_u32 m0, s28, 12288
s_mov_b32 s26, 0
buffer_load_dwordx4 v64, s[8:11], s26 offen lds
s_add_u32 m0, s28, 13312
s_mov_b32 s26, 0
buffer_load_dwordx4 v65, s[8:11], s26 offen lds
s_add_u32 m0, s28, 14336
s_mov_b32 s26, 0
buffer_load_dwordx4 v66, s[8:11], s26 offen lds
s_add_u32 m0, s28, 15360
s_mov_b32 s26, 331776
buffer_load_dwordx4 v64, s[8:11], s26 offen lds
s_add_u32 m0, s28, 16384
s_mov_b32 s26, 331776
buffer_load_dwordx4 v65, s[8:11], s26 offen lds
s_add_u32 m0, s28, 17408
s_mov_b32 s26, 331776
buffer_load_dwordx4 v66, s[8:11], s26 offen lds
s_waitcnt vmcnt(18)
ds_read_b64_tr_b16 a[72:73], v61 offset:18432
ds_read_b64_tr_b16 a[74:75], v61 offset:18816
ds_read_b64_tr_b16 a[76:77], v61 offset:18464
ds_read_b64_tr_b16 a[78:79], v61 offset:18848
ds_read_b64_tr_b16 a[80:81], v61 offset:18496
ds_read_b64_tr_b16 a[82:83], v61 offset:18880
ds_read_b64_tr_b16 a[84:85], v61 offset:21504
ds_read_b64_tr_b16 a[86:87], v61 offset:21888
ds_read_b64_tr_b16 a[88:89], v61 offset:21536
ds_read_b64_tr_b16 a[90:91], v61 offset:21920
ds_read_b64_tr_b16 a[92:93], v61 offset:21568
ds_read_b64_tr_b16 a[94:95], v61 offset:21952
ds_read_b64_tr_b16 a[96:97], v61 offset:24576
ds_read_b64_tr_b16 a[98:99], v61 offset:24960
ds_read_b64_tr_b16 a[100:101], v61 offset:24608
ds_read_b64_tr_b16 a[102:103], v61 offset:24992
ds_read_b64_tr_b16 a[104:105], v61 offset:24640
ds_read_b64_tr_b16 a[106:107], v61 offset:25024
ds_read_b64_tr_b16 a[108:109], v61 offset:27648
ds_read_b64_tr_b16 a[110:111], v61 offset:28032
ds_read_b64_tr_b16 a[112:113], v61 offset:27680
ds_read_b64_tr_b16 a[114:115], v61 offset:28064
ds_read_b64_tr_b16 a[116:117], v61 offset:27712
ds_read_b64_tr_b16 a[118:119], v61 offset:28096
ds_read_b64_tr_b16 a[120:121], v61 offset:30720
ds_read_b64_tr_b16 a[122:123], v61 offset:31104
ds_read_b64_tr_b16 a[124:125], v61 offset:30752
ds_read_b64_tr_b16 a[126:127], v61 offset:31136
ds_read_b64_tr_b16 a[128:129], v61 offset:30784
ds_read_b64_tr_b16 a[130:131], v61 offset:31168
ds_read_b64_tr_b16 a[132:133], v61 offset:33792
ds_read_b64_tr_b16 a[134:135], v61 offset:34176
ds_read_b64_tr_b16 a[136:137], v61 offset:33824
ds_read_b64_tr_b16 a[138:139], v61 offset:34208
ds_read_b64_tr_b16 a[140:141], v61 offset:33856
ds_read_b64_tr_b16 a[142:143], v61 offset:34240
s_waitcnt lgkmcnt(0)
s_waitcnt vmcnt(0)
ds_read_b64_tr_b16 a[144:145], v61 offset:0
ds_read_b64_tr_b16 a[146:147], v61 offset:384
ds_read_b64_tr_b16 a[148:149], v61 offset:32
ds_read_b64_tr_b16 a[150:151], v61 offset:416
ds_read_b64_tr_b16 a[152:153], v61 offset:64
ds_read_b64_tr_b16 a[154:155], v61 offset:448
ds_read_b64_tr_b16 a[156:157], v61 offset:3072
ds_read_b64_tr_b16 a[158:159], v61 offset:3456
ds_read_b64_tr_b16 a[160:161], v61 offset:3104
ds_read_b64_tr_b16 a[162:163], v61 offset:3488
ds_read_b64_tr_b16 a[164:165], v61 offset:3136
ds_read_b64_tr_b16 a[166:167], v61 offset:3520
ds_read_b64_tr_b16 a[168:169], v61 offset:6144
ds_read_b64_tr_b16 a[170:171], v61 offset:6528
ds_read_b64_tr_b16 a[172:173], v61 offset:6176
ds_read_b64_tr_b16 a[174:175], v61 offset:6560
ds_read_b64_tr_b16 a[176:177], v61 offset:6208
ds_read_b64_tr_b16 a[178:179], v61 offset:6592
ds_read_b64_tr_b16 a[180:181], v61 offset:9216
ds_read_b64_tr_b16 a[182:183], v61 offset:9600
ds_read_b64_tr_b16 a[184:185], v61 offset:9248
ds_read_b64_tr_b16 a[186:187], v61 offset:9632
ds_read_b64_tr_b16 a[188:189], v61 offset:9280
ds_read_b64_tr_b16 a[190:191], v61 offset:9664
ds_read_b64_tr_b16 a[192:193], v61 offset:12288
ds_read_b64_tr_b16 a[194:195], v61 offset:12672
ds_read_b64_tr_b16 a[196:197], v61 offset:12320
ds_read_b64_tr_b16 a[198:199], v61 offset:12704
ds_read_b64_tr_b16 a[200:201], v61 offset:12352
ds_read_b64_tr_b16 a[202:203], v61 offset:12736
ds_read_b64_tr_b16 a[204:205], v61 offset:15360
ds_read_b64_tr_b16 a[206:207], v61 offset:15744
ds_read_b64_tr_b16 a[208:209], v61 offset:15392
ds_read_b64_tr_b16 a[210:211], v61 offset:15776
ds_read_b64_tr_b16 a[212:213], v61 offset:15424
ds_read_b64_tr_b16 a[214:215], v61 offset:15808
s_waitcnt lgkmcnt(0)
v_mov_b32 v4, 128
s_mov_b32 s29, 0
Lwf16:
buffer_load_dword v5, v4, s[16:19], 0 offen sc1
s_add_u32 s29, s29, 1
s_waitcnt vmcnt(0)
v_cmp_eq_u32 vcc, 0, v5
s_cbranch_vccz Lwd17
s_sleep 2
s_cmp_lt_u32 s29, s25
s_cbranch_scc1 Lwf16
s_mov_b32 s25, 0
Lwd17:
v_and_b32 v50, 15, v0
v_lshrrev_b32 v51, 4, v0
v_mul_u32_u24 v2, 1152, v50
v_lshl_add_u32 v2, v51, 3, v2
v_add_u32 v2, s35, v2
v_add_u32 v3, 18432, v2
v_mul_u32_u24 v5, 12, v0
v_and_b32 v51, 1, v51
v_cmp_eq_u32 s[44:45], 1, v51
v_min_u32 v4, 7, v0
v_lshlrev_b32 v4, 7, v4
s_and_b32 s26, s24, 1
s_cselect_b32 s46, 0, -1
s_cselect_b32 s47, -1, 0
s_lshl_b32 s26, s24, 12
v_add_u32 v6, s26, v1
s_lshr_b32 s26, s24, 1
s_lshl_b32 s26, s26, 10
v_add_u32 v208, s26, v1
s_mov_b32 s36, 0
s_barrier
v_add_u32 v236, 0, v0
v_mul_u32_u24 v237, 10923, v236
v_lshrrev_b32 v237, 16, v237
v_mul_u32_u24 v238, 6, v237
v_sub_u32 v238, v236, v238
v_mul_u32_u24 v237, 1152, v237
v_lshl_add_u32 v237, v238, 4, v237
v_add_u32 v230, s35, v237
v_add_u32 v236, 64, v0
v_mul_u32_u24 v237, 10923, v236
v_lshrrev_b32 v237, 16, v237
v_mul_u32_u24 v238, 6, v237
v_sub_u32 v238, v236, v238
v_mul_u32_u24 v237, 1152, v237
v_lshl_add_u32 v237, v238, 4, v237
v_add_u32 v231, s35, v237
v_add_u32 v236, 128, v0
v_mul_u32_u24 v237, 10923, v236
v_lshrrev_b32 v237, 16, v237
v_mul_u32_u24 v238, 6, v237
v_sub_u32 v238, v236, v238
v_mul_u32_u24 v237, 1152, v237
v_lshl_add_u32 v237, v238, 4, v237
v_add_u32 v232, s35, v237
s_mul_i32 s26, s24, 3072
s_add_u32 s26, s26, 40960
v_add_u32 v233, s26, v1
v_mul_u32_u24 v234, 96, v50
v_lshrrev_b32 v236, 4, v0
v_lshl_add_u32 v234, v236, 3, v234
v_add_u32 v234, s26, v234
v_mov_b32 v75, 0
v_mov_b32 v79, 0
v_mov_b32 v83, 0
v_mov_b32 v87, 0
v_mov_b32 v91, 0
v_mov_b32 v95, 0
v_mov_b32 v99, 0
v_mov_b32 v103, 0
v_mov_b32 v107, 0
v_mov_b32 v111, 0
v_mov_b32 v115, 0
v_mov_b32 v119, 0
v_mov_b32 v123, 0
v_mov_b32 v127, 0
v_mov_b32 v131, 0
v_mov_b32 v135, 0
P2_layer:
s_lshl_b32 s41, s36, 2
s_add_u32 s41, s41, 61440
s_mov_b32 s29, 0
Lwf18:
buffer_load_dword v200, v4, s[4:7], s41 offen sc1
s_add_u32 s29, s29, 1
s_waitcnt vmcnt(0)
v_cmp_eq_u32 vcc, 0, v200
s_cbranch_vccz Lwd19
s_sleep 2
s_cmp_lt_u32 s29, s25
s_cbranch_scc1 Lwf18
s_mov_b32 s25, 0
Lwd19:
s_mul_i32 s41, s36, 65536
s_lshl_b32 s26, s24, 14
s_add_u32 s41, s41, s26
s_add_u32 s41, s41, 9437184
buffer_load_dwordx4 v[8:11], v1, s[4:7], s41 offen offset:0 sc1
buffer_load_dwordx4 v[12:15], v1, s[4:7], s41 offen offset:1024 sc1
buffer_load_dwordx4 v[16:19], v1, s[4:7], s41 offen offset:2048 sc1
buffer_load_dwordx4 v[20:23], v1, s[4:7], s41 offen offset:3072 sc1
s_add_u32 s41, s41, 4096
buffer_load_dwordx4 v[24:27], v1, s[4:7], s41 offen offset:0 sc1
buffer_load_dwordx4 v[28:31], v1, s[4:7], s41 offen offset:1024 sc1
buffer_load_dwordx4 v[32:35], v1, s[4:7], s41 offen offset:2048 sc1
buffer_load_dwordx4 v[36:39], v1, s[4:7], s41 offen offset:3072 sc1
s_add_u32 s41, s41, 4096
buffer_load_dwordx4 v[40:43], v1, s[4:7], s41 offen offset:0 sc1
buffer_load_dwordx4 v[44:47], v1, s[4:7], s41 offen offset:1024 sc1
buffer_load_dwordx4 v[48:51], v1, s[4:7], s41 offen offset:2048 sc1
buffer_load_dwordx4 v[52:55], v1, s[4:7], s41 offen offset:3072 sc1
s_add_u32 s41, s41, 4096
buffer_load_dwordx4 v[56:59], v1, s[4:7], s41 offen offset:0 sc1
buffer_load_dwordx4 v[60:63], v1, s[4:7], s41 offen offset:1024 sc1
buffer_load_dwordx4 v[64:67], v1, s[4:7], s41 offen offset:2048 sc1
buffer_load_dwordx4 v[68:71], v1, s[4:7], s41 offen offset:3072 sc1
s_add_u32 s41, s41, 4096
s_mov_b32 s37, s32
P2_seg:
s_lshl_b32 s41, s37, 2
s_add_u32 s41, s41, s24
s_mul_i32 s41, s41, 12288
s_mul_i32 s26, s36, 3145728
s_add_u32 s41, s41, s26
s_add_u32 s41, s41, 10485760
buffer_load_dwordx3 v[72:74], v5, s[4:7], s41 offen offset:0 sc1
buffer_load_dwordx3 v[76:78], v5, s[4:7], s41 offen offset:768 sc1
buffer_load_dwordx3 v[80:82], v5, s[4:7], s41 offen offset:1536 sc1
buffer_load_dwordx3 v[84:86], v5, s[4:7], s41 offen offset:2304 sc1
s_add_u32 s41, s41, 3072
buffer_load_dwordx3 v[88:90], v5, s[4:7], s41 offen offset:0 sc1
buffer_load_dwordx3 v[92:94], v5, s[4:7], s41 offen offset:768 sc1
buffer_load_dwordx3 v[96:98], v5, s[4:7], s41 offen offset:1536 sc1
buffer_load_dwordx3 v[100:102], v5, s[4:7], s41 offen offset:2304 sc1
s_add_u32 s41, s41, 3072
buffer_load_dwordx3 v[104:106], v5, s[4:7], s41 offen offset:0 sc1
buffer_load_dwordx3 v[108:110], v5, s[4:7], s41 offen offset:768 sc1
buffer_load_dwordx3 v[112:114], v5, s[4:7], s41 offen offset:1536 sc1
buffer_load_dwordx3 v[116:118], v5, s[4:7], s41 offen offset:2304 sc1
s_add_u32 s41, s41, 3072
buffer_load_dwordx3 v[120:122], v5, s[4:7], s41 offen offset:0 sc1
buffer_load_dwordx3 v[124:126], v5, s[4:7], s41 offen offset:768 sc1
buffer_load_dwordx3 v[128:130], v5, s[4:7], s41 offen offset:1536 sc1
buffer_load_dwordx3 v[132:134], v5, s[4:7], s41 offen offset:2304 sc1
s_add_u32 s41, s41, 3072
s_mul_i32 s42, s37, 36864
s_cmp_eq_u32 s36, 0
s_cbranch_scc0 P2_x2
buffer_load_dwordx2 v[136:137], v2, s[12:15], s42 offen offset:0
buffer_load_dwordx2 v[138:139], v2, s[12:15], s42 offen offset:32
buffer_load_dwordx2 v[140:141], v2, s[12:15], s42 offen offset:64
buffer_load_dwordx2 v[142:143], v3, s[12:15], s42 offen offset:0
buffer_load_dwordx2 v[144:145], v3, s[12:15], s42 offen offset:32
buffer_load_dwordx2 v[146:147], v3, s[12:15], s42 offen offset:64
s_branch P2_xd
P2_x2:
s_add_u32 s41, s42, 21495808
buffer_load_dwordx2 v[136:137], v2, s[4:7], s41 offen offset:0 sc1
buffer_load_dwordx2 v[138:139], v2, s[4:7], s41 offen offset:32 sc1
buffer_load_dwordx2 v[140:141], v2, s[4:7], s41 offen offset:64 sc1
buffer_load_dwordx2 v[142:143], v3, s[4:7], s41 offen offset:0 sc1
buffer_load_dwordx2 v[144:145], v3, s[4:7], s41 offen offset:32 sc1
buffer_load_dwordx2 v[146:147], v3, s[4:7], s41 offen offset:64 sc1
P2_xd:
s_waitcnt vmcnt(21)
v_mfma_f32_16x16x32_bf16 v[168:171], v[8:11], v[72:75], 0
v_mfma_f32_16x16x32_bf16 v[172:175], v[12:15], v[72:75], 0
s_waitcnt vmcnt(20)
v_mfma_f32_16x16x32_bf16 v[176:179], v[8:11], v[76:79], 0
v_mfma_f32_16x16x32_bf16 v[180:183], v[12:15], v[76:79], 0
s_waitcnt vmcnt(19)
v_mfma_f32_16x16x32_bf16 v[184:187], v[16:19], v[80:83], 0
v_mfma_f32_16x16x32_bf16 v[188:191], v[20:23], v[80:83], 0
s_nop 1
v_add_f32 v172, 0x358637bd, v172
v_rcp_f32 v172, v172
s_nop 0
v_mul_f32 v168, v168, v172
v_mul_f32 v169, v169, v172
v_mul_f32 v170, v170, v172
v_mul_f32 v171, v171, v172
v_mul_f32 v173, v173, v172
v_mul_f32 v174, v174, v172
v_cvt_pk_bf16_f32 v192, v168, v169
v_cvt_pk_bf16_f32 v193, v170, v171
v_cvt_pk_bf16_f32 v148, v173, v174
s_waitcnt vmcnt(18)
v_mfma_f32_16x16x32_bf16 v[168:171], v[16:19], v[84:87], 0
v_mfma_f32_16x16x32_bf16 v[172:175], v[20:23], v[84:87], 0
v_add_f32 v180, 0x358637bd, v180
v_rcp_f32 v180, v180
s_nop 0
v_mul_f32 v176, v176, v180
v_mul_f32 v177, v177, v180
v_mul_f32 v178, v178, v180
v_mul_f32 v179, v179, v180
v_mul_f32 v181, v181, v180
v_mul_f32 v182, v182, v180
v_cvt_pk_bf16_f32 v196, v176, v177
v_cvt_pk_bf16_f32 v197, v178, v179
v_cvt_pk_bf16_f32 v156, v181, v182
s_waitcnt vmcnt(17)
v_mfma_f32_16x16x32_bf16 v[176:179], v[24:27], v[88:91], 0
v_mfma_f32_16x16x32_bf16 v[180:183], v[28:31], v[88:91], 0
v_add_f32 v188, 0x358637bd, v188
v_rcp_f32 v188, v188
s_nop 0
v_mul_f32 v184, v184, v188
v_mul_f32 v185, v185, v188
v_mul_f32 v186, v186, v188
v_mul_f32 v187, v187, v188
v_mul_f32 v189, v189, v188
v_mul_f32 v190, v190, v188
v_cvt_pk_bf16_f32 v194, v184, v185
v_cvt_pk_bf16_f32 v195, v186, v187
v_cvt_pk_bf16_f32 v149, v189, v190
ds_write_b128 v6, v[192:195] offset:0
s_waitcnt vmcnt(16)
v_mfma_f32_16x16x32_bf16 v[184:187], v[24:27], v[92:95], 0
v_mfma_f32_16x16x32_bf16 v[188:191], v[28:31], v[92:95], 0
v_add_f32 v172, 0x358637bd, v172
v_rcp_f32 v172, v172
s_nop 0
v_mul_f32 v168, v168, v172
v_mul_f32 v169, v169, v172
v_mul_f32 v170, v170, v172
v_mul_f32 v171, v171, v172
v_mul_f32 v173, v173, v172
v_mul_f32 v174, v174, v172
v_cvt_pk_bf16_f32 v198, v168, v169
v_cvt_pk_bf16_f32 v199, v170, v171
v_cvt_pk_bf16_f32 v157, v173, v174
ds_write_b128 v6, v[196:199] offset:18432
s_waitcnt vmcnt(15)
v_mfma_f32_16x16x32_bf16 v[168:171], v[32:35], v[96:99], 0
v_mfma_f32_16x16x32_bf16 v[172:175], v[36:39], v[96:99], 0
v_add_f32 v180, 0x358637bd, v180
v_rcp_f32 v180, v180
s_nop 0
v_mul_f32 v176, v176, v180
v_mul_f32 v177, v177, v180
v_mul_f32 v178, v178, v180
v_mul_f32 v179, v179, v180
v_mul_f32 v181, v181, v180
v_mul_f32 v182, v182, v180
v_cvt_pk_bf16_f32 v192, v176, v177
v_cvt_pk_bf16_f32 v193, v178, v179
v_cvt_pk_bf16_f32 v150, v181, v182
s_waitcnt vmcnt(14)
v_mfma_f32_16x16x32_bf16 v[176:179], v[32:35], v[100:103], 0
v_mfma_f32_16x16x32_bf16 v[180:183], v[36:39], v[100:103], 0
v_add_f32 v188, 0x358637bd, v188
v_rcp_f32 v188, v188
s_nop 0
v_mul_f32 v184, v184, v188
v_mul_f32 v185, v185, v188
v_mul_f32 v186, v186, v188
v_mul_f32 v187, v187, v188
v_mul_f32 v189, v189, v188
v_mul_f32 v190, v190, v188
v_cvt_pk_bf16_f32 v196, v184, v185
v_cvt_pk_bf16_f32 v197, v186, v187
v_cvt_pk_bf16_f32 v158, v189, v190
s_waitcnt vmcnt(13)
v_mfma_f32_16x16x32_bf16 v[184:187], v[40:43], v[104:107], 0
v_mfma_f32_16x16x32_bf16 v[188:191], v[44:47], v[104:107], 0
v_add_f32 v172, 0x358637bd, v172
v_rcp_f32 v172, v172
s_nop 0
v_mul_f32 v168, v168, v172
v_mul_f32 v169, v169, v172
v_mul_f32 v170, v170, v172
v_mul_f32 v171, v171, v172
v_mul_f32 v173, v173, v172
v_mul_f32 v174, v174, v172
v_cvt_pk_bf16_f32 v194, v168, v169
v_cvt_pk_bf16_f32 v195, v170, v171
v_cvt_pk_bf16_f32 v151, v173, v174
ds_write_b128 v6, v[192:195] offset:1024
s_waitcnt vmcnt(12)
v_mfma_f32_16x16x32_bf16 v[168:171], v[40:43], v[108:111], 0
v_mfma_f32_16x16x32_bf16 v[172:175], v[44:47], v[108:111], 0
v_add_f32 v180, 0x358637bd, v180
v_rcp_f32 v180, v180
s_nop 0
v_mul_f32 v176, v176, v180
v_mul_f32 v177, v177, v180
v_mul_f32 v178, v178, v180
v_mul_f32 v179, v179, v180
v_mul_f32 v181, v181, v180
v_mul_f32 v182, v182, v180
v_cvt_pk_bf16_f32 v198, v176, v177
v_cvt_pk_bf16_f32 v199, v178, v179
v_cvt_pk_bf16_f32 v159, v181, v182
ds_write_b128 v6, v[196:199] offset:19456
s_waitcnt vmcnt(11)
v_mfma_f32_16x16x32_bf16 v[176:179], v[48:51], v[112:115], 0
v_mfma_f32_16x16x32_bf16 v[180:183], v[52:55], v[112:115], 0
v_add_f32 v188, 0x358637bd, v188
v_rcp_f32 v188, v188
s_nop 0
v_mul_f32 v184, v184, v188
v_mul_f32 v185, v185, v188
v_mul_f32 v186, v186, v188
v_mul_f32 v187, v187, v188
v_mul_f32 v189, v189, v188
v_mul_f32 v190, v190, v188
v_cvt_pk_bf16_f32 v192, v184, v185
v_cvt_pk_bf16_f32 v193, v186, v187
v_cvt_pk_bf16_f32 v152, v189, v190
s_waitcnt vmcnt(10)
v_mfma_f32_16x16x32_bf16 v[184:187], v[48:51], v[116:119], 0
v_mfma_f32_16x16x32_bf16 v[188:191], v[52:55], v[116:119], 0
v_add_f32 v172, 0x358637bd, v172
v_rcp_f32 v172, v172
s_nop 0
v_mul_f32 v168, v168, v172
v_mul_f32 v169, v169, v172
v_mul_f32 v170, v170, v172
v_mul_f32 v171, v171, v172
v_mul_f32 v173, v173, v172
v_mul_f32 v174, v174, v172
v_cvt_pk_bf16_f32 v196, v168, v169
v_cvt_pk_bf16_f32 v197, v170, v171
v_cvt_pk_bf16_f32 v160, v173, v174
s_waitcnt vmcnt(9)
v_mfma_f32_16x16x32_bf16 v[168:171], v[56:59], v[120:123], 0
v_mfma_f32_16x16x32_bf16 v[172:175], v[60:63], v[120:123], 0
v_add_f32 v180, 0x358637bd, v180
v_rcp_f32 v180, v180
s_nop 0
v_mul_f32 v176, v176, v180
v_mul_f32 v177, v177, v180
v_mul_f32 v178, v178, v180
v_mul_f32 v179, v179, v180
v_mul_f32 v181, v181, v180
v_mul_f32 v182, v182, v180
v_cvt_pk_bf16_f32 v194, v176, v177
v_cvt_pk_bf16_f32 v195, v178, v179
v_cvt_pk_bf16_f32 v153, v181, v182
ds_write_b128 v6, v[192:195] offset:2048
s_waitcnt vmcnt(8)
v_mfma_f32_16x16x32_bf16 v[176:179], v[56:59], v[124:127], 0
v_mfma_f32_16x16x32_bf16 v[180:183], v[60:63], v[124:127], 0
v_add_f32 v188, 0x358637bd, v188
v_rcp_f32 v188, v188
s_nop 0
v_mul_f32 v184, v184, v188
v_mul_f32 v185, v185, v188
v_mul_f32 v186, v186, v188
v_mul_f32 v187, v187, v188
v_mul_f32 v189, v189, v188
v_mul_f32 v190, v190, v188
v_cvt_pk_bf16_f32 v198, v184, v185
v_cvt_pk_bf16_f32 v199, v186, v187
v_cvt_pk_bf16_f32 v161, v189, v190
ds_write_b128 v6, v[196:199] offset:20480
s_waitcnt vmcnt(7)
v_mfma_f32_16x16x32_bf16 v[184:187], v[64:67], v[128:131], 0
v_mfma_f32_16x16x32_bf16 v[188:191], v[68:71], v[128:131], 0
v_add_f32 v172, 0x358637bd, v172
v_rcp_f32 v172, v172
s_nop 0
v_mul_f32 v168, v168, v172
v_mul_f32 v169, v169, v172
v_mul_f32 v170, v170, v172
v_mul_f32 v171, v171, v172
v_mul_f32 v173, v173, v172
v_mul_f32 v174, v174, v172
v_cvt_pk_bf16_f32 v192, v168, v169
v_cvt_pk_bf16_f32 v193, v170, v171
v_cvt_pk_bf16_f32 v154, v173, v174
s_waitcnt vmcnt(6)
v_mfma_f32_16x16x32_bf16 v[168:171], v[64:67], v[132:135], 0
v_mfma_f32_16x16x32_bf16 v[172:175], v[68:71], v[132:135], 0
v_add_f32 v180, 0x358637bd, v180
v_rcp_f32 v180, v180
s_nop 0
v_mul_f32 v176, v176, v180
v_mul_f32 v177, v177, v180
v_mul_f32 v178, v178, v180
v_mul_f32 v179, v179, v180
v_mul_f32 v181, v181, v180
v_mul_f32 v182, v182, v180
v_cvt_pk_bf16_f32 v196, v176, v177
v_cvt_pk_bf16_f32 v197, v178, v179
v_cvt_pk_bf16_f32 v162, v181, v182
v_add_f32 v188, 0x358637bd, v188
v_rcp_f32 v188, v188
s_nop 0
v_mul_f32 v184, v184, v188
v_mul_f32 v185, v185, v188
v_mul_f32 v186, v186, v188
v_mul_f32 v187, v187, v188
v_mul_f32 v189, v189, v188
v_mul_f32 v190, v190, v188
v_cvt_pk_bf16_f32 v194, v184, v185
v_cvt_pk_bf16_f32 v195, v186, v187
v_cvt_pk_bf16_f32 v155, v189, v190
ds_write_b128 v6, v[192:195] offset:3072
v_add_f32 v172, 0x358637bd, v172
v_rcp_f32 v172, v172
s_nop 0
v_mul_f32 v168, v168, v172
v_mul_f32 v169, v169, v172
v_mul_f32 v170, v170, v172
v_mul_f32 v171, v171, v172
v_mul_f32 v173, v173, v172
v_mul_f32 v174, v174, v172
v_cvt_pk_bf16_f32 v198, v168, v169
v_cvt_pk_bf16_f32 v199, v170, v171
v_cvt_pk_bf16_f32 v163, v173, v174
ds_write_b128 v6, v[196:199] offset:21504
v_cndmask_b32 v200, v148, v152, s[44:45]
v_cndmask_b32 v201, v149, v153, s[44:45]
v_cndmask_b32 v202, v150, v154, s[44:45]
v_cndmask_b32 v203, v151, v155, s[44:45]
v_cndmask_b32 v204, v156, v160, s[44:45]
v_cndmask_b32 v205, v157, v161, s[44:45]
v_cndmask_b32 v206, v158, v162, s[44:45]
v_cndmask_b32 v207, v159, v163, s[44:45]
s_mov_b64 exec, s[46:47]
ds_write_b128 v208, v[200:203] offset:16384
ds_write_b128 v208, v[204:207] offset:34816
s_mov_b64 exec, -1
s_waitcnt lgkmcnt(0)
s_barrier
ds_read_b128 v[212:215], v1 offset:0
ds_read_b128 v[216:219], v1 offset:18432
ds_read_b128 v[220:223], v1 offset:1024
ds_read_b128 v[224:227], v1 offset:19456
s_waitcnt lgkmcnt(2)
v_mfma_f32_16x16x32_bf16 v[168:171], a[0:3], v[212:215], 0
v_mfma_f32_16x16x32_bf16 v[172:175], a[4:7], v[212:215], 0
v_mfma_f32_16x16x32_bf16 v[176:179], a[8:11], v[212:215], 0
v_mfma_f32_16x16x32_bf16 v[180:183], a[0:3], v[216:219], 0
v_mfma_f32_16x16x32_bf16 v[184:187], a[4:7], v[216:219], 0
v_mfma_f32_16x16x32_bf16 v[188:191], a[8:11], v[216:219], 0
ds_read_b128 v[212:215], v1 offset:2048
ds_read_b128 v[216:219], v1 offset:20480
s_waitcnt lgkmcnt(2)
v_mfma_f32_16x16x32_bf16 v[168:171], a[12:15], v[220:223], v[168:171]
v_mfma_f32_16x16x32_bf16 v[172:175], a[16:19], v[220:223], v[172:175]
v_mfma_f32_16x16x32_bf16 v[176:179], a[20:23], v[220:223], v[176:179]
v_mfma_f32_16x16x32_bf16 v[180:183], a[12:15], v[224:227], v[180:183]
v_mfma_f32_16x16x32_bf16 v[184:187], a[16:19], v[224:227], v[184:187]
v_mfma_f32_16x16x32_bf16 v[188:191], a[20:23], v[224:227], v[188:191]
ds_read_b128 v[220:223], v1 offset:3072
ds_read_b128 v[224:227], v1 offset:21504
s_waitcnt lgkmcnt(2)
v_mfma_f32_16x16x32_bf16 v[168:171], a[24:27], v[212:215], v[168:171]
v_mfma_f32_16x16x32_bf16 v[172:175], a[28:31], v[212:215], v[172:175]
v_mfma_f32_16x16x32_bf16 v[176:179], a[32:35], v[212:215], v[176:179]
v_mfma_f32_16x16x32_bf16 v[180:183], a[24:27], v[216:219], v[180:183]
v_mfma_f32_16x16x32_bf16 v[184:187], a[28:31], v[216:219], v[184:187]
v_mfma_f32_16x16x32_bf16 v[188:191], a[32:35], v[216:219], v[188:191]
ds_read_b128 v[212:215], v1 offset:4096
ds_read_b128 v[216:219], v1 offset:22528
s_waitcnt lgkmcnt(2)
v_mfma_f32_16x16x32_bf16 v[168:171], a[36:39], v[220:223], v[168:171]
v_mfma_f32_16x16x32_bf16 v[172:175], a[40:43], v[220:223], v[172:175]
v_mfma_f32_16x16x32_bf16 v[176:179], a[44:47], v[220:223], v[176:179]
v_mfma_f32_16x16x32_bf16 v[180:183], a[36:39], v[224:227], v[180:183]
v_mfma_f32_16x16x32_bf16 v[184:187], a[40:43], v[224:227], v[184:187]
v_mfma_f32_16x16x32_bf16 v[188:191], a[44:47], v[224:227], v[188:191]
ds_read_b128 v[220:223], v1 offset:5120
ds_read_b128 v[224:227], v1 offset:23552
s_waitcnt lgkmcnt(2)
v_mfma_f32_16x16x32_bf16 v[168:171], a[48:51], v[212:215], v[168:171]
v_mfma_f32_16x16x32_bf16 v[172:175], a[52:55], v[212:215], v[172:175]
v_mfma_f32_16x16x32_bf16 v[176:179], a[56:59], v[212:215], v[176:179]
v_mfma_f32_16x16x32_bf16 v[180:183], a[48:51], v[216:219], v[180:183]
v_mfma_f32_16x16x32_bf16 v[184:187], a[52:55], v[216:219], v[184:187]
v_mfma_f32_16x16x32_bf16 v[188:191], a[56:59], v[216:219], v[188:191]
ds_read_b128 v[212:215], v1 offset:6144
ds_read_b128 v[216:219], v1 offset:24576
s_waitcnt lgkmcnt(2)
v_mfma_f32_16x16x32_bf16 v[168:171], a[60:63], v[220:223], v[168:171]
v_mfma_f32_16x16x32_bf16 v[172:175], a[64:67], v[220:223], v[172:175]
v_mfma_f32_16x16x32_bf16 v[176:179], a[68:71], v[220:223], v[176:179]
v_mfma_f32_16x16x32_bf16 v[180:183], a[60:63], v[224:227], v[180:183]
v_mfma_f32_16x16x32_bf16 v[184:187], a[64:67], v[224:227], v[184:187]
v_mfma_f32_16x16x32_bf16 v[188:191], a[68:71], v[224:227], v[188:191]
ds_read_b128 v[220:223], v1 offset:7168
ds_read_b128 v[224:227], v1 offset:25600
s_waitcnt lgkmcnt(2)
v_mfma_f32_16x16x32_bf16 v[168:171], a[72:75], v[212:215], v[168:171]
v_mfma_f32_16x16x32_bf16 v[172:175], a[76:79], v[212:215], v[172:175]
v_mfma_f32_16x16x32_bf16 v[176:179], a[80:83], v[212:215], v[176:179]
v_mfma_f32_16x16x32_bf16 v[180:183], a[72:75], v[216:219], v[180:183]
v_mfma_f32_16x16x32_bf16 v[184:187], a[76:79], v[216:219], v[184:187]
v_mfma_f32_16x16x32_bf16 v[188:191], a[80:83], v[216:219], v[188:191]
ds_read_b128 v[212:215], v1 offset:8192
ds_read_b128 v[216:219], v1 offset:26624
s_waitcnt lgkmcnt(2)
v_mfma_f32_16x16x32_bf16 v[168:171], a[84:87], v[220:223], v[168:171]
v_mfma_f32_16x16x32_bf16 v[172:175], a[88:91], v[220:223], v[172:175]
v_mfma_f32_16x16x32_bf16 v[176:179], a[92:95], v[220:223], v[176:179]
v_mfma_f32_16x16x32_bf16 v[180:183], a[84:87], v[224:227], v[180:183]
v_mfma_f32_16x16x32_bf16 v[184:187], a[88:91], v[224:227], v[184:187]
v_mfma_f32_16x16x32_bf16 v[188:191], a[92:95], v[224:227], v[188:191]
ds_read_b128 v[220:223], v1 offset:9216
ds_read_b128 v[224:227], v1 offset:27648
s_waitcnt lgkmcnt(2)
v_mfma_f32_16x16x32_bf16 v[168:171], a[96:99], v[212:215], v[168:171]
v_mfma_f32_16x16x32_bf16 v[172:175], a[100:103], v[212:215], v[172:175]
v_mfma_f32_16x16x32_bf16 v[176:179], a[104:107], v[212:215], v[176:179]
v_mfma_f32_16x16x32_bf16 v[180:183], a[96:99], v[216:219], v[180:183]
v_mfma_f32_16x16x32_bf16 v[184:187], a[100:103], v[216:219], v[184:187]
v_mfma_f32_16x16x32_bf16 v[188:191], a[104:107], v[216:219], v[188:191]
ds_read_b128 v[212:215], v1 offset:10240
ds_read_b128 v[216:219], v1 offset:28672
s_waitcnt lgkmcnt(2)
v_mfma_f32_16x16x32_bf16 v[168:171], a[108:111], v[220:223], v[168:171]
v_mfma_f32_16x16x32_bf16 v[172:175], a[112:115], v[220:223], v[172:175]
v_mfma_f32_16x16x32_bf16 v[176:179], a[116:119], v[220:223], v[176:179]
v_mfma_f32_16x16x32_bf16 v[180:183], a[108:111], v[224:227], v[180:183]
v_mfma_f32_16x16x32_bf16 v[184:187], a[112:115], v[224:227], v[184:187]
v_mfma_f32_16x16x32_bf16 v[188:191], a[116:119], v[224:227], v[188:191]
ds_read_b128 v[220:223], v1 offset:11264
ds_read_b128 v[224:227], v1 offset:29696
s_waitcnt lgkmcnt(2)
v_mfma_f32_16x16x32_bf16 v[168:171], a[120:123], v[212:215], v[168:171]
v_mfma_f32_16x16x32_bf16 v[172:175], a[124:127], v[212:215], v[172:175]
v_mfma_f32_16x16x32_bf16 v[176:179], a[128:131], v[212:215], v[176:179]
v_mfma_f32_16x16x32_bf16 v[180:183], a[120:123], v[216:219], v[180:183]
v_mfma_f32_16x16x32_bf16 v[184:187], a[124:127], v[216:219], v[184:187]
v_mfma_f32_16x16x32_bf16 v[188:191], a[128:131], v[216:219], v[188:191]
ds_read_b128 v[212:215], v1 offset:12288
ds_read_b128 v[216:219], v1 offset:30720
s_waitcnt lgkmcnt(2)
v_mfma_f32_16x16x32_bf16 v[168:171], a[132:135], v[220:223], v[168:171]
v_mfma_f32_16x16x32_bf16 v[172:175], a[136:139], v[220:223], v[172:175]
v_mfma_f32_16x16x32_bf16 v[176:179], a[140:143], v[220:223], v[176:179]
v_mfma_f32_16x16x32_bf16 v[180:183], a[132:135], v[224:227], v[180:183]
v_mfma_f32_16x16x32_bf16 v[184:187], a[136:139], v[224:227], v[184:187]
v_mfma_f32_16x16x32_bf16 v[188:191], a[140:143], v[224:227], v[188:191]
ds_read_b128 v[220:223], v1 offset:13312
ds_read_b128 v[224:227], v1 offset:31744
s_waitcnt lgkmcnt(2)
v_mfma_f32_16x16x32_bf16 v[168:171], a[144:147], v[212:215], v[168:171]
v_mfma_f32_16x16x32_bf16 v[172:175], a[148:151], v[212:215], v[172:175]
v_mfma_f32_16x16x32_bf16 v[176:179], a[152:155], v[212:215], v[176:179]
v_mfma_f32_16x16x32_bf16 v[180:183], a[144:147], v[216:219], v[180:183]
v_mfma_f32_16x16x32_bf16 v[184:187], a[148:151], v[216:219], v[184:187]
v_mfma_f32_16x16x32_bf16 v[188:191], a[152:155], v[216:219], v[188:191]
ds_read_b128 v[212:215], v1 offset:14336
ds_read_b128 v[216:219], v1 offset:32768
s_waitcnt lgkmcnt(2)
v_mfma_f32_16x16x32_bf16 v[168:171], a[156:159], v[220:223], v[168:171]
v_mfma_f32_16x16x32_bf16 v[172:175], a[160:163], v[220:223], v[172:175]
v_mfma_f32_16x16x32_bf16 v[176:179], a[164:167], v[220:223], v[176:179]
v_mfma_f32_16x16x32_bf16 v[180:183], a[156:159], v[224:227], v[180:183]
v_mfma_f32_16x16x32_bf16 v[184:187], a[160:163], v[224:227], v[184:187]
v_mfma_f32_16x16x32_bf16 v[188:191], a[164:167], v[224:227], v[188:191]
ds_read_b128 v[220:223], v1 offset:15360
ds_read_b128 v[224:227], v1 offset:33792
s_waitcnt lgkmcnt(2)
v_mfma_f32_16x16x32_bf16 v[168:171], a[168:171], v[212:215], v[168:171]
v_mfma_f32_16x16x32_bf16 v[172:175], a[172:175], v[212:215], v[172:175]
v_mfma_f32_16x16x32_bf16 v[176:179], a[176:179], v[212:215], v[176:179]
v_mfma_f32_16x16x32_bf16 v[180:183], a[168:171], v[216:219], v[180:183]
v_mfma_f32_16x16x32_bf16 v[184:187], a[172:175], v[216:219], v[184:187]
v_mfma_f32_16x16x32_bf16 v[188:191], a[176:179], v[216:219], v[188:191]
ds_read_b128 v[212:215], v1 offset:16384
ds_read_b128 v[216:219], v1 offset:34816
s_waitcnt lgkmcnt(2)
v_mfma_f32_16x16x32_bf16 v[168:171], a[180:183], v[220:223], v[168:171]
v_mfma_f32_16x16x32_bf16 v[172:175], a[184:187], v[220:223], v[172:175]
v_mfma_f32_16x16x32_bf16 v[176:179], a[188:191], v[220:223], v[176:179]
v_mfma_f32_16x16x32_bf16 v[180:183], a[180:183], v[224:227], v[180:183]
v_mfma_f32_16x16x32_bf16 v[184:187], a[184:187], v[224:227], v[184:187]
v_mfma_f32_16x16x32_bf16 v[188:191], a[188:191], v[224:227], v[188:191]
ds_read_b128 v[220:223], v1 offset:17408
ds_read_b128 v[224:227], v1 offset:35840
s_waitcnt lgkmcnt(2)
v_mfma_f32_16x16x32_bf16 v[168:171], a[192:195], v[212:215], v[168:171]
v_mfma_f32_16x16x32_bf16 v[172:175], a[196:199], v[212:215], v[172:175]
v_mfma_f32_16x16x32_bf16 v[176:179], a[200:203], v[212:215], v[176:179]
v_mfma_f32_16x16x32_bf16 v[180:183], a[192:195], v[216:219], v[180:183]
v_mfma_f32_16x16x32_bf16 v[184:187], a[196:199], v[216:219], v[184:187]
v_mfma_f32_16x16x32_bf16 v[188:191], a[200:203], v[216:219], v[188:191]
s_waitcnt lgkmcnt(0)
v_mfma_f32_16x16x32_bf16 v[168:171], a[204:207], v[220:223], v[168:171]
v_mfma_f32_16x16x32_bf16 v[172:175], a[208:211], v[220:223], v[172:175]
v_mfma_f32_16x16x32_bf16 v[176:179], a[212:215], v[220:223], v[176:179]
v_mfma_f32_16x16x32_bf16 v[180:183], a[204:207], v[224:227], v[180:183]
v_mfma_f32_16x16x32_bf16 v[184:187], a[208:211], v[224:227], v[184:187]
v_mfma_f32_16x16x32_bf16 v[188:191], a[212:215], v[224:227], v[188:191]
s_mul_i32 s26, s36, 2359296
s_add_u32 s41, s42, s26
s_add_u32 s41, s41, 16777216
s_waitcnt vmcnt(0)
v_lshlrev_b32 v192, 16, v136
v_and_b32 v193, 0xffff0000, v136
v_add_f32 v192, v192, v168
v_add_f32 v193, v193, v169
v_cvt_pk_bf16_f32 v136, v192, v193
v_lshlrev_b32 v192, 16, v137
v_and_b32 v193, 0xffff0000, v137
v_add_f32 v192, v192, v170
v_add_f32 v193, v193, v171
v_cvt_pk_bf16_f32 v137, v192, v193
ds_write_b64 v234, v[136:137] offset:0
v_lshlrev_b32 v192, 16, v138
v_and_b32 v193, 0xffff0000, v138
v_add_f32 v192, v192, v172
v_add_f32 v193, v193, v173
v_cvt_pk_bf16_f32 v138, v192, v193
v_lshlrev_b32 v192, 16, v139
v_and_b32 v193, 0xffff0000, v139
v_add_f32 v192, v192, v174
v_add_f32 v193, v193, v175
v_cvt_pk_bf16_f32 v139, v192, v193
ds_write_b64 v234, v[138:139] offset:32
v_lshlrev_b32 v192, 16, v140
v_and_b32 v193, 0xffff0000, v140
v_add_f32 v192, v192, v176
v_add_f32 v193, v193, v177
v_cvt_pk_bf16_f32 v140, v192, v193
v_lshlrev_b32 v192, 16, v141
v_and_b32 v193, 0xffff0000, v141
v_add_f32 v192, v192, v178
v_add_f32 v193, v193, v179
v_cvt_pk_bf16_f32 v141, v192, v193
ds_write_b64 v234, v[140:141] offset:64
v_lshlrev_b32 v192, 16, v142
v_and_b32 v193, 0xffff0000, v142
v_add_f32 v192, v192, v180
v_add_f32 v193, v193, v181
v_cvt_pk_bf16_f32 v142, v192, v193
v_lshlrev_b32 v192, 16, v143
v_and_b32 v193, 0xffff0000, v143
v_add_f32 v192, v192, v182
v_add_f32 v193, v193, v183
v_cvt_pk_bf16_f32 v143, v192, v193
ds_write_b64 v234, v[142:143] offset:1536
v_lshlrev_b32 v192, 16, v144
v_and_b32 v193, 0xffff0000, v144
v_add_f32 v192, v192, v184
v_add_f32 v193, v193, v185
v_cvt_pk_bf16_f32 v144, v192, v193
v_lshlrev_b32 v192, 16, v145
v_and_b32 v193, 0xffff0000, v145
v_add_f32 v192, v192, v186
v_add_f32 v193, v193, v187
v_cvt_pk_bf16_f32 v145, v192, v193
ds_write_b64 v234, v[144:145] offset:1568
v_lshlrev_b32 v192, 16, v146
v_and_b32 v193, 0xffff0000, v146
v_add_f32 v192, v192, v188
v_add_f32 v193, v193, v189
v_cvt_pk_bf16_f32 v146, v192, v193
v_lshlrev_b32 v192, 16, v147
v_and_b32 v193, 0xffff0000, v147
v_add_f32 v192, v192, v190
v_add_f32 v193, v193, v191
v_cvt_pk_bf16_f32 v147, v192, v193
ds_write_b64 v234, v[146:147] offset:1600
s_waitcnt lgkmcnt(0)
ds_read_b128 v[240:243], v233 offset:0
ds_read_b128 v[244:247], v233 offset:1024
ds_read_b128 v[248:251], v233 offset:2048
s_waitcnt lgkmcnt(2)
buffer_store_dwordx4 v[240:243], v230, s[4:7], s41 offen sc1
s_waitcnt lgkmcnt(1)
buffer_store_dwordx4 v[244:247], v231, s[4:7], s41 offen sc1
s_waitcnt lgkmcnt(0)
buffer_store_dwordx4 v[248:251], v232, s[4:7], s41 offen sc1
s_lshl_b32 s41, s36, 6
s_add_u32 s41, s41, s37
s_mul_i32 s26, s32, 3
s_add_u32 s26, s26, s33
s_lshl_b32 s26, s26, 7
s_add_u32 s41, s41, s26
s_lshl_b32 s41, s41, 2
s_add_u32 s41, s41, 49152
s_waitcnt vmcnt(0)
s_barrier
s_cmp_lg_u32 s24, 0
s_cbranch_scc1 Lsg20
v_mov_b32 v200, 1
s_mov_b64 exec, 1
buffer_store_dword v200, off, s[4:7], s41 sc1
s_mov_b64 exec, -1
Lsg20:
s_add_u32 s37, s37, 4
s_cmp_lt_u32 s37, 64
s_cbranch_scc1 P2_seg
s_add_u32 s36, s36, 1
s_cmp_lt_u32 s36, 2
s_cbranch_scc1 P2_layer
s_branch END
P4:
s_load_dwordx2 s[8:9], s[0:1], 64
s_mov_b32 s10, 4718592
s_mov_b32 s11, 0x20000
s_waitcnt lgkmcnt(0)
s_load_dwordx2 s[20:21], s[0:1], 80
s_mov_b32 s22, 2359296
s_mov_b32 s23, 0x20000
s_waitcnt lgkmcnt(0)
s_mul_i32 s28, s24, 40960
s_mul_i32 s35, s33, 96
s_mul_i32 s26, s24, 1179648
s_add_u32 s40, s35, s26
v_add_u32 v50, 0, v0
v_mul_u32_u24 v51, 10923, v50
v_lshrrev_b32 v51, 16, v51
v_mul_u32_u24 v52, 6, v51
v_sub_u32 v52, v50, v52
v_lshrrev_b32 v53, 3, v51
v_and_b32 v54, 7, v51
v_lshrrev_b32 v51, 2, v54
v_lshlrev_b32 v51, 4, v51
v_lshl_add_u32 v51, v53, 2, v51
v_and_b32 v54, 3, v54
v_add_u32 v51, v51, v54
v_mul_u32_u24 v51, 1152, v51
v_lshl_add_u32 v51, v52, 4, v51
v_add_u32 v56, s40, v51
v_add_u32 v50, 64, v0
v_mul_u32_u24 v51, 10923, v50
v_lshrrev_b32 v51, 16, v51
v_mul_u32_u24 v52, 6, v51
v_sub_u32 v52, v50, v52
v_lshrrev_b32 v53, 3, v51
v_and_b32 v54, 7, v51
v_lshrrev_b32 v51, 2, v54
v_lshlrev_b32 v51, 4, v51
v_lshl_add_u32 v51, v53, 2, v51
v_and_b32 v54, 3, v54
v_add_u32 v51, v51, v54
v_mul_u32_u24 v51, 1152, v51
v_lshl_add_u32 v51, v52, 4, v51
v_add_u32 v57, s40, v51
v_add_u32 v50, 128, v0
v_mul_u32_u24 v51, 10923, v50
v_lshrrev_b32 v51, 16, v51
v_mul_u32_u24 v52, 6, v51
v_sub_u32 v52, v50, v52
v_lshrrev_b32 v53, 3, v51
v_and_b32 v54, 7, v51
v_lshrrev_b32 v51, 2, v54
v_lshlrev_b32 v51, 4, v51
v_lshl_add_u32 v51, v53, 2, v51
v_and_b32 v54, 3, v54
v_add_u32 v51, v51, v54
v_mul_u32_u24 v51, 1152, v51
v_lshl_add_u32 v51, v52, 4, v51
v_add_u32 v58, s40, v51
v_lshrrev_b32 v61, 4, v0
v_bfe_u32 v50, v0, 2, 2
v_lshl_add_u32 v61, v61, 3, v50
v_mul_u32_u24 v61, 96, v61
v_and_b32 v50, 3, v0
v_lshl_add_u32 v61, v50, 3, v61
v_add_u32 v61, s28, v61
s_add_u32 m0, s28, 0
s_mov_b32 s26, 0
buffer_load_dwordx4 v56, s[8:11], s26 offen lds
s_add_u32 m0, s28, 1024
s_mov_b32 s26, 0
buffer_load_dwordx4 v57, s[8:11], s26 offen lds
s_add_u32 m0, s28, 2048
s_mov_b32 s26, 0
buffer_load_dwordx4 v58, s[8:11], s26 offen lds
s_add_u32 m0, s28, 3072
s_mov_b32 s26, 36864
buffer_load_dwordx4 v56, s[8:11], s26 offen lds
s_add_u32 m0, s28, 4096
s_mov_b32 s26, 36864
buffer_load_dwordx4 v57, s[8:11], s26 offen lds
s_add_u32 m0, s28, 5120
s_mov_b32 s26, 36864
buffer_load_dwordx4 v58, s[8:11], s26 offen lds
s_add_u32 m0, s28, 6144
s_mov_b32 s26, 73728
buffer_load_dwordx4 v56, s[8:11], s26 offen lds
s_add_u32 m0, s28, 7168
s_mov_b32 s26, 73728
buffer_load_dwordx4 v57, s[8:11], s26 offen lds
s_add_u32 m0, s28, 8192
s_mov_b32 s26, 73728
buffer_load_dwordx4 v58, s[8:11], s26 offen lds
s_add_u32 m0, s28, 9216
s_mov_b32 s26, 110592
buffer_load_dwordx4 v56, s[8:11], s26 offen lds
s_add_u32 m0, s28, 10240
s_mov_b32 s26, 110592
buffer_load_dwordx4 v57, s[8:11], s26 offen lds
s_add_u32 m0, s28, 11264
s_mov_b32 s26, 110592
buffer_load_dwordx4 v58, s[8:11], s26 offen lds
s_add_u32 m0, s28, 12288
s_mov_b32 s26, 147456
buffer_load_dwordx4 v56, s[8:11], s26 offen lds
s_add_u32 m0, s28, 13312
s_mov_b32 s26, 147456
buffer_load_dwordx4 v57, s[8:11], s26 offen lds
s_add_u32 m0, s28, 14336
s_mov_b32 s26, 147456
buffer_load_dwordx4 v58, s[8:11], s26 offen lds
s_add_u32 m0, s28, 15360
s_mov_b32 s26, 184320
buffer_load_dwordx4 v56, s[8:11], s26 offen lds
s_add_u32 m0, s28, 16384
s_mov_b32 s26, 184320
buffer_load_dwordx4 v57, s[8:11], s26 offen lds
s_add_u32 m0, s28, 17408
s_mov_b32 s26, 184320
buffer_load_dwordx4 v58, s[8:11], s26 offen lds
s_add_u32 m0, s28, 18432
s_mov_b32 s26, 221184
buffer_load_dwordx4 v56, s[8:11], s26 offen lds
s_add_u32 m0, s28, 19456
s_mov_b32 s26, 221184
buffer_load_dwordx4 v57, s[8:11], s26 offen lds
s_add_u32 m0, s28, 20480
s_mov_b32 s26, 221184
buffer_load_dwordx4 v58, s[8:11], s26 offen lds
s_add_u32 m0, s28, 21504
s_mov_b32 s26, 258048
buffer_load_dwordx4 v56, s[8:11], s26 offen lds
s_add_u32 m0, s28, 22528
s_mov_b32 s26, 258048
buffer_load_dwordx4 v57, s[8:11], s26 offen lds
s_add_u32 m0, s28, 23552
s_mov_b32 s26, 258048
buffer_load_dwordx4 v58, s[8:11], s26 offen lds
s_add_u32 m0, s28, 24576
s_mov_b32 s26, 294912
buffer_load_dwordx4 v56, s[8:11], s26 offen lds
s_add_u32 m0, s28, 25600
s_mov_b32 s26, 294912
buffer_load_dwordx4 v57, s[8:11], s26 offen lds
s_add_u32 m0, s28, 26624
s_mov_b32 s26, 294912
buffer_load_dwordx4 v58, s[8:11], s26 offen lds
s_add_u32 m0, s28, 27648
s_mov_b32 s26, 331776
buffer_load_dwordx4 v56, s[8:11], s26 offen lds
s_add_u32 m0, s28, 28672
s_mov_b32 s26, 331776
buffer_load_dwordx4 v57, s[8:11], s26 offen lds
s_add_u32 m0, s28, 29696
s_mov_b32 s26, 331776
buffer_load_dwordx4 v58, s[8:11], s26 offen lds
s_add_u32 m0, s28, 30720
s_mov_b32 s26, 368640
buffer_load_dwordx4 v56, s[8:11], s26 offen lds
s_add_u32 m0, s28, 31744
s_mov_b32 s26, 368640
buffer_load_dwordx4 v57, s[8:11], s26 offen lds
s_add_u32 m0, s28, 32768
s_mov_b32 s26, 368640
buffer_load_dwordx4 v58, s[8:11], s26 offen lds
s_add_u32 m0, s28, 33792
s_mov_b32 s26, 405504
buffer_load_dwordx4 v56, s[8:11], s26 offen lds
s_add_u32 m0, s28, 34816
s_mov_b32 s26, 405504
buffer_load_dwordx4 v57, s[8:11], s26 offen lds
s_add_u32 m0, s28, 35840
s_mov_b32 s26, 405504
buffer_load_dwordx4 v58, s[8:11], s26 offen lds
s_waitcnt vmcnt(18)
ds_read_b64_tr_b16 a[0:1], v61 offset:0
ds_read_b64_tr_b16 a[2:3], v61 offset:384
ds_read_b64_tr_b16 a[4:5], v61 offset:32
ds_read_b64_tr_b16 a[6:7], v61 offset:416
ds_read_b64_tr_b16 a[8:9], v61 offset:64
ds_read_b64_tr_b16 a[10:11], v61 offset:448
ds_read_b64_tr_b16 a[12:13], v61 offset:3072
ds_read_b64_tr_b16 a[14:15], v61 offset:3456
ds_read_b64_tr_b16 a[16:17], v61 offset:3104
ds_read_b64_tr_b16 a[18:19], v61 offset:3488
ds_read_b64_tr_b16 a[20:21], v61 offset:3136
ds_read_b64_tr_b16 a[22:23], v61 offset:3520
ds_read_b64_tr_b16 a[24:25], v61 offset:6144
ds_read_b64_tr_b16 a[26:27], v61 offset:6528
ds_read_b64_tr_b16 a[28:29], v61 offset:6176
ds_read_b64_tr_b16 a[30:31], v61 offset:6560
ds_read_b64_tr_b16 a[32:33], v61 offset:6208
ds_read_b64_tr_b16 a[34:35], v61 offset:6592
ds_read_b64_tr_b16 a[36:37], v61 offset:9216
ds_read_b64_tr_b16 a[38:39], v61 offset:9600
ds_read_b64_tr_b16 a[40:41], v61 offset:9248
ds_read_b64_tr_b16 a[42:43], v61 offset:9632
ds_read_b64_tr_b16 a[44:45], v61 offset:9280
ds_read_b64_tr_b16 a[46:47], v61 offset:9664
ds_read_b64_tr_b16 a[48:49], v61 offset:12288
ds_read_b64_tr_b16 a[50:51], v61 offset:12672
ds_read_b64_tr_b16 a[52:53], v61 offset:12320
ds_read_b64_tr_b16 a[54:55], v61 offset:12704
ds_read_b64_tr_b16 a[56:57], v61 offset:12352
ds_read_b64_tr_b16 a[58:59], v61 offset:12736
ds_read_b64_tr_b16 a[60:61], v61 offset:15360
ds_read_b64_tr_b16 a[62:63], v61 offset:15744
ds_read_b64_tr_b16 a[64:65], v61 offset:15392
ds_read_b64_tr_b16 a[66:67], v61 offset:15776
ds_read_b64_tr_b16 a[68:69], v61 offset:15424
ds_read_b64_tr_b16 a[70:71], v61 offset:15808
s_waitcnt lgkmcnt(0)
s_add_u32 m0, s28, 0
s_mov_b32 s26, 442368
buffer_load_dwordx4 v56, s[8:11], s26 offen lds
s_add_u32 m0, s28, 1024
s_mov_b32 s26, 442368
buffer_load_dwordx4 v57, s[8:11], s26 offen lds
s_add_u32 m0, s28, 2048
s_mov_b32 s26, 442368
buffer_load_dwordx4 v58, s[8:11], s26 offen lds
s_add_u32 m0, s28, 3072
s_mov_b32 s26, 479232
buffer_load_dwordx4 v56, s[8:11], s26 offen lds
s_add_u32 m0, s28, 4096
s_mov_b32 s26, 479232
buffer_load_dwordx4 v57, s[8:11], s26 offen lds
s_add_u32 m0, s28, 5120
s_mov_b32 s26, 479232
buffer_load_dwordx4 v58, s[8:11], s26 offen lds
s_add_u32 m0, s28, 6144
s_mov_b32 s26, 516096
buffer_load_dwordx4 v56, s[8:11], s26 offen lds
s_add_u32 m0, s28, 7168
s_mov_b32 s26, 516096
buffer_load_dwordx4 v57, s[8:11], s26 offen lds
s_add_u32 m0, s28, 8192
s_mov_b32 s26, 516096
buffer_load_dwordx4 v58, s[8:11], s26 offen lds
s_add_u32 m0, s28, 9216
s_mov_b32 s26, 552960
buffer_load_dwordx4 v56, s[8:11], s26 offen lds
s_add_u32 m0, s28, 10240
s_mov_b32 s26, 552960
buffer_load_dwordx4 v57, s[8:11], s26 offen lds
s_add_u32 m0, s28, 11264
s_mov_b32 s26, 552960
buffer_load_dwordx4 v58, s[8:11], s26 offen lds
s_add_u32 m0, s28, 12288
s_mov_b32 s26, 589824
buffer_load_dwordx4 v56, s[8:11], s26 offen lds
s_add_u32 m0, s28, 13312
s_mov_b32 s26, 589824
buffer_load_dwordx4 v57, s[8:11], s26 offen lds
s_add_u32 m0, s28, 14336
s_mov_b32 s26, 589824
buffer_load_dwordx4 v58, s[8:11], s26 offen lds
s_add_u32 m0, s28, 15360
s_mov_b32 s26, 626688
buffer_load_dwordx4 v56, s[8:11], s26 offen lds
s_add_u32 m0, s28, 16384
s_mov_b32 s26, 626688
buffer_load_dwordx4 v57, s[8:11], s26 offen lds
s_add_u32 m0, s28, 17408
s_mov_b32 s26, 626688
buffer_load_dwordx4 v58, s[8:11], s26 offen lds
s_waitcnt vmcnt(18)
ds_read_b64_tr_b16 a[72:73], v61 offset:18432
ds_read_b64_tr_b16 a[74:75], v61 offset:18816
ds_read_b64_tr_b16 a[76:77], v61 offset:18464
ds_read_b64_tr_b16 a[78:79], v61 offset:18848
ds_read_b64_tr_b16 a[80:81], v61 offset:18496
ds_read_b64_tr_b16 a[82:83], v61 offset:18880
ds_read_b64_tr_b16 a[84:85], v61 offset:21504
ds_read_b64_tr_b16 a[86:87], v61 offset:21888
ds_read_b64_tr_b16 a[88:89], v61 offset:21536
ds_read_b64_tr_b16 a[90:91], v61 offset:21920
ds_read_b64_tr_b16 a[92:93], v61 offset:21568
ds_read_b64_tr_b16 a[94:95], v61 offset:21952
ds_read_b64_tr_b16 a[96:97], v61 offset:24576
ds_read_b64_tr_b16 a[98:99], v61 offset:24960
ds_read_b64_tr_b16 a[100:101], v61 offset:24608
ds_read_b64_tr_b16 a[102:103], v61 offset:24992
ds_read_b64_tr_b16 a[104:105], v61 offset:24640
ds_read_b64_tr_b16 a[106:107], v61 offset:25024
ds_read_b64_tr_b16 a[108:109], v61 offset:27648
ds_read_b64_tr_b16 a[110:111], v61 offset:28032
ds_read_b64_tr_b16 a[112:113], v61 offset:27680
ds_read_b64_tr_b16 a[114:115], v61 offset:28064
ds_read_b64_tr_b16 a[116:117], v61 offset:27712
ds_read_b64_tr_b16 a[118:119], v61 offset:28096
ds_read_b64_tr_b16 a[120:121], v61 offset:30720
ds_read_b64_tr_b16 a[122:123], v61 offset:31104
ds_read_b64_tr_b16 a[124:125], v61 offset:30752
ds_read_b64_tr_b16 a[126:127], v61 offset:31136
ds_read_b64_tr_b16 a[128:129], v61 offset:30784
ds_read_b64_tr_b16 a[130:131], v61 offset:31168
ds_read_b64_tr_b16 a[132:133], v61 offset:33792
ds_read_b64_tr_b16 a[134:135], v61 offset:34176
ds_read_b64_tr_b16 a[136:137], v61 offset:33824
ds_read_b64_tr_b16 a[138:139], v61 offset:34208
ds_read_b64_tr_b16 a[140:141], v61 offset:33856
ds_read_b64_tr_b16 a[142:143], v61 offset:34240
s_waitcnt lgkmcnt(0)
s_add_u32 m0, s28, 18432
s_mov_b32 s26, 663552
buffer_load_dwordx4 v56, s[8:11], s26 offen lds
s_add_u32 m0, s28, 19456
s_mov_b32 s26, 663552
buffer_load_dwordx4 v57, s[8:11], s26 offen lds
s_add_u32 m0, s28, 20480
s_mov_b32 s26, 663552
buffer_load_dwordx4 v58, s[8:11], s26 offen lds
s_add_u32 m0, s28, 21504
s_mov_b32 s26, 700416
buffer_load_dwordx4 v56, s[8:11], s26 offen lds
s_add_u32 m0, s28, 22528
s_mov_b32 s26, 700416
buffer_load_dwordx4 v57, s[8:11], s26 offen lds
s_add_u32 m0, s28, 23552
s_mov_b32 s26, 700416
buffer_load_dwordx4 v58, s[8:11], s26 offen lds
s_add_u32 m0, s28, 24576
s_mov_b32 s26, 737280
buffer_load_dwordx4 v56, s[8:11], s26 offen lds
s_add_u32 m0, s28, 25600
s_mov_b32 s26, 737280
buffer_load_dwordx4 v57, s[8:11], s26 offen lds
s_add_u32 m0, s28, 26624
s_mov_b32 s26, 737280
buffer_load_dwordx4 v58, s[8:11], s26 offen lds
s_add_u32 m0, s28, 27648
s_mov_b32 s26, 774144
buffer_load_dwordx4 v56, s[8:11], s26 offen lds
s_add_u32 m0, s28, 28672
s_mov_b32 s26, 774144
buffer_load_dwordx4 v57, s[8:11], s26 offen lds
s_add_u32 m0, s28, 29696
s_mov_b32 s26, 774144
buffer_load_dwordx4 v58, s[8:11], s26 offen lds
s_add_u32 m0, s28, 30720
s_mov_b32 s26, 811008
buffer_load_dwordx4 v56, s[8:11], s26 offen lds
s_add_u32 m0, s28, 31744
s_mov_b32 s26, 811008
buffer_load_dwordx4 v57, s[8:11], s26 offen lds
s_add_u32 m0, s28, 32768
s_mov_b32 s26, 811008
buffer_load_dwordx4 v58, s[8:11], s26 offen lds
s_add_u32 m0, s28, 33792
s_mov_b32 s26, 847872
buffer_load_dwordx4 v56, s[8:11], s26 offen lds
s_add_u32 m0, s28, 34816
s_mov_b32 s26, 847872
buffer_load_dwordx4 v57, s[8:11], s26 offen lds
s_add_u32 m0, s28, 35840
s_mov_b32 s26, 847872
buffer_load_dwordx4 v58, s[8:11], s26 offen lds
s_waitcnt vmcnt(18)
ds_read_b64_tr_b16 a[144:145], v61 offset:0
ds_read_b64_tr_b16 a[146:147], v61 offset:384
ds_read_b64_tr_b16 a[148:149], v61 offset:32
ds_read_b64_tr_b16 a[150:151], v61 offset:416
ds_read_b64_tr_b16 a[152:153], v61 offset:64
ds_read_b64_tr_b16 a[154:155], v61 offset:448
ds_read_b64_tr_b16 a[156:157], v61 offset:3072
ds_read_b64_tr_b16 a[158:159], v61 offset:3456
ds_read_b64_tr_b16 a[160:161], v61 offset:3104
ds_read_b64_tr_b16 a[162:163], v61 offset:3488
ds_read_b64_tr_b16 a[164:165], v61 offset:3136
ds_read_b64_tr_b16 a[166:167], v61 offset:3520
ds_read_b64_tr_b16 a[168:169], v61 offset:6144
ds_read_b64_tr_b16 a[170:171], v61 offset:6528
ds_read_b64_tr_b16 a[172:173], v61 offset:6176
ds_read_b64_tr_b16 a[174:175], v61 offset:6560
ds_read_b64_tr_b16 a[176:177], v61 offset:6208
ds_read_b64_tr_b16 a[178:179], v61 offset:6592
ds_read_b64_tr_b16 a[180:181], v61 offset:9216
ds_read_b64_tr_b16 a[182:183], v61 offset:9600
ds_read_b64_tr_b16 a[184:185], v61 offset:9248
ds_read_b64_tr_b16 a[186:187], v61 offset:9632
ds_read_b64_tr_b16 a[188:189], v61 offset:9280
ds_read_b64_tr_b16 a[190:191], v61 offset:9664
ds_read_b64_tr_b16 a[192:193], v61 offset:12288
ds_read_b64_tr_b16 a[194:195], v61 offset:12672
ds_read_b64_tr_b16 a[196:197], v61 offset:12320
ds_read_b64_tr_b16 a[198:199], v61 offset:12704
ds_read_b64_tr_b16 a[200:201], v61 offset:12352
ds_read_b64_tr_b16 a[202:203], v61 offset:12736
ds_read_b64_tr_b16 a[204:205], v61 offset:15360
ds_read_b64_tr_b16 a[206:207], v61 offset:15744
ds_read_b64_tr_b16 a[208:209], v61 offset:15392
ds_read_b64_tr_b16 a[210:211], v61 offset:15776
ds_read_b64_tr_b16 a[212:213], v61 offset:15424
ds_read_b64_tr_b16 a[214:215], v61 offset:15808
s_waitcnt lgkmcnt(0)
s_add_u32 m0, s28, 0
s_mov_b32 s26, 884736
buffer_load_dwordx4 v56, s[8:11], s26 offen lds
s_add_u32 m0, s28, 1024
s_mov_b32 s26, 884736
buffer_load_dwordx4 v57, s[8:11], s26 offen lds
s_add_u32 m0, s28, 2048
s_mov_b32 s26, 884736
buffer_load_dwordx4 v58, s[8:11], s26 offen lds
s_add_u32 m0, s28, 3072
s_mov_b32 s26, 921600
buffer_load_dwordx4 v56, s[8:11], s26 offen lds
s_add_u32 m0, s28, 4096
s_mov_b32 s26, 921600
buffer_load_dwordx4 v57, s[8:11], s26 offen lds
s_add_u32 m0, s28, 5120
s_mov_b32 s26, 921600
buffer_load_dwordx4 v58, s[8:11], s26 offen lds
s_add_u32 m0, s28, 6144
s_mov_b32 s26, 958464
buffer_load_dwordx4 v56, s[8:11], s26 offen lds
s_add_u32 m0, s28, 7168
s_mov_b32 s26, 958464
buffer_load_dwordx4 v57, s[8:11], s26 offen lds
s_add_u32 m0, s28, 8192
s_mov_b32 s26, 958464
buffer_load_dwordx4 v58, s[8:11], s26 offen lds
s_add_u32 m0, s28, 9216
s_mov_b32 s26, 995328
buffer_load_dwordx4 v56, s[8:11], s26 offen lds
s_add_u32 m0, s28, 10240
s_mov_b32 s26, 995328
buffer_load_dwordx4 v57, s[8:11], s26 offen lds
s_add_u32 m0, s28, 11264
s_mov_b32 s26, 995328
buffer_load_dwordx4 v58, s[8:11], s26 offen lds
s_add_u32 m0, s28, 12288
s_mov_b32 s26, 1032192
buffer_load_dwordx4 v56, s[8:11], s26 offen lds
s_add_u32 m0, s28, 13312
s_mov_b32 s26, 1032192
buffer_load_dwordx4 v57, s[8:11], s26 offen lds
s_add_u32 m0, s28, 14336
s_mov_b32 s26, 1032192
buffer_load_dwordx4 v58, s[8:11], s26 offen lds
s_add_u32 m0, s28, 15360
s_mov_b32 s26, 1069056
buffer_load_dwordx4 v56, s[8:11], s26 offen lds
s_add_u32 m0, s28, 16384
s_mov_b32 s26, 1069056
buffer_load_dwordx4 v57, s[8:11], s26 offen lds
s_add_u32 m0, s28, 17408
s_mov_b32 s26, 1069056
buffer_load_dwordx4 v58, s[8:11], s26 offen lds
s_waitcnt vmcnt(18)
ds_read_b64_tr_b16 a[216:217], v61 offset:18432
ds_read_b64_tr_b16 a[218:219], v61 offset:18816
ds_read_b64_tr_b16 a[220:221], v61 offset:18464
ds_read_b64_tr_b16 a[222:223], v61 offset:18848
ds_read_b64_tr_b16 a[224:225], v61 offset:18496
ds_read_b64_tr_b16 a[226:227], v61 offset:18880
ds_read_b64_tr_b16 a[228:229], v61 offset:21504
ds_read_b64_tr_b16 a[230:231], v61 offset:21888
ds_read_b64_tr_b16 a[232:233], v61 offset:21536
ds_read_b64_tr_b16 a[234:235], v61 offset:21920
ds_read_b64_tr_b16 a[236:237], v61 offset:21568
ds_read_b64_tr_b16 a[238:239], v61 offset:21952
ds_read_b64_tr_b16 a[240:241], v61 offset:24576
ds_read_b64_tr_b16 a[242:243], v61 offset:24960
ds_read_b64_tr_b16 a[244:245], v61 offset:24608
ds_read_b64_tr_b16 a[246:247], v61 offset:24992
ds_read_b64_tr_b16 a[248:249], v61 offset:24640
ds_read_b64_tr_b16 a[250:251], v61 offset:25024
ds_read_b64_tr_b16 a[252:253], v61 offset:27648
ds_read_b64_tr_b16 a[254:255], v61 offset:28032
ds_read_b64_tr_b16 v[128:129], v61 offset:27680
ds_read_b64_tr_b16 v[130:131], v61 offset:28064
ds_read_b64_tr_b16 v[132:133], v61 offset:27712
ds_read_b64_tr_b16 v[134:135], v61 offset:28096
ds_read_b64_tr_b16 v[136:137], v61 offset:30720
ds_read_b64_tr_b16 v[138:139], v61 offset:31104
ds_read_b64_tr_b16 v[140:141], v61 offset:30752
ds_read_b64_tr_b16 v[142:143], v61 offset:31136
ds_read_b64_tr_b16 v[144:145], v61 offset:30784
ds_read_b64_tr_b16 v[146:147], v61 offset:31168
ds_read_b64_tr_b16 v[148:149], v61 offset:33792
ds_read_b64_tr_b16 v[150:151], v61 offset:34176
ds_read_b64_tr_b16 v[152:153], v61 offset:33824
ds_read_b64_tr_b16 v[154:155], v61 offset:34208
ds_read_b64_tr_b16 v[156:157], v61 offset:33856
ds_read_b64_tr_b16 v[158:159], v61 offset:34240
s_waitcnt lgkmcnt(0)
s_add_u32 m0, s28, 18432
s_mov_b32 s26, 1105920
buffer_load_dwordx4 v56, s[8:11], s26 offen lds
s_add_u32 m0, s28, 19456
s_mov_b32 s26, 1105920
buffer_load_dwordx4 v57, s[8:11], s26 offen lds
s_add_u32 m0, s28, 20480
s_mov_b32 s26, 1105920
buffer_load_dwordx4 v58, s[8:11], s26 offen lds
s_add_u32 m0, s28, 21504
s_mov_b32 s26, 1142784
buffer_load_dwordx4 v56, s[8:11], s26 offen lds
s_add_u32 m0, s28, 22528
s_mov_b32 s26, 1142784
buffer_load_dwordx4 v57, s[8:11], s26 offen lds
s_add_u32 m0, s28, 23552
s_mov_b32 s26, 1142784
buffer_load_dwordx4 v58, s[8:11], s26 offen lds
s_waitcnt vmcnt(6)
ds_read_b64_tr_b16 v[160:161], v61 offset:0
ds_read_b64_tr_b16 v[162:163], v61 offset:384
ds_read_b64_tr_b16 v[164:165], v61 offset:32
ds_read_b64_tr_b16 v[166:167], v61 offset:416
ds_read_b64_tr_b16 v[168:169], v61 offset:64
ds_read_b64_tr_b16 v[170:171], v61 offset:448
ds_read_b64_tr_b16 v[172:173], v61 offset:3072
ds_read_b64_tr_b16 v[174:175], v61 offset:3456
ds_read_b64_tr_b16 v[176:177], v61 offset:3104
ds_read_b64_tr_b16 v[178:179], v61 offset:3488
ds_read_b64_tr_b16 v[180:181], v61 offset:3136
ds_read_b64_tr_b16 v[182:183], v61 offset:3520
ds_read_b64_tr_b16 v[184:185], v61 offset:6144
ds_read_b64_tr_b16 v[186:187], v61 offset:6528
ds_read_b64_tr_b16 v[188:189], v61 offset:6176
ds_read_b64_tr_b16 v[190:191], v61 offset:6560
ds_read_b64_tr_b16 v[192:193], v61 offset:6208
ds_read_b64_tr_b16 v[194:195], v61 offset:6592
ds_read_b64_tr_b16 v[196:197], v61 offset:9216
ds_read_b64_tr_b16 v[198:199], v61 offset:9600
ds_read_b64_tr_b16 v[200:201], v61 offset:9248
ds_read_b64_tr_b16 v[202:203], v61 offset:9632
ds_read_b64_tr_b16 v[204:205], v61 offset:9280
ds_read_b64_tr_b16 v[206:207], v61 offset:9664
ds_read_b64_tr_b16 v[208:209], v61 offset:12288
ds_read_b64_tr_b16 v[210:211], v61 offset:12672
ds_read_b64_tr_b16 v[212:213], v61 offset:12320
ds_read_b64_tr_b16 v[214:215], v61 offset:12704
ds_read_b64_tr_b16 v[216:217], v61 offset:12352
ds_read_b64_tr_b16 v[218:219], v61 offset:12736
ds_read_b64_tr_b16 v[220:221], v61 offset:15360
ds_read_b64_tr_b16 v[222:223], v61 offset:15744
ds_read_b64_tr_b16 v[224:225], v61 offset:15392
ds_read_b64_tr_b16 v[226:227], v61 offset:15776
ds_read_b64_tr_b16 v[228:229], v61 offset:15424
ds_read_b64_tr_b16 v[230:231], v61 offset:15808
s_waitcnt lgkmcnt(0)
s_waitcnt vmcnt(0)
ds_read_b64_tr_b16 v[232:233], v61 offset:18432
ds_read_b64_tr_b16 v[234:235], v61 offset:18816
ds_read_b64_tr_b16 v[236:237], v61 offset:18464
ds_read_b64_tr_b16 v[238:239], v61 offset:18848
ds_read_b64_tr_b16 v[240:241], v61 offset:18496
ds_read_b64_tr_b16 v[242:243], v61 offset:18880
ds_read_b64_tr_b16 v[244:245], v61 offset:21504
ds_read_b64_tr_b16 v[246:247], v61 offset:21888
ds_read_b64_tr_b16 v[248:249], v61 offset:21536
ds_read_b64_tr_b16 v[250:251], v61 offset:21920
ds_read_b64_tr_b16 v[252:253], v61 offset:21568
ds_read_b64_tr_b16 v[254:255], v61 offset:21952
s_waitcnt lgkmcnt(0)
v_mov_b32 v4, 128
s_mov_b32 s29, 0
Lwf21:
buffer_load_dword v5, v4, s[16:19], 0 offen sc1
s_add_u32 s29, s29, 1
s_waitcnt vmcnt(0)
v_cmp_eq_u32 vcc, 0, v5
s_cbranch_vccz Lwd22
s_sleep 2
s_cmp_lt_u32 s29, s25
s_cbranch_scc1 Lwf21
s_mov_b32 s25, 0
Lwd22:
v_and_b32 v50, 15, v0
v_lshrrev_b32 v51, 4, v0
v_mul_u32_u24 v2, 1152, v50
v_lshl_add_u32 v2, v51, 3, v2
s_min_u32 s26, s24, 2
s_lshl_b32 s27, s26, 5
s_add_u32 s35, s35, s27
v_add_u32 v2, s35, v2
s_lshl_b32 s26, s26, 10
v_add_u32 v5, s26, v1
s_mul_i32 s26, s24, 3072
v_add_u32 v3, s26, v1
v_and_b32 v4, 7, v0
s_lshl_b32 s26, s24, 3
v_add_lshl_u32 v4, v4, s26, 9
s_mov_b32 s36, 0
s_barrier
P4_layer:
s_mov_b32 s37, s32
P4_unit:
s_lshl_b32 s40, s36, 7
s_add_u32 s40, s40, s37
s_lshr_b32 s41, s40, 1
s_lshl_b32 s41, s41, 2
s_add_u32 s41, s41, 32768
s_mov_b32 s29, 0
Lwf23:
buffer_load_dword v8, v4, s[4:7], s41 offen sc1
s_add_u32 s29, s29, 1
s_waitcnt vmcnt(0)
v_cmp_eq_u32 vcc, 0, v8
s_cbranch_vccz Lwd24
s_sleep 1
s_cmp_lt_u32 s29, s25
s_cbranch_scc1 Lwf23
s_mov_b32 s25, 0
Lwd24:
s_mul_i32 s42, s40, 18432
s_add_u32 s42, s42, 16777216
buffer_load_dwordx2 v[116:117], v2, s[4:7], s42 offen sc1
s_lshl_b32 s41, s40, 2
s_add_u32 s41, s41, s24
s_lshl_b32 s41, s41, 15
s_add_u32 s41, s41, 125829120
buffer_load_dwordx4 v[8:11], v1, s[4:7], s41 offen offset:0 sc1
buffer_load_dwordx4 v[12:15], v1, s[4:7], s41 offen offset:1024 sc1
buffer_load_dwordx4 v[16:19], v1, s[4:7], s41 offen offset:2048 sc1
buffer_load_dwordx4 v[20:23], v1, s[4:7], s41 offen offset:3072 sc1
s_add_u32 s41, s41, 4096
buffer_load_dwordx4 v[24:27], v1, s[4:7], s41 offen offset:0 sc1
buffer_load_dwordx4 v[28:31], v1, s[4:7], s41 offen offset:1024 sc1
buffer_load_dwordx4 v[32:35], v1, s[4:7], s41 offen offset:2048 sc1
buffer_load_dwordx4 v[36:39], v1, s[4:7], s41 offen offset:3072 sc1
s_add_u32 s41, s41, 4096
buffer_load_dwordx4 v[40:43], v1, s[4:7], s41 offen offset:0 sc1
buffer_load_dwordx4 v[44:47], v1, s[4:7], s41 offen offset:1024 sc1
buffer_load_dwordx4 v[48:51], v1, s[4:7], s41 offen offset:2048 sc1
buffer_load_dwordx4 v[52:55], v1, s[4:7], s41 offen offset:3072 sc1
s_add_u32 s41, s41, 4096
buffer_load_dwordx4 v[56:59], v1, s[4:7], s41 offen offset:0 sc1
buffer_load_dwordx4 v[60:63], v1, s[4:7], s41 offen offset:1024 sc1
buffer_load_dwordx4 v[64:67], v1, s[4:7], s41 offen offset:2048 sc1
buffer_load_dwordx4 v[68:71], v1, s[4:7], s41 offen offset:3072 sc1
s_add_u32 s41, s41, 4096
buffer_load_dwordx4 v[72:75], v1, s[4:7], s41 offen offset:0 sc1
buffer_load_dwordx4 v[76:79], v1, s[4:7], s41 offen offset:1024 sc1
buffer_load_dwordx4 v[80:83], v1, s[4:7], s41 offen offset:2048 sc1
buffer_load_dwordx4 v[84:87], v1, s[4:7], s41 offen offset:3072 sc1
s_add_u32 s41, s41, 4096
buffer_load_dwordx4 v[88:91], v1, s[4:7], s41 offen offset:0 sc1
buffer_load_dwordx4 v[92:95], v1, s[4:7], s41 offen offset:1024 sc1
buffer_load_dwordx4 v[96:99], v1, s[4:7], s41 offen offset:2048 sc1
buffer_load_dwordx4 v[100:103], v1, s[4:7], s41 offen offset:3072 sc1
s_add_u32 s41, s41, 4096
s_waitcnt vmcnt(23)
v_mfma_f32_16x16x32_bf16 v[104:107], a[0:3], v[8:11], 0
v_mfma_f32_16x16x32_bf16 v[108:111], a[4:7], v[8:11], 0
v_mfma_f32_16x16x32_bf16 v[112:115], a[8:11], v[8:11], 0
buffer_load_dwordx4 v[8:11], v1, s[4:7], s41 offen offset:0 sc1
s_waitcnt vmcnt(23)
v_mfma_f32_16x16x32_bf16 v[104:107], a[12:15], v[12:15], v[104:107]
v_mfma_f32_16x16x32_bf16 v[108:111], a[16:19], v[12:15], v[108:111]
v_mfma_f32_16x16x32_bf16 v[112:115], a[20:23], v[12:15], v[112:115]
buffer_load_dwordx4 v[12:15], v1, s[4:7], s41 offen offset:1024 sc1
s_waitcnt vmcnt(23)
v_mfma_f32_16x16x32_bf16 v[104:107], a[24:27], v[16:19], v[104:107]
v_mfma_f32_16x16x32_bf16 v[108:111], a[28:31], v[16:19], v[108:111]
v_mfma_f32_16x16x32_bf16 v[112:115], a[32:35], v[16:19], v[112:115]
buffer_load_dwordx4 v[16:19], v1, s[4:7], s41 offen offset:2048 sc1
s_waitcnt vmcnt(23)
v_mfma_f32_16x16x32_bf16 v[104:107], a[36:39], v[20:23], v[104:107]
v_mfma_f32_16x16x32_bf16 v[108:111], a[40:43], v[20:23], v[108:111]
v_mfma_f32_16x16x32_bf16 v[112:115], a[44:47], v[20:23], v[112:115]
buffer_load_dwordx4 v[20:23], v1, s[4:7], s41 offen offset:3072 sc1
s_add_u32 s41, s41, 4096
s_waitcnt vmcnt(23)
v_mfma_f32_16x16x32_bf16 v[104:107], a[48:51], v[24:27], v[104:107]
v_mfma_f32_16x16x32_bf16 v[108:111], a[52:55], v[24:27], v[108:111]
v_mfma_f32_16x16x32_bf16 v[112:115], a[56:59], v[24:27], v[112:115]
buffer_load_dwordx4 v[24:27], v1, s[4:7], s41 offen offset:0 sc1
s_waitcnt vmcnt(23)
v_mfma_f32_16x16x32_bf16 v[104:107], a[60:63], v[28:31], v[104:107]
v_mfma_f32_16x16x32_bf16 v[108:111], a[64:67], v[28:31], v[108:111]
v_mfma_f32_16x16x32_bf16 v[112:115], a[68:71], v[28:31], v[112:115]
buffer_load_dwordx4 v[28:31], v1, s[4:7], s41 offen offset:1024 sc1
s_waitcnt vmcnt(23)
v_mfma_f32_16x16x32_bf16 v[104:107], a[72:75], v[32:35], v[104:107]
v_mfma_f32_16x16x32_bf16 v[108:111], a[76:79], v[32:35], v[108:111]
v_mfma_f32_16x16x32_bf16 v[112:115], a[80:83], v[32:35], v[112:115]
buffer_load_dwordx4 v[32:35], v1, s[4:7], s41 offen offset:2048 sc1
s_waitcnt vmcnt(23)
v_mfma_f32_16x16x32_bf16 v[104:107], a[84:87], v[36:39], v[104:107]
v_mfma_f32_16x16x32_bf16 v[108:111], a[88:91], v[36:39], v[108:111]
v_mfma_f32_16x16x32_bf16 v[112:115], a[92:95], v[36:39], v[112:115]
buffer_load_dwordx4 v[36:39], v1, s[4:7], s41 offen offset:3072 sc1
s_add_u32 s41, s41, 4096
s_waitcnt vmcnt(23)
v_mfma_f32_16x16x32_bf16 v[104:107], a[96:99], v[40:43], v[104:107]
v_mfma_f32_16x16x32_bf16 v[108:111], a[100:103], v[40:43], v[108:111]
v_mfma_f32_16x16x32_bf16 v[112:115], a[104:107], v[40:43], v[112:115]
s_waitcnt vmcnt(22)
v_mfma_f32_16x16x32_bf16 v[104:107], a[108:111], v[44:47], v[104:107]
v_mfma_f32_16x16x32_bf16 v[108:111], a[112:115], v[44:47], v[108:111]
v_mfma_f32_16x16x32_bf16 v[112:115], a[116:119], v[44:47], v[112:115]
s_waitcnt vmcnt(21)
v_mfma_f32_16x16x32_bf16 v[104:107], a[120:123], v[48:51], v[104:107]
v_mfma_f32_16x16x32_bf16 v[108:111], a[124:127], v[48:51], v[108:111]
v_mfma_f32_16x16x32_bf16 v[112:115], a[128:131], v[48:51], v[112:115]
s_waitcnt vmcnt(20)
v_mfma_f32_16x16x32_bf16 v[104:107], a[132:135], v[52:55], v[104:107]
v_mfma_f32_16x16x32_bf16 v[108:111], a[136:139], v[52:55], v[108:111]
v_mfma_f32_16x16x32_bf16 v[112:115], a[140:143], v[52:55], v[112:115]
s_waitcnt vmcnt(19)
v_mfma_f32_16x16x32_bf16 v[104:107], a[144:147], v[56:59], v[104:107]
v_mfma_f32_16x16x32_bf16 v[108:111], a[148:151], v[56:59], v[108:111]
v_mfma_f32_16x16x32_bf16 v[112:115], a[152:155], v[56:59], v[112:115]
s_waitcnt vmcnt(18)
v_mfma_f32_16x16x32_bf16 v[104:107], a[156:159], v[60:63], v[104:107]
v_mfma_f32_16x16x32_bf16 v[108:111], a[160:163], v[60:63], v[108:111]
v_mfma_f32_16x16x32_bf16 v[112:115], a[164:167], v[60:63], v[112:115]
s_waitcnt vmcnt(17)
v_mfma_f32_16x16x32_bf16 v[104:107], a[168:171], v[64:67], v[104:107]
v_mfma_f32_16x16x32_bf16 v[108:111], a[172:175], v[64:67], v[108:111]
v_mfma_f32_16x16x32_bf16 v[112:115], a[176:179], v[64:67], v[112:115]
s_waitcnt vmcnt(16)
v_mfma_f32_16x16x32_bf16 v[104:107], a[180:183], v[68:71], v[104:107]
v_mfma_f32_16x16x32_bf16 v[108:111], a[184:187], v[68:71], v[108:111]
v_mfma_f32_16x16x32_bf16 v[112:115], a[188:191], v[68:71], v[112:115]
s_waitcnt vmcnt(15)
v_mfma_f32_16x16x32_bf16 v[104:107], a[192:195], v[72:75], v[104:107]
v_mfma_f32_16x16x32_bf16 v[108:111], a[196:199], v[72:75], v[108:111]
v_mfma_f32_16x16x32_bf16 v[112:115], a[200:203], v[72:75], v[112:115]
s_waitcnt vmcnt(14)
v_mfma_f32_16x16x32_bf16 v[104:107], a[204:207], v[76:79], v[104:107]
v_mfma_f32_16x16x32_bf16 v[108:111], a[208:211], v[76:79], v[108:111]
v_mfma_f32_16x16x32_bf16 v[112:115], a[212:215], v[76:79], v[112:115]
s_waitcnt vmcnt(13)
v_mfma_f32_16x16x32_bf16 v[104:107], a[216:219], v[80:83], v[104:107]
v_mfma_f32_16x16x32_bf16 v[108:111], a[220:223], v[80:83], v[108:111]
v_mfma_f32_16x16x32_bf16 v[112:115], a[224:227], v[80:83], v[112:115]
s_waitcnt vmcnt(12)
v_mfma_f32_16x16x32_bf16 v[104:107], a[228:231], v[84:87], v[104:107]
v_mfma_f32_16x16x32_bf16 v[108:111], a[232:235], v[84:87], v[108:111]
v_mfma_f32_16x16x32_bf16 v[112:115], a[236:239], v[84:87], v[112:115]
s_waitcnt vmcnt(11)
v_mfma_f32_16x16x32_bf16 v[104:107], a[240:243], v[88:91], v[104:107]
v_mfma_f32_16x16x32_bf16 v[108:111], a[244:247], v[88:91], v[108:111]
v_mfma_f32_16x16x32_bf16 v[112:115], a[248:251], v[88:91], v[112:115]
s_waitcnt vmcnt(10)
v_mfma_f32_16x16x32_bf16 v[104:107], a[252:255], v[92:95], v[104:107]
v_mfma_f32_16x16x32_bf16 v[108:111], v[128:131], v[92:95], v[108:111]
v_mfma_f32_16x16x32_bf16 v[112:115], v[132:135], v[92:95], v[112:115]
s_waitcnt vmcnt(9)
v_mfma_f32_16x16x32_bf16 v[104:107], v[136:139], v[96:99], v[104:107]
v_mfma_f32_16x16x32_bf16 v[108:111], v[140:143], v[96:99], v[108:111]
v_mfma_f32_16x16x32_bf16 v[112:115], v[144:147], v[96:99], v[112:115]
s_waitcnt vmcnt(8)
v_mfma_f32_16x16x32_bf16 v[104:107], v[148:151], v[100:103], v[104:107]
v_mfma_f32_16x16x32_bf16 v[108:111], v[152:155], v[100:103], v[108:111]
v_mfma_f32_16x16x32_bf16 v[112:115], v[156:159], v[100:103], v[112:115]
s_waitcnt vmcnt(7)
v_mfma_f32_16x16x32_bf16 v[104:107], v[160:163], v[8:11], v[104:107]
v_mfma_f32_16x16x32_bf16 v[108:111], v[164:167], v[8:11], v[108:111]
v_mfma_f32_16x16x32_bf16 v[112:115], v[168:171], v[8:11], v[112:115]
s_waitcnt vmcnt(6)
v_mfma_f32_16x16x32_bf16 v[104:107], v[172:175], v[12:15], v[104:107]
v_mfma_f32_16x16x32_bf16 v[108:111], v[176:179], v[12:15], v[108:111]
v_mfma_f32_16x16x32_bf16 v[112:115], v[180:183], v[12:15], v[112:115]
s_waitcnt vmcnt(5)
v_mfma_f32_16x16x32_bf16 v[104:107], v[184:187], v[16:19], v[104:107]
v_mfma_f32_16x16x32_bf16 v[108:111], v[188:191], v[16:19], v[108:111]
v_mfma_f32_16x16x32_bf16 v[112:115], v[192:195], v[16:19], v[112:115]
s_waitcnt vmcnt(4)
v_mfma_f32_16x16x32_bf16 v[104:107], v[196:199], v[20:23], v[104:107]
v_mfma_f32_16x16x32_bf16 v[108:111], v[200:203], v[20:23], v[108:111]
v_mfma_f32_16x16x32_bf16 v[112:115], v[204:207], v[20:23], v[112:115]
s_waitcnt vmcnt(3)
v_mfma_f32_16x16x32_bf16 v[104:107], v[208:211], v[24:27], v[104:107]
v_mfma_f32_16x16x32_bf16 v[108:111], v[212:215], v[24:27], v[108:111]
v_mfma_f32_16x16x32_bf16 v[112:115], v[216:219], v[24:27], v[112:115]
s_waitcnt vmcnt(2)
v_mfma_f32_16x16x32_bf16 v[104:107], v[220:223], v[28:31], v[104:107]
v_mfma_f32_16x16x32_bf16 v[108:111], v[224:227], v[28:31], v[108:111]
v_mfma_f32_16x16x32_bf16 v[112:115], v[228:231], v[28:31], v[112:115]
s_waitcnt vmcnt(1)
v_mfma_f32_16x16x32_bf16 v[104:107], v[232:235], v[32:35], v[104:107]
v_mfma_f32_16x16x32_bf16 v[108:111], v[236:239], v[32:35], v[108:111]
v_mfma_f32_16x16x32_bf16 v[112:115], v[240:243], v[32:35], v[112:115]
s_waitcnt vmcnt(0)
v_mfma_f32_16x16x32_bf16 v[104:107], v[244:247], v[36:39], v[104:107]
v_mfma_f32_16x16x32_bf16 v[108:111], v[248:251], v[36:39], v[108:111]
v_mfma_f32_16x16x32_bf16 v[112:115], v[252:255], v[36:39], v[112:115]
s_nop 5
ds_write_b128 v3, v[104:107] offset:0
ds_write_b128 v3, v[108:111] offset:1024
ds_write_b128 v3, v[112:115] offset:2048
s_waitcnt lgkmcnt(0)
s_barrier
ds_read_b128 v[8:11], v5 offset:0
ds_read_b128 v[12:15], v5 offset:3072
ds_read_b128 v[16:19], v5 offset:6144
ds_read_b128 v[20:23], v5 offset:9216
s_waitcnt lgkmcnt(0)
v_add_f32 v8, v8, v12
v_add_f32 v16, v16, v20
v_add_f32 v9, v9, v13
v_add_f32 v17, v17, v21
v_add_f32 v10, v10, v14
v_add_f32 v18, v18, v22
v_add_f32 v11, v11, v15
v_add_f32 v19, v19, v23
v_add_f32 v8, v8, v16
v_add_f32 v9, v9, v17
v_add_f32 v10, v10, v18
v_add_f32 v11, v11, v19
v_lshlrev_b32 v24, 16, v116
v_and_b32 v25, 0xffff0000, v116
v_add_f32 v24, v24, v8
v_add_f32 v25, v25, v9
v_cvt_pk_bf16_f32 v116, v24, v25
v_lshlrev_b32 v24, 16, v117
v_and_b32 v25, 0xffff0000, v117
v_add_f32 v24, v24, v10
v_add_f32 v25, v25, v11
v_cvt_pk_bf16_f32 v117, v24, v25
s_mul_i32 s42, s37, 18432
s_cmp_eq_u32 s36, 1
s_cbranch_scc1 P4_out
s_add_u32 s42, s42, 21495808
s_cmp_eq_u32 s24, 3
s_cbranch_scc1 P4_s1
buffer_store_dwordx2 v[116:117], v2, s[4:7], s42 offen sc1
P4_s1:
s_lshr_b32 s41, s37, 1
s_and_b32 s26, s37, 1
s_mul_i32 s26, s26, 12
s_add_u32 s26, s26, s33
s_lshl_b32 s26, s26, 6
s_add_u32 s41, s41, s26
s_lshl_b32 s41, s41, 2
s_add_u32 s41, s41, 55296
s_waitcnt vmcnt(0)
s_barrier
s_cmp_lg_u32 s24, 0
s_cbranch_scc1 Lsg25
v_mov_b32 v8, 1
s_mov_b64 exec, 1
buffer_store_dword v8, off, s[4:7], s41 sc1
s_mov_b64 exec, -1
Lsg25:
s_branch P4_next
P4_out:
s_cmp_eq_u32 s24, 3
s_cbranch_scc1 P4_s2
buffer_store_dwordx2 v[116:117], v2, s[20:23], s42 offen
P4_s2:
s_barrier
P4_next:
s_add_u32 s37, s37, 5
s_cmp_lt_u32 s37, 128
s_cbranch_scc1 P4_unit
s_add_u32 s36, s36, 1
s_cmp_lt_u32 s36, 2
s_cbranch_scc1 P4_layer
s_branch END
END:
s_waitcnt vmcnt(0)
s_endpgm
CH:
s_setprio 3
s_getreg_b32 s54, hwreg(HW_REG_XCC_ID, 0, 4)
s_add_u32 s54, s54, 1
s_mul_i32 s28, s24, 36864
s_add_u32 s28, s28, 16384
v_add_u32 v6, s28, v1
s_lshl_b32 s26, s24, 3
v_lshrrev_b32 v50, 3, v0
v_add_u32 v50, s26, v50
v_mul_u32_u24 v50, 96, v50
v_add_lshl_u32 v50, v50, s52, 7
v_and_b32 v51, 7, v0
v_lshl_add_u32 v2, v51, 4, v50
s_mul_i32 s59, s52, 12288
s_lshl_b32 s26, s24, 12
s_add_u32 s59, s59, s26
s_add_u32 s59, s59, 131072
s_mov_b32 s60, 131072
s_mov_b32 s61, 135168
s_mov_b32 s62, 139264
v_and_b32 v50, 15, v0
v_cmp_gt_u32 s[46:47], 6, v50
v_lshrrev_b32 v51, 1, v50
s_mul_i32 s63, s24, 3072
v_lshl_add_u32 v3, v51, 10, s63
v_and_b32 v51, 1, v0
v_lshl_add_u32 v3, v51, 4, v3
s_lshr_b32 s26, s52, 1
s_lshl_b32 s26, s26, 6
s_and_b32 s27, s52, 1
s_lshl_b32 s27, s27, 5
s_add_u32 s26, s26, s27
v_add_u32 v3, s26, v3
v_bfe_u32 v51, v0, 4, 1
v_lshl_add_u32 v3, v51, 3, v3
v_lshrrev_b32 v51, 5, v0
v_lshl_add_u32 v3, v51, 2, v3
s_mov_b32 s56, 786432
s_mov_b32 s57, 795648
s_mov_b32 s58, 804864
v_mov_b64 v[8:9], 0
v_mov_b64 v[10:11], 0
v_mov_b32 v12, -1
buffer_store_dwordx4 v[8:11], v2, s[4:7], s60 offen sc1
buffer_store_dwordx4 v[8:11], v2, s[4:7], s61 offen sc1
buffer_store_dwordx4 v[8:11], v2, s[4:7], s62 offen sc1
s_cmp_eq_u32 s24, 3
s_cbranch_scc1 CH_np
s_mov_b64 exec, s[46:47]
buffer_store_dword v12, v3, s[4:7], s56 offen sc1
buffer_store_dword v12, v3, s[4:7], s57 offen sc1
buffer_store_dword v12, v3, s[4:7], s58 offen sc1
s_mov_b64 exec, -1
CH_np:
s_lshl_b32 s41, s52, 2
s_waitcnt vmcnt(0)
s_barrier
s_cmp_lg_u32 s24, 0
s_cbranch_scc1 Lsg26
v_mov_b32 v50, s54
s_mov_b64 exec, 1
buffer_store_dword v50, off, s[16:19], s41 sc1
s_mov_b64 exec, -1
Lsg26:
s_load_dwordx2 s[8:9], s[0:1], 40
s_mov_b32 s10, 4718592
s_mov_b32 s11, 0x20000
s_waitcnt lgkmcnt(0)
s_load_dwordx2 s[12:13], s[0:1], 48
s_mov_b32 s14, 4718592
s_mov_b32 s15, 0x20000
s_waitcnt lgkmcnt(0)
s_load_dwordx2 s[20:21], s[0:1], 56
s_mov_b32 s22, 4718592
s_mov_b32 s23, 0x20000
s_waitcnt lgkmcnt(0)
s_load_dwordx2 s[64:65], s[0:1], 64
s_mov_b32 s66, 4718592
s_mov_b32 s67, 0x20000
s_waitcnt lgkmcnt(0)
s_load_dwordx2 s[32:33], s[0:1], 32
s_mov_b32 s34, 9216
s_mov_b32 s35, 0x20000
s_waitcnt lgkmcnt(0)
v_lshrrev_b32 v50, 4, v0
v_bfe_u32 v51, v0, 3, 1
v_bfe_u32 v52, v0, 2, 1
v_and_b32 v53, 3, v0
v_lshl_add_u32 v54, v50, 1, v52
v_lshl_add_u32 v54, v51, 3, v54
v_lshlrev_b32 v54, 13, v54
v_lshl_add_u32 v54, v53, 4, v54
s_lshl_b32 s27, s52, 8
s_lshl_b32 s26, s24, 6
s_add_u32 s27, s27, s26
v_add_u32 v76, s27, v54
v_lshrrev_b32 v54, 1, v50
v_lshlrev_b32 v54, 4, v54
v_lshl_add_u32 v54, v51, 2, v54
v_and_b32 v50, 1, v50
v_lshl_add_u32 v54, v50, 1, v54
v_add_u32 v54, v54, v52
v_mul_u32_u24 v54, 1152, v54
v_and_b32 v50, 1, v53
v_lshl_add_u32 v54, v50, 4, v54
s_mul_i32 s27, s52, 147456
s_lshl_b32 s26, s24, 5
s_add_u32 s27, s27, s26
v_add_u32 v78, s27, v54
v_lshrrev_b32 v50, 1, v53
v_lshl_add_u32 v77, v50, 7, v78
v_lshrrev_b32 v79, 4, v0
v_bfe_u32 v50, v0, 2, 2
v_lshl_add_u32 v79, v79, 3, v50
v_mul_u32_u24 v79, 64, v79
v_and_b32 v50, 3, v0
v_lshl_add_u32 v79, v50, 3, v79
v_add_u32 v79, s28, v79
s_add_u32 m0, s28, 0
s_mov_b32 s26, 524288
buffer_load_dwordx4 v76, s[8:11], s26 offen lds
s_add_u32 m0, s28, 1024
s_mov_b32 s26, 655360
buffer_load_dwordx4 v76, s[8:11], s26 offen lds
s_add_u32 m0, s28, 2048
s_mov_b32 s26, 786432
buffer_load_dwordx4 v76, s[8:11], s26 offen lds
s_add_u32 m0, s28, 3072
s_mov_b32 s26, 917504
buffer_load_dwordx4 v76, s[8:11], s26 offen lds
s_add_u32 m0, s28, 4096
s_mov_b32 s26, 1048576
buffer_load_dwordx4 v76, s[8:11], s26 offen lds
s_add_u32 m0, s28, 5120
s_mov_b32 s26, 1179648
buffer_load_dwordx4 v76, s[8:11], s26 offen lds
s_add_u32 m0, s28, 6144
s_mov_b32 s26, 1310720
buffer_load_dwordx4 v76, s[8:11], s26 offen lds
s_add_u32 m0, s28, 7168
s_mov_b32 s26, 1441792
buffer_load_dwordx4 v76, s[8:11], s26 offen lds
s_add_u32 m0, s28, 8192
s_mov_b32 s26, 2097152
buffer_load_dwordx4 v76, s[8:11], s26 offen lds
s_add_u32 m0, s28, 9216
s_mov_b32 s26, 2228224
buffer_load_dwordx4 v76, s[8:11], s26 offen lds
s_add_u32 m0, s28, 10240
s_mov_b32 s26, 2359296
buffer_load_dwordx4 v76, s[8:11], s26 offen lds
s_add_u32 m0, s28, 11264
s_mov_b32 s26, 2490368
buffer_load_dwordx4 v76, s[8:11], s26 offen lds
s_add_u32 m0, s28, 12288
s_mov_b32 s26, 3145728
buffer_load_dwordx4 v76, s[8:11], s26 offen lds
s_add_u32 m0, s28, 13312
s_mov_b32 s26, 3276800
buffer_load_dwordx4 v76, s[8:11], s26 offen lds
s_add_u32 m0, s28, 14336
s_mov_b32 s26, 3407872
buffer_load_dwordx4 v76, s[8:11], s26 offen lds
s_add_u32 m0, s28, 15360
s_mov_b32 s26, 3538944
buffer_load_dwordx4 v76, s[8:11], s26 offen lds
s_add_u32 m0, s28, 16384
s_mov_b32 s26, 4194304
buffer_load_dwordx4 v76, s[8:11], s26 offen lds
s_add_u32 m0, s28, 17408
s_mov_b32 s26, 4325376
buffer_load_dwordx4 v76, s[8:11], s26 offen lds
s_add_u32 m0, s28, 18432
s_mov_b32 s26, 4456448
buffer_load_dwordx4 v76, s[8:11], s26 offen lds
s_add_u32 m0, s28, 19456
s_mov_b32 s26, 4587520
buffer_load_dwordx4 v76, s[8:11], s26 offen lds
s_add_u32 m0, s28, 20480
s_mov_b32 s26, 0
buffer_load_dwordx4 v76, s[12:15], s26 offen lds
s_add_u32 m0, s28, 21504
s_mov_b32 s26, 131072
buffer_load_dwordx4 v76, s[12:15], s26 offen lds
s_add_u32 m0, s28, 22528
s_mov_b32 s26, 262144
buffer_load_dwordx4 v76, s[12:15], s26 offen lds
s_add_u32 m0, s28, 23552
s_mov_b32 s26, 393216
buffer_load_dwordx4 v76, s[12:15], s26 offen lds
s_add_u32 m0, s28, 24576
s_mov_b32 s26, 524288
buffer_load_dwordx4 v76, s[12:15], s26 offen lds
s_add_u32 m0, s28, 25600
s_mov_b32 s26, 655360
buffer_load_dwordx4 v76, s[12:15], s26 offen lds
s_add_u32 m0, s28, 26624
s_mov_b32 s26, 786432
buffer_load_dwordx4 v76, s[12:15], s26 offen lds
s_add_u32 m0, s28, 27648
s_mov_b32 s26, 917504
buffer_load_dwordx4 v76, s[12:15], s26 offen lds
s_add_u32 m0, s28, 28672
s_mov_b32 s26, 1048576
buffer_load_dwordx4 v76, s[12:15], s26 offen lds
s_add_u32 m0, s28, 29696
s_mov_b32 s26, 1179648
buffer_load_dwordx4 v76, s[12:15], s26 offen lds
s_add_u32 m0, s28, 30720
s_mov_b32 s26, 1310720
buffer_load_dwordx4 v76, s[12:15], s26 offen lds
s_add_u32 m0, s28, 31744
s_mov_b32 s26, 1441792
buffer_load_dwordx4 v76, s[12:15], s26 offen lds
s_add_u32 m0, s28, 32768
s_mov_b32 s26, 1572864
buffer_load_dwordx4 v76, s[12:15], s26 offen lds
s_add_u32 m0, s28, 33792
s_mov_b32 s26, 1703936
buffer_load_dwordx4 v76, s[12:15], s26 offen lds
s_add_u32 m0, s28, 34816
s_mov_b32 s26, 1835008
buffer_load_dwordx4 v76, s[12:15], s26 offen lds
s_add_u32 m0, s28, 35840
s_mov_b32 s26, 1966080
buffer_load_dwordx4 v76, s[12:15], s26 offen lds
s_waitcnt vmcnt(18)
ds_read_b64_tr_b16 a[0:1], v79 offset:0
ds_read_b64_tr_b16 a[2:3], v79 offset:256
ds_read_b64_tr_b16 a[8:9], v79 offset:32
ds_read_b64_tr_b16 a[10:11], v79 offset:288
ds_read_b64_tr_b16 a[4:5], v79 offset:2048
ds_read_b64_tr_b16 a[6:7], v79 offset:2304
ds_read_b64_tr_b16 a[12:13], v79 offset:2080
ds_read_b64_tr_b16 a[14:15], v79 offset:2336
ds_read_b64_tr_b16 a[16:17], v79 offset:4096
ds_read_b64_tr_b16 a[18:19], v79 offset:4352
ds_read_b64_tr_b16 a[24:25], v79 offset:4128
ds_read_b64_tr_b16 a[26:27], v79 offset:4384
ds_read_b64_tr_b16 a[20:21], v79 offset:6144
ds_read_b64_tr_b16 a[22:23], v79 offset:6400
ds_read_b64_tr_b16 a[28:29], v79 offset:6176
ds_read_b64_tr_b16 a[30:31], v79 offset:6432
ds_read_b64_tr_b16 a[32:33], v79 offset:8192
ds_read_b64_tr_b16 a[34:35], v79 offset:8448
ds_read_b64_tr_b16 a[40:41], v79 offset:8224
ds_read_b64_tr_b16 a[42:43], v79 offset:8480
ds_read_b64_tr_b16 a[36:37], v79 offset:10240
ds_read_b64_tr_b16 a[38:39], v79 offset:10496
ds_read_b64_tr_b16 a[44:45], v79 offset:10272
ds_read_b64_tr_b16 a[46:47], v79 offset:10528
ds_read_b64_tr_b16 a[48:49], v79 offset:12288
ds_read_b64_tr_b16 a[50:51], v79 offset:12544
ds_read_b64_tr_b16 a[56:57], v79 offset:12320
ds_read_b64_tr_b16 a[58:59], v79 offset:12576
ds_read_b64_tr_b16 a[52:53], v79 offset:14336
ds_read_b64_tr_b16 a[54:55], v79 offset:14592
ds_read_b64_tr_b16 a[60:61], v79 offset:14368
ds_read_b64_tr_b16 a[62:63], v79 offset:14624
ds_read_b64_tr_b16 a[64:65], v79 offset:16384
ds_read_b64_tr_b16 a[66:67], v79 offset:16640
ds_read_b64_tr_b16 a[72:73], v79 offset:16416
ds_read_b64_tr_b16 a[74:75], v79 offset:16672
s_waitcnt lgkmcnt(0)
s_add_u32 m0, s28, 0
s_mov_b32 s26, 2097152
buffer_load_dwordx4 v76, s[12:15], s26 offen lds
s_add_u32 m0, s28, 1024
s_mov_b32 s26, 2228224
buffer_load_dwordx4 v76, s[12:15], s26 offen lds
s_add_u32 m0, s28, 2048
s_mov_b32 s26, 2359296
buffer_load_dwordx4 v76, s[12:15], s26 offen lds
s_add_u32 m0, s28, 3072
s_mov_b32 s26, 2490368
buffer_load_dwordx4 v76, s[12:15], s26 offen lds
s_add_u32 m0, s28, 4096
s_mov_b32 s26, 2621440
buffer_load_dwordx4 v76, s[12:15], s26 offen lds
s_add_u32 m0, s28, 5120
s_mov_b32 s26, 2752512
buffer_load_dwordx4 v76, s[12:15], s26 offen lds
s_add_u32 m0, s28, 6144
s_mov_b32 s26, 2883584
buffer_load_dwordx4 v76, s[12:15], s26 offen lds
s_add_u32 m0, s28, 7168
s_mov_b32 s26, 3014656
buffer_load_dwordx4 v76, s[12:15], s26 offen lds
s_add_u32 m0, s28, 8192
s_mov_b32 s26, 3145728
buffer_load_dwordx4 v76, s[12:15], s26 offen lds
s_add_u32 m0, s28, 9216
s_mov_b32 s26, 3276800
buffer_load_dwordx4 v76, s[12:15], s26 offen lds
s_add_u32 m0, s28, 10240
s_mov_b32 s26, 3407872
buffer_load_dwordx4 v76, s[12:15], s26 offen lds
s_add_u32 m0, s28, 11264
s_mov_b32 s26, 3538944
buffer_load_dwordx4 v76, s[12:15], s26 offen lds
s_add_u32 m0, s28, 12288
s_mov_b32 s26, 3670016
buffer_load_dwordx4 v76, s[12:15], s26 offen lds
s_add_u32 m0, s28, 13312
s_mov_b32 s26, 3801088
buffer_load_dwordx4 v76, s[12:15], s26 offen lds
s_add_u32 m0, s28, 14336
s_mov_b32 s26, 3932160
buffer_load_dwordx4 v76, s[12:15], s26 offen lds
s_add_u32 m0, s28, 15360
s_mov_b32 s26, 4063232
buffer_load_dwordx4 v76, s[12:15], s26 offen lds
s_add_u32 m0, s28, 16384
s_mov_b32 s26, 4194304
buffer_load_dwordx4 v76, s[12:15], s26 offen lds
s_add_u32 m0, s28, 17408
s_mov_b32 s26, 4325376
buffer_load_dwordx4 v76, s[12:15], s26 offen lds
s_waitcnt vmcnt(18)
ds_read_b64_tr_b16 a[68:69], v79 offset:18432
ds_read_b64_tr_b16 a[70:71], v79 offset:18688
ds_read_b64_tr_b16 a[76:77], v79 offset:18464
ds_read_b64_tr_b16 a[78:79], v79 offset:18720
ds_read_b64_tr_b16 a[80:81], v79 offset:20480
ds_read_b64_tr_b16 a[82:83], v79 offset:20736
ds_read_b64_tr_b16 a[88:89], v79 offset:20512
ds_read_b64_tr_b16 a[90:91], v79 offset:20768
ds_read_b64_tr_b16 a[84:85], v79 offset:22528
ds_read_b64_tr_b16 a[86:87], v79 offset:22784
ds_read_b64_tr_b16 a[92:93], v79 offset:22560
ds_read_b64_tr_b16 a[94:95], v79 offset:22816
ds_read_b64_tr_b16 a[96:97], v79 offset:24576
ds_read_b64_tr_b16 a[98:99], v79 offset:24832
ds_read_b64_tr_b16 a[104:105], v79 offset:24608
ds_read_b64_tr_b16 a[106:107], v79 offset:24864
ds_read_b64_tr_b16 a[100:101], v79 offset:26624
ds_read_b64_tr_b16 a[102:103], v79 offset:26880
ds_read_b64_tr_b16 a[108:109], v79 offset:26656
ds_read_b64_tr_b16 a[110:111], v79 offset:26912
ds_read_b64_tr_b16 a[112:113], v79 offset:28672
ds_read_b64_tr_b16 a[114:115], v79 offset:28928
ds_read_b64_tr_b16 a[120:121], v79 offset:28704
ds_read_b64_tr_b16 a[122:123], v79 offset:28960
ds_read_b64_tr_b16 a[116:117], v79 offset:30720
ds_read_b64_tr_b16 a[118:119], v79 offset:30976
ds_read_b64_tr_b16 a[124:125], v79 offset:30752
ds_read_b64_tr_b16 a[126:127], v79 offset:31008
ds_read_b64_tr_b16 a[128:129], v79 offset:32768
ds_read_b64_tr_b16 a[130:131], v79 offset:33024
ds_read_b64_tr_b16 a[136:137], v79 offset:32800
ds_read_b64_tr_b16 a[138:139], v79 offset:33056
ds_read_b64_tr_b16 a[132:133], v79 offset:34816
ds_read_b64_tr_b16 a[134:135], v79 offset:35072
ds_read_b64_tr_b16 a[140:141], v79 offset:34848
ds_read_b64_tr_b16 a[142:143], v79 offset:35104
s_waitcnt lgkmcnt(0)
s_add_u32 m0, s28, 18432
s_mov_b32 s26, 4456448
buffer_load_dwordx4 v76, s[12:15], s26 offen lds
s_add_u32 m0, s28, 19456
s_mov_b32 s26, 4587520
buffer_load_dwordx4 v76, s[12:15], s26 offen lds
s_add_u32 m0, s28, 20480
s_mov_b32 s26, 0
buffer_load_dwordx4 v76, s[20:23], s26 offen lds
s_add_u32 m0, s28, 21504
s_mov_b32 s26, 131072
buffer_load_dwordx4 v76, s[20:23], s26 offen lds
s_add_u32 m0, s28, 22528
s_mov_b32 s26, 262144
buffer_load_dwordx4 v76, s[20:23], s26 offen lds
s_add_u32 m0, s28, 23552
s_mov_b32 s26, 393216
buffer_load_dwordx4 v76, s[20:23], s26 offen lds
s_add_u32 m0, s28, 24576
s_mov_b32 s26, 524288
buffer_load_dwordx4 v76, s[20:23], s26 offen lds
s_add_u32 m0, s28, 25600
s_mov_b32 s26, 655360
buffer_load_dwordx4 v76, s[20:23], s26 offen lds
s_add_u32 m0, s28, 26624
s_mov_b32 s26, 786432
buffer_load_dwordx4 v76, s[20:23], s26 offen lds
s_add_u32 m0, s28, 27648
s_mov_b32 s26, 917504
buffer_load_dwordx4 v76, s[20:23], s26 offen lds
s_add_u32 m0, s28, 28672
s_mov_b32 s26, 1048576
buffer_load_dwordx4 v76, s[20:23], s26 offen lds
s_add_u32 m0, s28, 29696
s_mov_b32 s26, 1179648
buffer_load_dwordx4 v76, s[20:23], s26 offen lds
s_add_u32 m0, s28, 30720
s_mov_b32 s26, 1310720
buffer_load_dwordx4 v76, s[20:23], s26 offen lds
s_add_u32 m0, s28, 31744
s_mov_b32 s26, 1441792
buffer_load_dwordx4 v76, s[20:23], s26 offen lds
s_add_u32 m0, s28, 32768
s_mov_b32 s26, 1572864
buffer_load_dwordx4 v76, s[20:23], s26 offen lds
s_add_u32 m0, s28, 33792
s_mov_b32 s26, 1703936
buffer_load_dwordx4 v76, s[20:23], s26 offen lds
s_add_u32 m0, s28, 34816
s_mov_b32 s26, 1835008
buffer_load_dwordx4 v76, s[20:23], s26 offen lds
s_add_u32 m0, s28, 35840
s_mov_b32 s26, 1966080
buffer_load_dwordx4 v76, s[20:23], s26 offen lds
s_waitcnt vmcnt(18)
ds_read_b64_tr_b16 a[144:145], v79 offset:0
ds_read_b64_tr_b16 a[146:147], v79 offset:256
ds_read_b64_tr_b16 a[152:153], v79 offset:32
ds_read_b64_tr_b16 a[154:155], v79 offset:288
ds_read_b64_tr_b16 a[148:149], v79 offset:2048
ds_read_b64_tr_b16 a[150:151], v79 offset:2304
ds_read_b64_tr_b16 a[156:157], v79 offset:2080
ds_read_b64_tr_b16 a[158:159], v79 offset:2336
ds_read_b64_tr_b16 a[160:161], v79 offset:4096
ds_read_b64_tr_b16 a[162:163], v79 offset:4352
ds_read_b64_tr_b16 a[168:169], v79 offset:4128
ds_read_b64_tr_b16 a[170:171], v79 offset:4384
ds_read_b64_tr_b16 a[164:165], v79 offset:6144
ds_read_b64_tr_b16 a[166:167], v79 offset:6400
ds_read_b64_tr_b16 a[172:173], v79 offset:6176
ds_read_b64_tr_b16 a[174:175], v79 offset:6432
ds_read_b64_tr_b16 a[176:177], v79 offset:8192
ds_read_b64_tr_b16 a[178:179], v79 offset:8448
ds_read_b64_tr_b16 a[184:185], v79 offset:8224
ds_read_b64_tr_b16 a[186:187], v79 offset:8480
ds_read_b64_tr_b16 a[180:181], v79 offset:10240
ds_read_b64_tr_b16 a[182:183], v79 offset:10496
ds_read_b64_tr_b16 a[188:189], v79 offset:10272
ds_read_b64_tr_b16 a[190:191], v79 offset:10528
ds_read_b64_tr_b16 a[192:193], v79 offset:12288
ds_read_b64_tr_b16 a[194:195], v79 offset:12544
ds_read_b64_tr_b16 a[200:201], v79 offset:12320
ds_read_b64_tr_b16 a[202:203], v79 offset:12576
ds_read_b64_tr_b16 a[196:197], v79 offset:14336
ds_read_b64_tr_b16 a[198:199], v79 offset:14592
ds_read_b64_tr_b16 a[204:205], v79 offset:14368
ds_read_b64_tr_b16 a[206:207], v79 offset:14624
ds_read_b64_tr_b16 a[208:209], v79 offset:16384
ds_read_b64_tr_b16 a[210:211], v79 offset:16640
ds_read_b64_tr_b16 a[216:217], v79 offset:16416
ds_read_b64_tr_b16 a[218:219], v79 offset:16672
s_waitcnt lgkmcnt(0)
s_add_u32 m0, s28, 0
s_mov_b32 s26, 2097152
buffer_load_dwordx4 v76, s[20:23], s26 offen lds
s_add_u32 m0, s28, 1024
s_mov_b32 s26, 2228224
buffer_load_dwordx4 v76, s[20:23], s26 offen lds
s_add_u32 m0, s28, 2048
s_mov_b32 s26, 2359296
buffer_load_dwordx4 v76, s[20:23], s26 offen lds
s_add_u32 m0, s28, 3072
s_mov_b32 s26, 2490368
buffer_load_dwordx4 v76, s[20:23], s26 offen lds
s_add_u32 m0, s28, 4096
s_mov_b32 s26, 2621440
buffer_load_dwordx4 v76, s[20:23], s26 offen lds
s_add_u32 m0, s28, 5120
s_mov_b32 s26, 2752512
buffer_load_dwordx4 v76, s[20:23], s26 offen lds
s_add_u32 m0, s28, 6144
s_mov_b32 s26, 2883584
buffer_load_dwordx4 v76, s[20:23], s26 offen lds
s_add_u32 m0, s28, 7168
s_mov_b32 s26, 3014656
buffer_load_dwordx4 v76, s[20:23], s26 offen lds
s_add_u32 m0, s28, 8192
s_mov_b32 s26, 3145728
buffer_load_dwordx4 v76, s[20:23], s26 offen lds
s_add_u32 m0, s28, 9216
s_mov_b32 s26, 3276800
buffer_load_dwordx4 v76, s[20:23], s26 offen lds
s_add_u32 m0, s28, 10240
s_mov_b32 s26, 3407872
buffer_load_dwordx4 v76, s[20:23], s26 offen lds
s_add_u32 m0, s28, 11264
s_mov_b32 s26, 3538944
buffer_load_dwordx4 v76, s[20:23], s26 offen lds
s_add_u32 m0, s28, 12288
s_mov_b32 s26, 3670016
buffer_load_dwordx4 v76, s[20:23], s26 offen lds
s_add_u32 m0, s28, 13312
s_mov_b32 s26, 3801088
buffer_load_dwordx4 v76, s[20:23], s26 offen lds
s_add_u32 m0, s28, 14336
s_mov_b32 s26, 3932160
buffer_load_dwordx4 v76, s[20:23], s26 offen lds
s_add_u32 m0, s28, 15360
s_mov_b32 s26, 4063232
buffer_load_dwordx4 v76, s[20:23], s26 offen lds
s_add_u32 m0, s28, 16384
s_mov_b32 s26, 4194304
buffer_load_dwordx4 v76, s[20:23], s26 offen lds
s_add_u32 m0, s28, 17408
s_mov_b32 s26, 4325376
buffer_load_dwordx4 v76, s[20:23], s26 offen lds
s_waitcnt vmcnt(18)
ds_read_b64_tr_b16 a[212:213], v79 offset:18432
ds_read_b64_tr_b16 a[214:215], v79 offset:18688
ds_read_b64_tr_b16 a[220:221], v79 offset:18464
ds_read_b64_tr_b16 a[222:223], v79 offset:18720
ds_read_b64_tr_b16 a[224:225], v79 offset:20480
ds_read_b64_tr_b16 a[226:227], v79 offset:20736
ds_read_b64_tr_b16 a[232:233], v79 offset:20512
ds_read_b64_tr_b16 a[234:235], v79 offset:20768
ds_read_b64_tr_b16 a[228:229], v79 offset:22528
ds_read_b64_tr_b16 a[230:231], v79 offset:22784
ds_read_b64_tr_b16 a[236:237], v79 offset:22560
ds_read_b64_tr_b16 a[238:239], v79 offset:22816
ds_read_b64_tr_b16 a[240:241], v79 offset:24576
ds_read_b64_tr_b16 a[242:243], v79 offset:24832
ds_read_b64_tr_b16 a[248:249], v79 offset:24608
ds_read_b64_tr_b16 a[250:251], v79 offset:24864
ds_read_b64_tr_b16 a[244:245], v79 offset:26624
ds_read_b64_tr_b16 a[246:247], v79 offset:26880
ds_read_b64_tr_b16 a[252:253], v79 offset:26656
ds_read_b64_tr_b16 a[254:255], v79 offset:26912
ds_read_b64_tr_b16 v[80:81], v79 offset:28672
ds_read_b64_tr_b16 v[82:83], v79 offset:28928
ds_read_b64_tr_b16 v[88:89], v79 offset:28704
ds_read_b64_tr_b16 v[90:91], v79 offset:28960
ds_read_b64_tr_b16 v[84:85], v79 offset:30720
ds_read_b64_tr_b16 v[86:87], v79 offset:30976
ds_read_b64_tr_b16 v[92:93], v79 offset:30752
ds_read_b64_tr_b16 v[94:95], v79 offset:31008
ds_read_b64_tr_b16 v[96:97], v79 offset:32768
ds_read_b64_tr_b16 v[98:99], v79 offset:33024
ds_read_b64_tr_b16 v[104:105], v79 offset:32800
ds_read_b64_tr_b16 v[106:107], v79 offset:33056
ds_read_b64_tr_b16 v[100:101], v79 offset:34816
ds_read_b64_tr_b16 v[102:103], v79 offset:35072
ds_read_b64_tr_b16 v[108:109], v79 offset:34848
ds_read_b64_tr_b16 v[110:111], v79 offset:35104
s_waitcnt lgkmcnt(0)
s_add_u32 m0, s28, 18432
s_mov_b32 s26, 4456448
buffer_load_dwordx4 v76, s[20:23], s26 offen lds
s_add_u32 m0, s28, 19456
s_mov_b32 s26, 4587520
buffer_load_dwordx4 v76, s[20:23], s26 offen lds
s_add_u32 m0, s28, 20480
s_mov_b32 s26, 256
buffer_load_dwordx4 v77, s[64:67], s26 offen lds
s_add_u32 m0, s28, 21504
s_mov_b32 s26, 9472
buffer_load_dwordx4 v77, s[64:67], s26 offen lds
s_add_u32 m0, s28, 22528
s_mov_b32 s26, 37120
buffer_load_dwordx4 v77, s[64:67], s26 offen lds
s_add_u32 m0, s28, 23552
s_mov_b32 s26, 46336
buffer_load_dwordx4 v77, s[64:67], s26 offen lds
s_add_u32 m0, s28, 24576
s_mov_b32 s26, 73984
buffer_load_dwordx4 v77, s[64:67], s26 offen lds
s_add_u32 m0, s28, 25600
s_mov_b32 s26, 83200
buffer_load_dwordx4 v77, s[64:67], s26 offen lds
s_add_u32 m0, s28, 26624
s_mov_b32 s26, 110848
buffer_load_dwordx4 v77, s[64:67], s26 offen lds
s_add_u32 m0, s28, 27648
s_mov_b32 s26, 120064
buffer_load_dwordx4 v77, s[64:67], s26 offen lds
s_add_u32 m0, s28, 28672
s_mov_b32 s26, 768
buffer_load_dwordx4 v77, s[64:67], s26 offen lds
s_add_u32 m0, s28, 29696
s_mov_b32 s26, 9984
buffer_load_dwordx4 v77, s[64:67], s26 offen lds
s_add_u32 m0, s28, 30720
s_mov_b32 s26, 37632
buffer_load_dwordx4 v77, s[64:67], s26 offen lds
s_add_u32 m0, s28, 31744
s_mov_b32 s26, 46848
buffer_load_dwordx4 v77, s[64:67], s26 offen lds
s_add_u32 m0, s28, 32768
s_mov_b32 s26, 1024
buffer_load_dwordx4 v78, s[64:67], s26 offen lds
s_add_u32 m0, s28, 33792
s_mov_b32 s26, 10240
buffer_load_dwordx4 v78, s[64:67], s26 offen lds
s_add_u32 m0, s28, 34816
s_mov_b32 s26, 37888
buffer_load_dwordx4 v78, s[64:67], s26 offen lds
s_add_u32 m0, s28, 35840
s_mov_b32 s26, 47104
buffer_load_dwordx4 v78, s[64:67], s26 offen lds
s_waitcnt vmcnt(18)
ds_read_b64_tr_b16 v[112:113], v79 offset:0
ds_read_b64_tr_b16 v[114:115], v79 offset:256
ds_read_b64_tr_b16 v[120:121], v79 offset:32
ds_read_b64_tr_b16 v[122:123], v79 offset:288
ds_read_b64_tr_b16 v[116:117], v79 offset:2048
ds_read_b64_tr_b16 v[118:119], v79 offset:2304
ds_read_b64_tr_b16 v[124:125], v79 offset:2080
ds_read_b64_tr_b16 v[126:127], v79 offset:2336
ds_read_b64_tr_b16 v[128:129], v79 offset:4096
ds_read_b64_tr_b16 v[130:131], v79 offset:4352
ds_read_b64_tr_b16 v[136:137], v79 offset:4128
ds_read_b64_tr_b16 v[138:139], v79 offset:4384
ds_read_b64_tr_b16 v[132:133], v79 offset:6144
ds_read_b64_tr_b16 v[134:135], v79 offset:6400
ds_read_b64_tr_b16 v[140:141], v79 offset:6176
ds_read_b64_tr_b16 v[142:143], v79 offset:6432
ds_read_b64_tr_b16 v[144:145], v79 offset:8192
ds_read_b64_tr_b16 v[146:147], v79 offset:8448
ds_read_b64_tr_b16 v[152:153], v79 offset:8224
ds_read_b64_tr_b16 v[154:155], v79 offset:8480
ds_read_b64_tr_b16 v[148:149], v79 offset:10240
ds_read_b64_tr_b16 v[150:151], v79 offset:10496
ds_read_b64_tr_b16 v[156:157], v79 offset:10272
ds_read_b64_tr_b16 v[158:159], v79 offset:10528
ds_read_b64_tr_b16 v[160:161], v79 offset:12288
ds_read_b64_tr_b16 v[162:163], v79 offset:12544
ds_read_b64_tr_b16 v[168:169], v79 offset:12320
ds_read_b64_tr_b16 v[170:171], v79 offset:12576
ds_read_b64_tr_b16 v[164:165], v79 offset:14336
ds_read_b64_tr_b16 v[166:167], v79 offset:14592
ds_read_b64_tr_b16 v[172:173], v79 offset:14368
ds_read_b64_tr_b16 v[174:175], v79 offset:14624
ds_read_b64_tr_b16 v[176:177], v79 offset:16384
ds_read_b64_tr_b16 v[178:179], v79 offset:16640
ds_read_b64_tr_b16 v[184:185], v79 offset:16416
ds_read_b64_tr_b16 v[186:187], v79 offset:16672
s_waitcnt lgkmcnt(0)
s_add_u32 m0, s28, 0
s_mov_b32 s26, 74752
buffer_load_dwordx4 v78, s[64:67], s26 offen lds
s_add_u32 m0, s28, 1024
s_mov_b32 s26, 83968
buffer_load_dwordx4 v78, s[64:67], s26 offen lds
s_add_u32 m0, s28, 2048
s_mov_b32 s26, 111616
buffer_load_dwordx4 v78, s[64:67], s26 offen lds
s_add_u32 m0, s28, 3072
s_mov_b32 s26, 120832
buffer_load_dwordx4 v78, s[64:67], s26 offen lds
s_waitcnt vmcnt(4)
ds_read_b64_tr_b16 v[180:181], v79 offset:18432
ds_read_b64_tr_b16 v[182:183], v79 offset:18688
ds_read_b64_tr_b16 v[188:189], v79 offset:18464
ds_read_b64_tr_b16 v[190:191], v79 offset:18720
ds_read_b64_tr_b16 v[192:193], v79 offset:20480
ds_read_b64_tr_b16 v[194:195], v79 offset:20736
ds_read_b64_tr_b16 v[208:209], v79 offset:20512
ds_read_b64_tr_b16 v[210:211], v79 offset:20768
ds_read_b64_tr_b16 v[196:197], v79 offset:22528
ds_read_b64_tr_b16 v[198:199], v79 offset:22784
ds_read_b64_tr_b16 v[212:213], v79 offset:22560
ds_read_b64_tr_b16 v[214:215], v79 offset:22816
ds_read_b64_tr_b16 v[200:201], v79 offset:24576
ds_read_b64_tr_b16 v[202:203], v79 offset:24832
ds_read_b64_tr_b16 v[216:217], v79 offset:24608
ds_read_b64_tr_b16 v[218:219], v79 offset:24864
ds_read_b64_tr_b16 v[204:205], v79 offset:26624
ds_read_b64_tr_b16 v[206:207], v79 offset:26880
ds_read_b64_tr_b16 v[220:221], v79 offset:26656
ds_read_b64_tr_b16 v[222:223], v79 offset:26912
ds_read_b64_tr_b16 v[224:225], v79 offset:28672
ds_read_b64_tr_b16 v[226:227], v79 offset:28928
ds_read_b64_tr_b16 v[232:233], v79 offset:28704
ds_read_b64_tr_b16 v[234:235], v79 offset:28960
ds_read_b64_tr_b16 v[228:229], v79 offset:30720
ds_read_b64_tr_b16 v[230:231], v79 offset:30976
ds_read_b64_tr_b16 v[236:237], v79 offset:30752
ds_read_b64_tr_b16 v[238:239], v79 offset:31008
ds_read_b64_tr_b16 v[240:241], v79 offset:32768
ds_read_b64_tr_b16 v[242:243], v79 offset:33024
ds_read_b64_tr_b16 v[244:245], v79 offset:34816
ds_read_b64_tr_b16 v[246:247], v79 offset:35072
s_waitcnt lgkmcnt(0)
s_waitcnt vmcnt(0)
ds_read_b64_tr_b16 v[248:249], v79 offset:0
ds_read_b64_tr_b16 v[250:251], v79 offset:256
ds_read_b64_tr_b16 v[252:253], v79 offset:2048
ds_read_b64_tr_b16 v[254:255], v79 offset:2304
s_waitcnt lgkmcnt(0)
s_add_u32 m0, s28, 0
s_mov_b32 s26, 0
buffer_load_dwordx4 v76, s[8:11], s26 offen lds
s_add_u32 m0, s28, 1024
s_mov_b32 s26, 131072
buffer_load_dwordx4 v76, s[8:11], s26 offen lds
s_add_u32 m0, s28, 2048
s_mov_b32 s26, 262144
buffer_load_dwordx4 v76, s[8:11], s26 offen lds
s_add_u32 m0, s28, 3072
s_mov_b32 s26, 393216
buffer_load_dwordx4 v76, s[8:11], s26 offen lds
s_add_u32 m0, s28, 4096
s_mov_b32 s26, 1572864
buffer_load_dwordx4 v76, s[8:11], s26 offen lds
s_add_u32 m0, s28, 5120
s_mov_b32 s26, 1703936
buffer_load_dwordx4 v76, s[8:11], s26 offen lds
s_add_u32 m0, s28, 6144
s_mov_b32 s26, 1835008
buffer_load_dwordx4 v76, s[8:11], s26 offen lds
s_add_u32 m0, s28, 7168
s_mov_b32 s26, 1966080
buffer_load_dwordx4 v76, s[8:11], s26 offen lds
s_add_u32 m0, s28, 8192
s_mov_b32 s26, 2621440
buffer_load_dwordx4 v76, s[8:11], s26 offen lds
s_add_u32 m0, s28, 9216
s_mov_b32 s26, 2752512
buffer_load_dwordx4 v76, s[8:11], s26 offen lds
s_add_u32 m0, s28, 10240
s_mov_b32 s26, 2883584
buffer_load_dwordx4 v76, s[8:11], s26 offen lds
s_add_u32 m0, s28, 11264
s_mov_b32 s26, 3014656
buffer_load_dwordx4 v76, s[8:11], s26 offen lds
s_add_u32 m0, s28, 12288
s_mov_b32 s26, 3670016
buffer_load_dwordx4 v76, s[8:11], s26 offen lds
s_add_u32 m0, s28, 13312
s_mov_b32 s26, 3801088
buffer_load_dwordx4 v76, s[8:11], s26 offen lds
s_add_u32 m0, s28, 14336
s_mov_b32 s26, 3932160
buffer_load_dwordx4 v76, s[8:11], s26 offen lds
s_add_u32 m0, s28, 15360
s_mov_b32 s26, 4063232
buffer_load_dwordx4 v76, s[8:11], s26 offen lds
s_add_u32 m0, s28, 16384
s_mov_b32 s26, 0
buffer_load_dwordx4 v77, s[64:67], s26 offen lds
s_add_u32 m0, s28, 17408
s_mov_b32 s26, 9216
buffer_load_dwordx4 v77, s[64:67], s26 offen lds
s_add_u32 m0, s28, 18432
s_mov_b32 s26, 36864
buffer_load_dwordx4 v77, s[64:67], s26 offen lds
s_add_u32 m0, s28, 19456
s_mov_b32 s26, 46080
buffer_load_dwordx4 v77, s[64:67], s26 offen lds
s_add_u32 m0, s28, 20480
s_mov_b32 s26, 73728
buffer_load_dwordx4 v77, s[64:67], s26 offen lds
s_add_u32 m0, s28, 21504
s_mov_b32 s26, 82944
buffer_load_dwordx4 v77, s[64:67], s26 offen lds
s_add_u32 m0, s28, 22528
s_mov_b32 s26, 110592
buffer_load_dwordx4 v77, s[64:67], s26 offen lds
s_add_u32 m0, s28, 23552
s_mov_b32 s26, 119808
buffer_load_dwordx4 v77, s[64:67], s26 offen lds
s_add_u32 m0, s28, 24576
s_mov_b32 s26, 512
buffer_load_dwordx4 v77, s[64:67], s26 offen lds
s_add_u32 m0, s28, 25600
s_mov_b32 s26, 9728
buffer_load_dwordx4 v77, s[64:67], s26 offen lds
s_add_u32 m0, s28, 26624
s_mov_b32 s26, 37376
buffer_load_dwordx4 v77, s[64:67], s26 offen lds
s_add_u32 m0, s28, 27648
s_mov_b32 s26, 46592
buffer_load_dwordx4 v77, s[64:67], s26 offen lds
s_add_u32 m0, s28, 28672
s_mov_b32 s26, 74240
buffer_load_dwordx4 v77, s[64:67], s26 offen lds
s_add_u32 m0, s28, 29696
s_mov_b32 s26, 83456
buffer_load_dwordx4 v77, s[64:67], s26 offen lds
s_add_u32 m0, s28, 30720
s_mov_b32 s26, 111104
buffer_load_dwordx4 v77, s[64:67], s26 offen lds
s_add_u32 m0, s28, 31744
s_mov_b32 s26, 120320
buffer_load_dwordx4 v77, s[64:67], s26 offen lds
s_add_u32 m0, s28, 32768
s_mov_b32 s26, 74496
buffer_load_dwordx4 v77, s[64:67], s26 offen lds
s_add_u32 m0, s28, 33792
s_mov_b32 s26, 83712
buffer_load_dwordx4 v77, s[64:67], s26 offen lds
s_add_u32 m0, s28, 34816
s_mov_b32 s26, 111360
buffer_load_dwordx4 v77, s[64:67], s26 offen lds
s_add_u32 m0, s28, 35840
s_mov_b32 s26, 120576
buffer_load_dwordx4 v77, s[64:67], s26 offen lds
s_waitcnt vmcnt(32)
ds_read_b64_tr_b16 v[8:9], v79 offset:0
ds_read_b64_tr_b16 v[10:11], v79 offset:256
ds_read_b64_tr_b16 v[16:17], v79 offset:32
ds_read_b64_tr_b16 v[18:19], v79 offset:288
ds_read_b64_tr_b16 v[12:13], v79 offset:2048
ds_read_b64_tr_b16 v[14:15], v79 offset:2304
ds_read_b64_tr_b16 v[20:21], v79 offset:2080
ds_read_b64_tr_b16 v[22:23], v79 offset:2336
s_waitcnt lgkmcnt(0)
ds_write_b128 v6, v[8:11] offset:0
ds_write_b128 v6, v[12:15] offset:1024
ds_write_b128 v6, v[16:19] offset:2048
ds_write_b128 v6, v[20:23] offset:3072
s_waitcnt lgkmcnt(0)
s_waitcnt vmcnt(28)
ds_read_b64_tr_b16 v[8:9], v79 offset:4096
ds_read_b64_tr_b16 v[10:11], v79 offset:4352
ds_read_b64_tr_b16 v[16:17], v79 offset:4128
ds_read_b64_tr_b16 v[18:19], v79 offset:4384
ds_read_b64_tr_b16 v[12:13], v79 offset:6144
ds_read_b64_tr_b16 v[14:15], v79 offset:6400
ds_read_b64_tr_b16 v[20:21], v79 offset:6176
ds_read_b64_tr_b16 v[22:23], v79 offset:6432
s_waitcnt lgkmcnt(0)
ds_write_b128 v6, v[8:11] offset:4096
ds_write_b128 v6, v[12:15] offset:5120
ds_write_b128 v6, v[16:19] offset:6144
ds_write_b128 v6, v[20:23] offset:7168
s_waitcnt lgkmcnt(0)
s_waitcnt vmcnt(24)
ds_read_b64_tr_b16 v[8:9], v79 offset:8192
ds_read_b64_tr_b16 v[10:11], v79 offset:8448
ds_read_b64_tr_b16 v[16:17], v79 offset:8224
ds_read_b64_tr_b16 v[18:19], v79 offset:8480
ds_read_b64_tr_b16 v[12:13], v79 offset:10240
ds_read_b64_tr_b16 v[14:15], v79 offset:10496
ds_read_b64_tr_b16 v[20:21], v79 offset:10272
ds_read_b64_tr_b16 v[22:23], v79 offset:10528
s_waitcnt lgkmcnt(0)
ds_write_b128 v6, v[8:11] offset:8192
ds_write_b128 v6, v[12:15] offset:9216
ds_write_b128 v6, v[16:19] offset:10240
ds_write_b128 v6, v[20:23] offset:11264
s_waitcnt lgkmcnt(0)
s_waitcnt vmcnt(20)
ds_read_b64_tr_b16 v[8:9], v79 offset:12288
ds_read_b64_tr_b16 v[10:11], v79 offset:12544
ds_read_b64_tr_b16 v[16:17], v79 offset:12320
ds_read_b64_tr_b16 v[18:19], v79 offset:12576
ds_read_b64_tr_b16 v[12:13], v79 offset:14336
ds_read_b64_tr_b16 v[14:15], v79 offset:14592
ds_read_b64_tr_b16 v[20:21], v79 offset:14368
ds_read_b64_tr_b16 v[22:23], v79 offset:14624
s_waitcnt lgkmcnt(0)
ds_write_b128 v6, v[8:11] offset:12288
ds_write_b128 v6, v[12:15] offset:13312
ds_write_b128 v6, v[16:19] offset:14336
ds_write_b128 v6, v[20:23] offset:15360
s_waitcnt lgkmcnt(0)
s_waitcnt vmcnt(16)
ds_read_b64_tr_b16 v[8:9], v79 offset:16384
ds_read_b64_tr_b16 v[10:11], v79 offset:16640
ds_read_b64_tr_b16 v[16:17], v79 offset:16416
ds_read_b64_tr_b16 v[18:19], v79 offset:16672
ds_read_b64_tr_b16 v[12:13], v79 offset:18432
ds_read_b64_tr_b16 v[14:15], v79 offset:18688
ds_read_b64_tr_b16 v[20:21], v79 offset:18464
ds_read_b64_tr_b16 v[22:23], v79 offset:18720
s_waitcnt lgkmcnt(0)
ds_write_b128 v6, v[8:11] offset:16384
ds_write_b128 v6, v[12:15] offset:17408
ds_write_b128 v6, v[16:19] offset:18432
ds_write_b128 v6, v[20:23] offset:19456
s_waitcnt lgkmcnt(0)
s_waitcnt vmcnt(12)
ds_read_b64_tr_b16 v[8:9], v79 offset:20480
ds_read_b64_tr_b16 v[10:11], v79 offset:20736
ds_read_b64_tr_b16 v[16:17], v79 offset:20512
ds_read_b64_tr_b16 v[18:19], v79 offset:20768
ds_read_b64_tr_b16 v[12:13], v79 offset:22528
ds_read_b64_tr_b16 v[14:15], v79 offset:22784
ds_read_b64_tr_b16 v[20:21], v79 offset:22560
ds_read_b64_tr_b16 v[22:23], v79 offset:22816
s_waitcnt lgkmcnt(0)
ds_write_b128 v6, v[8:11] offset:20480
ds_write_b128 v6, v[12:15] offset:21504
ds_write_b128 v6, v[16:19] offset:22528
ds_write_b128 v6, v[20:23] offset:23552
s_waitcnt lgkmcnt(0)
s_waitcnt vmcnt(8)
ds_read_b64_tr_b16 v[8:9], v79 offset:24576
ds_read_b64_tr_b16 v[10:11], v79 offset:24832
ds_read_b64_tr_b16 v[16:17], v79 offset:24608
ds_read_b64_tr_b16 v[18:19], v79 offset:24864
ds_read_b64_tr_b16 v[12:13], v79 offset:26624
ds_read_b64_tr_b16 v[14:15], v79 offset:26880
ds_read_b64_tr_b16 v[20:21], v79 offset:26656
ds_read_b64_tr_b16 v[22:23], v79 offset:26912
s_waitcnt lgkmcnt(0)
ds_write_b128 v6, v[8:11] offset:24576
ds_write_b128 v6, v[12:15] offset:25600
ds_write_b128 v6, v[16:19] offset:26624
ds_write_b128 v6, v[20:23] offset:27648
s_waitcnt lgkmcnt(0)
s_waitcnt vmcnt(4)
ds_read_b64_tr_b16 v[8:9], v79 offset:28672
ds_read_b64_tr_b16 v[10:11], v79 offset:28928
ds_read_b64_tr_b16 v[16:17], v79 offset:28704
ds_read_b64_tr_b16 v[18:19], v79 offset:28960
ds_read_b64_tr_b16 v[12:13], v79 offset:30720
ds_read_b64_tr_b16 v[14:15], v79 offset:30976
ds_read_b64_tr_b16 v[20:21], v79 offset:30752
ds_read_b64_tr_b16 v[22:23], v79 offset:31008
s_waitcnt lgkmcnt(0)
ds_write_b128 v6, v[8:11] offset:28672
ds_write_b128 v6, v[12:15] offset:29696
ds_write_b128 v6, v[16:19] offset:30720
ds_write_b128 v6, v[20:23] offset:31744
s_waitcnt lgkmcnt(0)
s_waitcnt vmcnt(0)
ds_read_b64_tr_b16 v[8:9], v79 offset:32768
ds_read_b64_tr_b16 v[10:11], v79 offset:33024
ds_read_b64_tr_b16 v[16:17], v79 offset:32800
ds_read_b64_tr_b16 v[18:19], v79 offset:33056
ds_read_b64_tr_b16 v[12:13], v79 offset:34816
ds_read_b64_tr_b16 v[14:15], v79 offset:35072
ds_read_b64_tr_b16 v[20:21], v79 offset:34848
ds_read_b64_tr_b16 v[22:23], v79 offset:35104
s_waitcnt lgkmcnt(0)
ds_write_b128 v6, v[8:11] offset:32768
ds_write_b128 v6, v[12:15] offset:33792
ds_write_b128 v6, v[16:19] offset:34816
ds_write_b128 v6, v[20:23] offset:35840
s_waitcnt lgkmcnt(0)
v_and_b32 v50, 15, v0
s_mov_b32 s55, 0x3f80
v_lshrrev_b32 v51, 2, v50
v_lshrrev_b32 v52, 4, v0
v_and_b32 v53, 3, v0
v_lshlrev_b32 v4, 8, v51
v_lshl_add_u32 v4, v52, 6, v4
v_lshl_add_u32 v4, v53, 2, v4
s_lshl_b32 s26, s24, 10
s_add_u32 s26, s26, 3072
v_add_u32 v4, s26, v4
v_cmp_le_u32 s[44:45], 2, v53
v_and_b32 v53, 1, v0
v_lshlrev_b32 v51, 6, v51
v_lshl_add_u32 v51, v53, 4, v51
v_and_b32 v54, 1, v52
v_lshl_add_u32 v51, v54, 5, v51
v_lshrrev_b32 v54, 1, v52
v_lshl_add_u32 v51, v54, 8, v51
s_lshl_b32 s26, s24, 9
v_add_u32 v5, s26, v51
v_mov_b32 v55, 128
s_mov_b32 s29, 0
Lwf27:
buffer_load_dword v56, v55, s[16:19], 0 offen sc1
s_add_u32 s29, s29, 1
s_waitcnt vmcnt(0)
v_cmp_eq_u32 vcc, 0, v56
s_cbranch_vccz Lwd28
s_sleep 2
s_cmp_lt_u32 s29, s25
s_cbranch_scc1 Lwf27
s_mov_b32 s25, 0
Lwd28:
v_and_b32 v55, 31, v0
v_lshlrev_b32 v55, 2, v55
s_mov_b32 s29, 0
Lwf29:
buffer_load_dword v56, v55, s[16:19], 0 offen sc1
s_add_u32 s29, s29, 1
s_waitcnt vmcnt(0)
v_cmp_eq_u32 vcc, 0, v56
s_cbranch_vccz Lwd30
s_sleep 2
s_cmp_lt_u32 s29, s25
s_cbranch_scc1 Lwf29
s_mov_b32 s25, 0
Lwd30:
v_cmp_ne_u32 vcc, s54, v56
v_mov_b32 v51, 0x4444
v_mov_b32 v52, 0xeeee
s_mov_b32 s30, 0x3e0293ee
s_mov_b32 s31, 1
s_mov_b32 s36, 0
v_cndmask_b32 v0, v51, v52, s[44:45]
s_waitcnt lgkmcnt(0)
s_barrier
s_cbranch_vccnz CH_far
s_cmp_eq_u32 s24, 0
s_cbranch_scc1 CHn0_layer
s_cmp_eq_u32 s24, 1
s_cbranch_scc1 CHn1_layer
s_cmp_eq_u32 s24, 2
s_cbranch_scc1 CHn2_layer
s_branch CHn3_layer
CH_far:
s_cmp_eq_u32 s24, 0
s_cbranch_scc1 CHf0_layer
s_cmp_eq_u32 s24, 1
s_cbranch_scc1 CHf1_layer
s_cmp_eq_u32 s24, 2
s_cbranch_scc1 CHf2_layer
s_branch CHf3_layer
s_nop 7
CHn0_layer:
s_mov_b32 s37, 0
s_lshl_b32 s43, s52, 1
s_add_u32 s43, s43, s36
s_lshl_b32 s43, s43, 8
s_lshl_b32 s42, s36, 5
s_add_u32 s42, s42, s52
s_lshl_b32 s38, s42, 20
s_add_u32 s38, s38, 58720256
s_lshl_b32 s42, s42, 18
s_add_u32 s42, s42, 25165824
v_bfe_u32 v76, v1, 6, 2
v_bfe_u32 v77, v1, 4, 1
v_lshl_add_u32 v76, v76, 1, v77
v_mul_u32_u24 v76, 1152, v76
v_bfe_u32 v77, v1, 5, 1
v_lshl_add_u32 v76, v77, 4, v76
v_lshrrev_b32 v77, 8, v1
v_lshl_add_u32 v76, v77, 5, v76
buffer_load_dwordx4 v[8:11], v76, s[32:35], 0 offen offset:0
buffer_load_dwordx4 v[12:15], v76, s[32:35], 0 offen offset:128
buffer_load_dwordx4 v[16:19], v76, s[32:35], 0 offen offset:256
s_barrier
s_add_u32 s41, s38, 0
s_mov_b32 m0, 8192
s_nop 0
buffer_load_dwordx4 v1, s[4:7], s41 offen offset:0 sc1 lds
buffer_load_dwordx4 v1, s[4:7], s41 offen offset:1024 sc1 lds
buffer_load_dwordx4 v1, s[4:7], s41 offen offset:2048 sc1 lds
s_add_u32 s40, s56, 0
v_mov_b64 v[44:45], 0
v_mov_b64 v[46:47], 0
v_mov_b64 v[48:49], 0
v_mov_b64 v[50:51], 0
v_mov_b64 v[52:53], 0
v_mov_b64 v[54:55], 0
v_mov_b64 v[56:57], 0
v_mov_b64 v[58:59], 0
ds_read_b128 v[60:63], v6 offset:0
ds_read_b128 v[64:67], v6 offset:1024
ds_read_b128 v[68:71], v6 offset:2048
ds_read_b128 v[72:75], v6 offset:3072
CHn0_step:
s_mov_b32 s29, 0
s_waitcnt vmcnt(0)
Lgc31:
v_max3_u32 v76, v8, v9, v10
v_max3_u32 v77, v12, v13, v14
v_max3_u32 v78, v16, v17, v18
v_max_u32 v76, v76, v11
v_max_u32 v77, v77, v15
v_max_u32 v78, v78, v19
v_cmp_eq_u32 s[94:95], -1, v76
v_cmp_eq_u32 vcc, -1, v77
v_cmp_eq_u32 s[50:51], -1, v78
s_or_b64 s[68:69], s[94:95], vcc
s_or_b64 s[68:69], s[68:69], s[50:51]
s_cbranch_scc0 Lgd32
s_mov_b64 exec, s[94:95]
buffer_load_dwordx4 v[8:11], v1, s[4:7], s40 offen offset:0 sc1
s_mov_b64 exec, vcc
buffer_load_dwordx4 v[12:15], v1, s[4:7], s40 offen offset:1024 sc1
s_mov_b64 exec, s[50:51]
buffer_load_dwordx4 v[16:19], v1, s[4:7], s40 offen offset:2048 sc1
s_mov_b64 exec, -1
s_add_u32 s29, s29, 1
s_add_u32 s90, s90, 1
s_cmp_lt_u32 s29, s25
s_waitcnt vmcnt(0)
s_cbranch_scc1 Lgc31
s_mov_b32 s25, 0
Lgd32:
ds_write_b128 v1, v[8:11] offset:0
ds_write_b128 v1, v[12:15] offset:1024
s_cmp_lt_u32 s37, 63
s_cselect_b32 s40, 16384, 0
s_add_u32 s40, s40, s38
s_add_u32 s40, s40, 0
v_lshlrev_b32 v7, 3, v1
s_add_u32 s41, s38, 8192
s_add_u32 s39, s56, 2048
s_cmp_eq_u32 s37, 0
s_waitcnt lgkmcnt(4)
v_smfmac_f32_16x16x64_bf16 v[44:47], v[8:11], v[60:67], v0
s_waitcnt lgkmcnt(2)
ds_read_b128 v[60:63], v6 offset:4096
v_smfmac_f32_16x16x64_bf16 v[48:51], v[8:11], v[68:75], v0
ds_read_b128 v[64:67], v6 offset:5120
v_smfmac_f32_16x16x64_bf16 v[52:55], v[8:11], a[80:87], v0
s_waitcnt lgkmcnt(2)
s_barrier
ds_read_b128 v[20:23], v1 offset:2048
v_smfmac_f32_16x16x64_bf16 v[56:59], v[8:11], a[88:95], v0
ds_read_b128 v[24:27], v1 offset:3072
v_smfmac_f32_16x16x64_bf16 v[52:55], v[12:15], a[96:103], v0
ds_read_b128 v[28:31], v1 offset:4096
buffer_load_dwordx4 v[68:71], v1, s[4:7], s41 offen offset:0 sc1
v_smfmac_f32_16x16x64_bf16 v[56:59], v[12:15], a[104:111], v0
ds_read_b128 v[32:35], v1 offset:5120
buffer_load_dwordx4 v[72:75], v1, s[4:7], s41 offen offset:1024 sc1
v_smfmac_f32_16x16x64_bf16 v[52:55], v[16:19], a[112:119], v0
ds_read_b128 v[36:39], v1 offset:6144
v_smfmac_f32_16x16x64_bf16 v[56:59], v[16:19], a[120:127], v0
s_waitcnt lgkmcnt(4)
ds_read_b128 v[40:43], v1 offset:7168
v_smfmac_f32_16x16x64_bf16 v[44:47], v[20:23], v[60:67], v0
ds_read_b128 v[60:63], v6 offset:6144
ds_read_b128 v[64:67], v6 offset:7168
v_smfmac_f32_16x16x64_bf16 v[52:55], v[20:23], a[128:135], v0
v_smfmac_f32_16x16x64_bf16 v[56:59], v[20:23], a[136:143], v0
s_waitcnt lgkmcnt(6)
buffer_load_dword v7, v7, s[4:7], s40 offen sc1
v_smfmac_f32_16x16x64_bf16 v[52:55], v[24:27], a[144:151], v0
v_smfmac_f32_16x16x64_bf16 v[56:59], v[24:27], a[152:159], v0
s_waitcnt lgkmcnt(0)
v_smfmac_f32_16x16x64_bf16 v[48:51], v[20:23], v[60:67], v0
ds_read_b128 v[60:63], v6 offset:8192
ds_read_b128 v[64:67], v6 offset:9216
v_smfmac_f32_16x16x64_bf16 v[52:55], v[28:31], a[160:167], v0
s_barrier
v_smfmac_f32_16x16x64_bf16 v[56:59], v[28:31], a[168:175], v0
v_smfmac_f32_16x16x64_bf16 v[52:55], v[32:35], a[176:183], v0
v_smfmac_f32_16x16x64_bf16 v[56:59], v[32:35], a[184:191], v0
s_waitcnt lgkmcnt(0)
v_smfmac_f32_16x16x64_bf16 v[44:47], v[28:31], v[60:67], v0
ds_read_b128 v[60:63], v6 offset:10240
ds_read_b128 v[64:67], v6 offset:11264
v_smfmac_f32_16x16x64_bf16 v[52:55], v[36:39], a[192:199], v0
v_smfmac_f32_16x16x64_bf16 v[56:59], v[36:39], a[200:207], v0
v_smfmac_f32_16x16x64_bf16 v[52:55], v[40:43], a[208:215], v0
v_smfmac_f32_16x16x64_bf16 v[56:59], v[40:43], a[216:223], v0
s_waitcnt lgkmcnt(0)
v_smfmac_f32_16x16x64_bf16 v[48:51], v[28:31], v[60:67], v0
ds_read_b128 v[60:63], v6 offset:12288
ds_read_b128 v[64:67], v6 offset:13312
v_smfmac_f32_16x16x64_bf16 v[44:47], v[12:15], a[0:7], v0
v_smfmac_f32_16x16x64_bf16 v[48:51], v[12:15], a[8:15], v0
v_smfmac_f32_16x16x64_bf16 v[44:47], v[16:19], a[16:23], v0
v_add_f32 v52, v52, v54
v_smfmac_f32_16x16x64_bf16 v[48:51], v[16:19], a[24:31], v0
s_waitcnt lgkmcnt(0)
v_add_f32 v56, v56, v58
v_smfmac_f32_16x16x64_bf16 v[44:47], v[36:39], v[60:67], v0
ds_read_b128 v[60:63], v6 offset:14336
ds_read_b128 v[64:67], v6 offset:15360
v_add_f32 v53, v53, v55
v_smfmac_f32_16x16x64_bf16 v[44:47], v[24:27], a[32:39], v0
v_add_f32 v57, v57, v59
v_smfmac_f32_16x16x64_bf16 v[48:51], v[24:27], a[40:47], v0
v_cvt_pk_bf16_f32 v78, v52, v56
v_smfmac_f32_16x16x64_bf16 v[44:47], v[32:35], a[48:55], v0
s_waitcnt lgkmcnt(0)
v_cvt_pk_bf16_f32 v79, v53, v57
v_smfmac_f32_16x16x64_bf16 v[48:51], v[36:39], v[60:67], v0
v_smfmac_f32_16x16x64_bf16 v[48:51], v[32:35], a[56:63], v0
ds_write2_b32 v4, v78, v79 offset0:0 offset1:4
v_mov_b64 v[60:61], 0
v_smfmac_f32_16x16x64_bf16 v[44:47], v[40:43], a[64:71], v0
v_mov_b64 v[62:63], 0
v_smfmac_f32_16x16x64_bf16 v[48:51], v[40:43], a[72:79], v0
v_mov_b64 v[64:65], 0
v_mov_b64 v[66:67], 0
v_smfmac_f32_16x16x64_bf16 v[60:63], v[8:11], a[224:231], v0
v_add_f32 v44, v44, v46
v_add_f32 v45, v45, v47
v_smfmac_f32_16x16x64_bf16 v[64:67], v[8:11], a[232:239], v0
v_add_f32 v48, v48, v50
v_add_f32 v49, v49, v51
v_smfmac_f32_16x16x64_bf16 v[60:63], v[12:15], a[240:247], v0
v_cvt_pk_bf16_f32 v76, v44, v48
v_cvt_pk_bf16_f32 v77, v45, v49
v_smfmac_f32_16x16x64_bf16 v[64:67], v[12:15], a[248:255], v0
ds_write2_b32 v4, v76, v77 offset0:8 offset1:12
v_smfmac_f32_16x16x64_bf16 v[60:63], v[16:19], v[80:87], v0
v_smfmac_f32_16x16x64_bf16 v[64:67], v[16:19], v[88:95], v0
s_waitcnt vmcnt(1)
v_smfmac_f32_16x16x64_bf16 v[60:63], v[20:23], v[96:103], v0
s_add_u32 s39, s42, 2048
v_smfmac_f32_16x16x64_bf16 v[64:67], v[20:23], v[104:111], v0
v_smfmac_f32_16x16x64_bf16 v[60:63], v[24:27], v[112:119], v0
v_smfmac_f32_16x16x64_bf16 v[64:67], v[24:27], v[120:127], v0
s_waitcnt lgkmcnt(0)
s_barrier
ds_read_b128 v[44:47], v1 offset:3072
v_smfmac_f32_16x16x64_bf16 v[60:63], v[28:31], v[128:135], v0
ds_read_b128 v[48:51], v1 offset:4096
v_smfmac_f32_16x16x64_bf16 v[64:67], v[28:31], v[136:143], v0
ds_read_b128 v[52:55], v1 offset:5120
v_smfmac_f32_16x16x64_bf16 v[60:63], v[32:35], v[144:151], v0
ds_read_b128 v[56:59], v1 offset:6144
v_smfmac_f32_16x16x64_bf16 v[64:67], v[32:35], v[152:159], v0
ds_read_b128 v[8:11], v1 offset:8192
v_smfmac_f32_16x16x64_bf16 v[60:63], v[36:39], v[160:167], v0
ds_read_b128 v[16:19], v1 offset:9216
v_smfmac_f32_16x16x64_bf16 v[64:67], v[36:39], v[168:175], v0
ds_read_b128 v[20:23], v1 offset:10240
v_smfmac_f32_16x16x64_bf16 v[60:63], v[40:43], v[176:183], v0
s_waitcnt lgkmcnt(3)
ds_read_b128 v[24:27], v1 offset:11264
v_smfmac_f32_16x16x64_bf16 v[64:67], v[40:43], v[184:191], v0
ds_read_b128 v[12:15], v1 offset:12288
v_mfma_f32_16x16x32_bf16 v[76:79], v[44:47], v[44:47], 0
ds_read_b128 v[28:31], v1 offset:13312
v_add_f32 v60, v60, v62
v_lshrrev_b32 v41, 1, v1
v_mfma_f32_16x16x32_bf16 v[76:79], v[48:51], v[48:51], v[76:79]
ds_read_b128 v[32:35], v1 offset:14336
v_add_f32 v61, v61, v63
v_mfma_f32_16x16x32_bf16 v[76:79], v[52:55], v[52:55], v[76:79]
s_waitcnt lgkmcnt(3)
ds_read_b128 v[36:39], v1 offset:15360
v_add_f32 v64, v64, v66
v_add_f32 v65, v65, v67
v_mfma_f32_16x16x32_bf16 v[76:79], v[56:59], v[56:59], v[76:79]
s_waitcnt lgkmcnt(3)
v_cvt_pk_bf16_f32 v42, v60, v61
v_cvt_pk_bf16_f32 v43, v64, v65
v_mfma_f32_16x16x32_bf16 v[8:11], v[8:11], v[44:47], 0
s_andn2_b64 exec, exec, s[44:45]
buffer_store_dwordx4 v[44:47], v5, s[4:7], s42 offen sc1
s_mov_b64 exec, -1
v_mfma_f32_16x16x32_bf16 v[8:11], v[16:19], v[48:51], v[8:11]
v_mfma_f32_16x16x32_bf16 v[8:11], v[20:23], v[52:55], v[8:11]
buffer_store_dwordx2 v[42:43], v41, s[4:7], s39 offen offset:0 sc1
v_mfma_f32_16x16x32_bf16 v[8:11], v[24:27], v[56:59], v[8:11]
v_mfma_f32_16x16x32_bf16 v[12:15], v[12:15], v[44:47], 0
s_waitcnt lgkmcnt(0)
v_mov_b32 v16, 0x3f803f80
v_mov_b32 v17, v16
v_mfma_f32_16x16x32_bf16 v[12:15], v[28:31], v[48:51], v[12:15]
v_mov_b64 v[18:19], v[16:17]
v_max3_f32 v40, v76, v77, v8
v_mfma_f32_16x16x32_bf16 v[12:15], v[32:35], v[52:55], v[12:15]
v_max3_f32 v40, v40, v9, v10
v_max_f32 v40, v40, v11
v_mfma_f32_16x16x32_bf16 v[12:15], v[36:39], v[56:59], v[12:15]
ds_read_b128 v[44:47], v6 offset:16384
ds_read_b128 v[48:51], v6 offset:17408
v_mov_b32 v21, 0
v_mov_b32 v22, 0
s_cmp_eq_u32 s37, 63
s_cbranch_scc1 CHn0_end
s_nop 1
v_max3_f32 v40, v40, v12, v13
v_max3_f32 v41, v40, v14, v15
v_max3_f32 v40, v40, v14, v15
ds_read_b128 v[52:55], v6 offset:20480
ds_read_b128 v[56:59], v6 offset:21504
v_permlane16_swap_b32 v40, v41
v_max_f32 v40, v40, v41
v_max_f32 v41, v40, v41
ds_read_b128 v[32:35], v6 offset:18432
ds_read_b128 v[36:39], v6 offset:19456
v_permlane32_swap_b32 v40, v41
v_max_f32 v40, v40, v41
v_mul_f32 v40, s30, v40
v_pk_fma_f32 v[76:77], v[76:77], s[30:31], v[40:41] op_sel_hi:[1,0,0] neg_lo:[0,0,1] neg_hi:[0,0,1]
v_pk_fma_f32 v[8:9], v[8:9], s[30:31], v[40:41] op_sel_hi:[1,0,0] neg_lo:[0,0,1] neg_hi:[0,0,1]
v_pk_fma_f32 v[10:11], v[10:11], s[30:31], v[40:41] op_sel_hi:[1,0,0] neg_lo:[0,0,1] neg_hi:[0,0,1]
v_pk_fma_f32 v[12:13], v[12:13], s[30:31], v[40:41] op_sel_hi:[1,0,0] neg_lo:[0,0,1] neg_hi:[0,0,1]
v_pk_fma_f32 v[14:15], v[14:15], s[30:31], v[40:41] op_sel_hi:[1,0,0] neg_lo:[0,0,1] neg_hi:[0,0,1]
v_exp_f32 v76, v76
v_exp_f32 v77, v77
v_exp_f32 v8, v8
v_cvt_pk_bf16_f32 v20, v76, v77
v_cvt_pk_bf16_f32 v23, v76, v77
v_exp_f32 v9, v9
v_exp_f32 v10, v10
v_mfma_f32_16x16x16_bf16 v[28:31], v[16:17], v[20:21], 0
v_exp_f32 v11, v11
v_mfma_f32_16x16x16_bf16 v[60:63], v[42:43], v[20:21], 0
v_exp_f32 v12, v12
v_mfma_f32_16x16x16_bf16 v[64:67], v[42:43], v[22:23], 0
v_exp_f32 v13, v13
v_exp_f32 v14, v14
v_exp_f32 v15, v15
v_cvt_pk_bf16_f32 v24, v8, v9
v_cvt_pk_bf16_f32 v25, v10, v11
v_cvt_pk_bf16_f32 v26, v12, v13
v_cvt_pk_bf16_f32 v27, v14, v15
v_mov_b64 v[8:9], 0
v_mov_b64 v[10:11], 0
v_mfma_f32_16x16x32_bf16 v[28:31], v[16:19], v[24:27], v[28:31]
v_mov_b64 v[12:13], 0
v_mov_b64 v[14:15], 0
v_mfma_f32_16x16x32_bf16 v[60:63], v[68:71], v[24:27], v[60:63]
v_mov_b64 v[20:21], 0
v_mov_b64 v[22:23], 0
v_mfma_f32_16x16x32_bf16 v[64:67], v[72:75], v[24:27], v[64:67]
v_rcp_f32 v40, v28
v_mov_b64 v[16:17], 0
v_mov_b64 v[18:19], 0
s_mov_b64 exec, s[44:45]
v_mul_f32 v60, v60, v40
v_mul_f32 v61, v61, v40
v_mul_f32 v62, v62, v40
v_mul_f32 v63, v63, v40
v_cvt_pk_bf16_f32 v76, v60, v61
v_cvt_pk_bf16_f32 v77, v62, v63
ds_write_b64 v5, v[76:77] offset:0
v_pk_mul_f32 v[64:65], v[64:65], v[40:41] op_sel_hi:[1,0]
v_pk_mul_f32 v[66:67], v[66:67], v[40:41] op_sel_hi:[1,0]
v_cvt_pk_bf16_f32 v78, v64, v65
v_cvt_pk_bf16_f32 v79, v66, v67
ds_write_b64 v5, v[78:79] offset:8
s_mov_b64 exec, s[46:47]
v_mov_b32 v41, -1
buffer_store_dword v41, v3, s[4:7], s58 offen
s_mov_b64 exec, -1
ds_read_b128 v[60:63], v6 offset:22528
ds_read_b128 v[64:67], v6 offset:23552
v_mov_b64 v[24:25], 0
v_mov_b64 v[26:27], 0
v_mov_b64 v[28:29], 0
v_mov_b64 v[30:31], 0
v_mov_b32 v43, s31
s_waitcnt lgkmcnt(2)
s_barrier
ds_read_b128 v[68:71], v1 offset:0
ds_read_b128 v[72:75], v1 offset:1024
v_mov_b32 v79, s31
s_waitcnt lgkmcnt(1)
v_smfmac_f32_16x16x64_bf16 v[8:11], v[68:71], v[44:51], v0
s_waitcnt lgkmcnt(0)
ds_read_b128 v[44:47], v6 offset:24576
v_smfmac_f32_16x16x64_bf16 v[8:11], v[72:75], v[52:59], v0
ds_read_b128 v[48:51], v6 offset:25600
v_smfmac_f32_16x16x64_bf16 v[12:15], v[68:71], v[32:39], v0
ds_read_b128 v[52:55], v6 offset:28672
v_smfmac_f32_16x16x64_bf16 v[12:15], v[72:75], v[60:67], v0
ds_read_b128 v[56:59], v6 offset:29696
v_add_f32 v8, v8, v10
v_add_f32 v9, v9, v11
v_smfmac_f32_16x16x64_bf16 v[16:19], v[68:71], v[192:199], v0
ds_read_b128 v[32:35], v6 offset:26624
v_cvt_pk_bf16_f32 v40, v8, v9
v_smfmac_f32_16x16x64_bf16 v[16:19], v[72:75], v[200:207], v0
ds_read_b128 v[36:39], v6 offset:27648
v_add_f32 v12, v12, v14
v_add_f32 v13, v13, v15
v_smfmac_f32_16x16x64_bf16 v[20:23], v[68:71], v[208:215], v0
ds_read_b128 v[60:63], v6 offset:30720
v_cvt_pk_bf16_f32 v41, v12, v13
v_mov_b64 v[8:9], 0
v_smfmac_f32_16x16x64_bf16 v[20:23], v[72:75], v[216:223], v0
s_waitcnt lgkmcnt(5)
ds_read_b128 v[64:67], v6 offset:31744
v_add_f32 v16, v16, v18
v_add_f32 v17, v17, v19
v_cvt_pk_bf16_f32 v42, v16, v17
v_smfmac_f32_16x16x64_bf16 v[24:27], v[68:71], v[44:51], v0
s_waitcnt lgkmcnt(4)
ds_read_b128 v[44:47], v6 offset:32768
buffer_store_dwordx4 v[40:43], v2, s[4:7], s60 offen
v_mov_b64 v[16:17], 0
v_mov_b64 v[10:11], 0
v_smfmac_f32_16x16x64_bf16 v[24:27], v[72:75], v[52:59], v0
s_waitcnt lgkmcnt(3)
ds_read_b128 v[48:51], v6 offset:33792
v_add_f32 v20, v20, v22
v_add_f32 v21, v21, v23
v_smfmac_f32_16x16x64_bf16 v[28:31], v[68:71], v[32:39], v0
s_waitcnt lgkmcnt(2)
ds_read_b128 v[52:55], v6 offset:34816
v_cvt_pk_bf16_f32 v76, v20, v21
v_mov_b64 v[18:19], 0
v_smfmac_f32_16x16x64_bf16 v[28:31], v[72:75], v[60:67], v0
ds_read_b128 v[56:59], v6 offset:35840
v_add_f32 v24, v24, v26
v_add_f32 v25, v25, v27
v_smfmac_f32_16x16x64_bf16 v[16:19], v[68:71], v[240:247], v0
v_cvt_pk_bf16_f32 v77, v24, v25
v_mov_b64 v[12:13], 0
v_smfmac_f32_16x16x64_bf16 v[16:19], v[72:75], v[248:255], v0
v_add_f32 v28, v28, v30
v_add_f32 v29, v29, v31
v_cvt_pk_bf16_f32 v78, v28, v29
v_smfmac_f32_16x16x64_bf16 v[8:11], v[68:71], v[224:231], v0
s_waitcnt lgkmcnt(2)
buffer_store_dwordx4 v[76:79], v2, s[4:7], s61 offen
v_mov_b64 v[14:15], 0
v_smfmac_f32_16x16x64_bf16 v[8:11], v[72:75], v[44:51], v0
v_add_f32 v16, v16, v18
v_add_f32 v17, v17, v19
v_smfmac_f32_16x16x64_bf16 v[12:15], v[68:71], v[232:239], v0
s_waitcnt lgkmcnt(0)
s_add_u32 s43, s43, 4
s_add_u32 s37, s37, 1
v_cvt_pk_bf16_f32 v42, v16, v17
v_smfmac_f32_16x16x64_bf16 v[12:15], v[72:75], v[52:59], v0
s_add_u32 s38, s38, 16384
s_add_u32 s42, s42, 4096
v_add_f32 v8, v8, v10
v_add_f32 v9, v9, v11
v_cvt_pk_bf16_f32 v40, v8, v9
s_nop 2
v_pk_add_f32 v[12:13], v[12:13], v[14:15]
v_cvt_pk_bf16_f32 v41, v12, v13
buffer_store_dwordx4 v[40:43], v2, s[4:7], s62 offen
v_and_b32 v33, 16, v1
v_bfe_u32 v32, v1, 5, 3
v_lshlrev_b32 v33, v33, s55
v_mov_b32 v63, 0
v_cmp_eq_u32 vcc, 0, v32
s_nop 1
v_cndmask_b32 v60, 0, v33, vcc
v_cmp_eq_u32 vcc, 1, v32
s_nop 1
v_cndmask_b32 v61, 0, v33, vcc
v_cmp_eq_u32 vcc, 2, v32
s_nop 1
v_cndmask_b32 v62, 0, v33, vcc
s_waitcnt vmcnt(2)
buffer_load_dwordx4 v[44:47], v1, s[4:7], s59 offen offset:0 sc1
buffer_load_dwordx4 v[48:51], v1, s[4:7], s59 offen offset:1024 sc1
buffer_load_dwordx4 v[52:55], v1, s[4:7], s59 offen offset:2048 sc1
buffer_load_dwordx4 v[56:59], v1, s[4:7], s59 offen offset:3072 sc1
s_waitcnt lgkmcnt(0)
s_mov_b32 s29, 0
Lpc33:
s_waitcnt vmcnt(3)
v_mfma_f32_16x16x32_bf16 v[64:67], v[44:47], v[60:63], 0
v_cmp_ne_u32 s[48:49], s31, v47
s_waitcnt vmcnt(2)
v_mfma_f32_16x16x32_bf16 v[64:67], v[48:51], v[60:63], v[64:67]
v_cmp_ne_u32 s[50:51], s31, v51
s_waitcnt vmcnt(1)
v_mfma_f32_16x16x32_bf16 v[64:67], v[52:55], v[60:63], v[64:67]
v_cmp_ne_u32 s[94:95], s31, v55
s_or_b64 s[68:69], s[48:49], s[50:51]
s_waitcnt vmcnt(0)
v_mfma_f32_16x16x32_bf16 v[64:67], v[56:59], v[60:63], v[64:67]
v_cmp_ne_u32 vcc, s31, v59
s_or_b64 s[68:69], s[68:69], s[94:95]
s_or_b64 s[68:69], s[68:69], vcc
s_cbranch_scc0 Lpd34
s_mov_b64 exec, s[48:49]
buffer_load_dwordx4 v[44:47], v1, s[4:7], s59 offen offset:0 sc1
s_mov_b64 exec, s[50:51]
buffer_load_dwordx4 v[48:51], v1, s[4:7], s59 offen offset:1024 sc1
s_mov_b64 exec, s[94:95]
buffer_load_dwordx4 v[52:55], v1, s[4:7], s59 offen offset:2048 sc1
s_mov_b64 exec, vcc
buffer_load_dwordx4 v[56:59], v1, s[4:7], s59 offen offset:3072 sc1
s_mov_b64 exec, -1
s_add_u32 s29, s29, 1
s_add_u32 s91, s91, 1
s_cmp_lt_u32 s29, s25
s_cbranch_scc1 Lpc33
s_mov_b32 s25, 0
s_waitcnt vmcnt(0)
Lpd34:
v_mov_b64 v[44:45], 0
v_mov_b64 v[46:47], 0
v_mov_b64 v[48:49], 0
v_mov_b64 v[50:51], 0
v_permlane32_swap_b32 v64, v66
v_permlane32_swap_b32 v65, v67
v_pk_add_f32 v[64:65], v[64:65], v[66:67]
v_cvt_pk_bf16_f32 v76, v64, v65
s_mov_b64 exec, s[46:47]
buffer_store_dword v76, v3, s[4:7], s57 offen
s_mov_b64 exec, -1
v_mov_b64 v[52:53], 0
v_mov_b64 v[54:55], 0
v_mov_b64 v[56:57], 0
v_mov_b64 v[58:59], 0
ds_read_b128 v[60:63], v6 offset:0
ds_read_b128 v[64:67], v6 offset:1024
ds_read_b128 v[68:71], v6 offset:2048
ds_read_b128 v[72:75], v6 offset:3072
s_mov_b32 s26, s56
s_mov_b32 s56, s57
s_mov_b32 s57, s58
s_mov_b32 s58, s26
s_add_u32 s31, s31, 1
s_add_u32 s40, s56, 0
s_add_u32 s41, s38, 0
s_mov_b32 m0, 8192
s_nop 0
buffer_load_dwordx4 v1, s[4:7], s41 offen offset:0 sc1 lds
buffer_load_dwordx4 v1, s[4:7], s41 offen offset:1024 sc1 lds
buffer_load_dwordx4 v1, s[4:7], s41 offen offset:2048 sc1 lds
s_waitcnt vmcnt(3)
s_barrier
buffer_load_dwordx4 v[8:11], v1, s[4:7], s40 offen offset:0 sc1
buffer_load_dwordx4 v[12:15], v1, s[4:7], s40 offen offset:1024 sc1
buffer_load_dwordx4 v[16:19], v1, s[4:7], s40 offen offset:2048 sc1
s_branch CHn0_step
CHn0_end:
s_mov_b64 exec, s[46:47]
v_mov_b32 v40, -1
buffer_store_dword v40, v3, s[4:7], s58 offen
s_mov_b64 exec, -1
s_waitcnt lgkmcnt(0) vmcnt(0)
s_barrier
s_waitcnt vmcnt(0)
s_barrier
s_mov_b32 s26, s56
s_mov_b32 s56, s57
s_mov_b32 s57, s58
s_mov_b32 s58, s26
s_add_u32 s36, s36, 1
s_cmp_lt_u32 s36, 2
s_cbranch_scc1 CHn0_layer
s_branch END
s_nop 7
CHn1_layer:
s_mov_b32 s37, 0
s_lshl_b32 s43, s52, 1
s_add_u32 s43, s43, s36
s_lshl_b32 s43, s43, 8
s_lshl_b32 s42, s36, 5
s_add_u32 s42, s42, s52
s_lshl_b32 s38, s42, 20
s_add_u32 s38, s38, 58722304
s_lshl_b32 s42, s42, 18
s_add_u32 s42, s42, 25165824
v_bfe_u32 v76, v1, 6, 2
v_bfe_u32 v77, v1, 4, 1
v_lshl_add_u32 v76, v76, 1, v77
v_mul_u32_u24 v76, 1152, v76
v_bfe_u32 v77, v1, 5, 1
v_lshl_add_u32 v76, v77, 4, v76
v_lshrrev_b32 v77, 8, v1
v_lshl_add_u32 v76, v77, 5, v76
buffer_load_dwordx4 v[16:19], v76, s[32:35], 0 offen offset:256
buffer_load_dwordx4 v[20:23], v76, s[32:35], 0 offen offset:384
buffer_load_dwordx4 v[24:27], v76, s[32:35], 0 offen offset:512
s_barrier
s_add_u32 s41, s38, 1024
s_mov_b32 m0, 11264
s_nop 0
buffer_load_dwordx4 v1, s[4:7], s41 offen offset:0 sc1 lds
buffer_load_dwordx4 v1, s[4:7], s41 offen offset:1024 sc1 lds
buffer_load_dwordx4 v1, s[4:7], s41 offen offset:2048 sc1 lds
s_add_u32 s40, s56, 3072
v_mov_b64 v[44:45], 0
v_mov_b64 v[46:47], 0
v_mov_b64 v[48:49], 0
v_mov_b64 v[50:51], 0
v_mov_b64 v[52:53], 0
v_mov_b64 v[54:55], 0
v_mov_b64 v[56:57], 0
v_mov_b64 v[58:59], 0
ds_read_b128 v[60:63], v6 offset:4096
ds_read_b128 v[64:67], v6 offset:5120
ds_read_b128 v[68:71], v6 offset:6144
ds_read_b128 v[72:75], v6 offset:7168
CHn1_step:
s_mov_b32 s29, 0
s_waitcnt vmcnt(0)
Lgc35:
v_max3_u32 v76, v20, v21, v22
v_max3_u32 v77, v24, v25, v26
v_max_u32 v76, v76, v23
v_max_u32 v77, v77, v27
v_cmp_eq_u32 s[94:95], -1, v76
v_cmp_eq_u32 vcc, -1, v77
s_or_b64 s[68:69], s[94:95], vcc
s_cbranch_scc0 Lgd36
s_mov_b64 exec, s[94:95]
buffer_load_dwordx4 v[20:23], v1, s[4:7], s40 offen offset:0 sc1
s_mov_b64 exec, vcc
buffer_load_dwordx4 v[24:27], v1, s[4:7], s40 offen offset:1024 sc1
s_mov_b64 exec, -1
s_add_u32 s29, s29, 1
s_add_u32 s90, s90, 1
s_cmp_lt_u32 s29, s25
s_waitcnt vmcnt(0)
s_cbranch_scc1 Lgc35
s_mov_b32 s25, 0
Lgd36:
ds_write_b128 v1, v[20:23] offset:2048
ds_write_b128 v1, v[24:27] offset:3072
s_cmp_lt_u32 s37, 63
s_cselect_b32 s40, 16384, 0
s_add_u32 s40, s40, s38
s_add_u32 s40, s40, 6144
v_lshlrev_b32 v7, 3, v1
s_add_u32 s41, s38, 8192
s_add_u32 s39, s56, 2048
s_cmp_eq_u32 s37, 0
s_waitcnt lgkmcnt(4)
v_smfmac_f32_16x16x64_bf16 v[44:47], v[20:23], v[60:67], v0
s_waitcnt lgkmcnt(2)
ds_read_b128 v[60:63], v6 offset:8192
v_smfmac_f32_16x16x64_bf16 v[48:51], v[20:23], v[68:75], v0
ds_read_b128 v[64:67], v6 offset:9216
v_smfmac_f32_16x16x64_bf16 v[52:55], v[20:23], a[128:135], v0
s_waitcnt lgkmcnt(2)
s_barrier
ds_read_b128 v[28:31], v1 offset:4096
v_smfmac_f32_16x16x64_bf16 v[56:59], v[20:23], a[136:143], v0
s_cbranch_scc1 CHn1_n8
buffer_load_dwordx4 v[16:19], v1, s[4:7], s39 offen sc1
CHn1_n8:
ds_read_b128 v[32:35], v1 offset:5120
v_smfmac_f32_16x16x64_bf16 v[52:55], v[24:27], a[144:151], v0
ds_read_b128 v[36:39], v1 offset:6144
buffer_load_dwordx4 v[68:71], v1, s[4:7], s41 offen offset:0 sc1
v_smfmac_f32_16x16x64_bf16 v[56:59], v[24:27], a[152:159], v0
ds_read_b128 v[40:43], v1 offset:7168
buffer_load_dwordx4 v[72:75], v1, s[4:7], s41 offen offset:1024 sc1
v_smfmac_f32_16x16x64_bf16 v[44:47], v[24:27], a[32:39], v0
ds_read_b128 v[8:11], v1 offset:0
v_smfmac_f32_16x16x64_bf16 v[48:51], v[24:27], a[40:47], v0
s_waitcnt lgkmcnt(4)
ds_read_b128 v[12:15], v1 offset:1024
v_smfmac_f32_16x16x64_bf16 v[44:47], v[28:31], v[60:67], v0
ds_read_b128 v[60:63], v6 offset:10240
ds_read_b128 v[64:67], v6 offset:11264
v_smfmac_f32_16x16x64_bf16 v[52:55], v[28:31], a[160:167], v0
v_smfmac_f32_16x16x64_bf16 v[56:59], v[28:31], a[168:175], v0
s_waitcnt lgkmcnt(6)
buffer_load_dword v7, v7, s[4:7], s40 offen sc1
v_smfmac_f32_16x16x64_bf16 v[52:55], v[32:35], a[176:183], v0
v_smfmac_f32_16x16x64_bf16 v[56:59], v[32:35], a[184:191], v0
s_waitcnt lgkmcnt(0)
v_smfmac_f32_16x16x64_bf16 v[48:51], v[28:31], v[60:67], v0
ds_read_b128 v[60:63], v6 offset:12288
ds_read_b128 v[64:67], v6 offset:13312
v_smfmac_f32_16x16x64_bf16 v[52:55], v[36:39], a[192:199], v0
s_barrier
v_smfmac_f32_16x16x64_bf16 v[56:59], v[36:39], a[200:207], v0
v_smfmac_f32_16x16x64_bf16 v[52:55], v[40:43], a[208:215], v0
v_smfmac_f32_16x16x64_bf16 v[56:59], v[40:43], a[216:223], v0
s_waitcnt lgkmcnt(0)
v_smfmac_f32_16x16x64_bf16 v[44:47], v[36:39], v[60:67], v0
ds_read_b128 v[60:63], v6 offset:14336
ds_read_b128 v[64:67], v6 offset:15360
v_smfmac_f32_16x16x64_bf16 v[52:55], v[8:11], a[80:87], v0
v_smfmac_f32_16x16x64_bf16 v[56:59], v[8:11], a[88:95], v0
v_smfmac_f32_16x16x64_bf16 v[52:55], v[12:15], a[96:103], v0
v_smfmac_f32_16x16x64_bf16 v[56:59], v[12:15], a[104:111], v0
s_waitcnt lgkmcnt(0)
v_smfmac_f32_16x16x64_bf16 v[48:51], v[36:39], v[60:67], v0
s_waitcnt vmcnt(3)
ds_read_b128 v[60:63], v6 offset:0
ds_read_b128 v[64:67], v6 offset:1024
v_smfmac_f32_16x16x64_bf16 v[52:55], v[16:19], a[112:119], v0
v_smfmac_f32_16x16x64_bf16 v[56:59], v[16:19], a[120:127], v0
v_smfmac_f32_16x16x64_bf16 v[44:47], v[32:35], a[48:55], v0
v_add_f32 v52, v52, v54
v_smfmac_f32_16x16x64_bf16 v[48:51], v[32:35], a[56:63], v0
s_waitcnt lgkmcnt(0)
v_add_f32 v56, v56, v58
v_smfmac_f32_16x16x64_bf16 v[44:47], v[8:11], v[60:67], v0
ds_read_b128 v[60:63], v6 offset:2048
ds_read_b128 v[64:67], v6 offset:3072
v_add_f32 v53, v53, v55
v_smfmac_f32_16x16x64_bf16 v[44:47], v[40:43], a[64:71], v0
v_add_f32 v57, v57, v59
v_smfmac_f32_16x16x64_bf16 v[48:51], v[40:43], a[72:79], v0
v_cvt_pk_bf16_f32 v78, v52, v56
v_smfmac_f32_16x16x64_bf16 v[44:47], v[12:15], a[0:7], v0
s_waitcnt lgkmcnt(0)
v_cvt_pk_bf16_f32 v79, v53, v57
v_smfmac_f32_16x16x64_bf16 v[48:51], v[8:11], v[60:67], v0
v_smfmac_f32_16x16x64_bf16 v[48:51], v[12:15], a[8:15], v0
ds_write2_b32 v4, v78, v79 offset0:0 offset1:4
v_mov_b64 v[60:61], 0
v_smfmac_f32_16x16x64_bf16 v[44:47], v[16:19], a[16:23], v0
v_mov_b64 v[62:63], 0
v_smfmac_f32_16x16x64_bf16 v[48:51], v[16:19], a[24:31], v0
v_mov_b64 v[64:65], 0
v_mov_b64 v[66:67], 0
v_smfmac_f32_16x16x64_bf16 v[60:63], v[8:11], a[224:231], v0
v_add_f32 v44, v44, v46
v_add_f32 v45, v45, v47
v_smfmac_f32_16x16x64_bf16 v[64:67], v[8:11], a[232:239], v0
v_add_f32 v48, v48, v50
v_add_f32 v49, v49, v51
v_smfmac_f32_16x16x64_bf16 v[60:63], v[12:15], a[240:247], v0
v_cvt_pk_bf16_f32 v76, v44, v48
v_cvt_pk_bf16_f32 v77, v45, v49
v_smfmac_f32_16x16x64_bf16 v[64:67], v[12:15], a[248:255], v0
ds_write2_b32 v4, v76, v77 offset0:8 offset1:12
v_smfmac_f32_16x16x64_bf16 v[60:63], v[16:19], v[80:87], v0
v_smfmac_f32_16x16x64_bf16 v[64:67], v[16:19], v[88:95], v0
s_waitcnt vmcnt(1)
v_smfmac_f32_16x16x64_bf16 v[60:63], v[20:23], v[96:103], v0
s_add_u32 s39, s42, 2048
v_smfmac_f32_16x16x64_bf16 v[64:67], v[20:23], v[104:111], v0
v_smfmac_f32_16x16x64_bf16 v[60:63], v[24:27], v[112:119], v0
v_smfmac_f32_16x16x64_bf16 v[64:67], v[24:27], v[120:127], v0
s_waitcnt lgkmcnt(0)
s_barrier
ds_read_b128 v[44:47], v1 offset:3072
v_smfmac_f32_16x16x64_bf16 v[60:63], v[28:31], v[128:135], v0
ds_read_b128 v[48:51], v1 offset:4096
v_smfmac_f32_16x16x64_bf16 v[64:67], v[28:31], v[136:143], v0
ds_read_b128 v[52:55], v1 offset:5120
v_smfmac_f32_16x16x64_bf16 v[60:63], v[32:35], v[144:151], v0
ds_read_b128 v[56:59], v1 offset:6144
v_smfmac_f32_16x16x64_bf16 v[64:67], v[32:35], v[152:159], v0
ds_read_b128 v[8:11], v1 offset:8192
v_smfmac_f32_16x16x64_bf16 v[60:63], v[36:39], v[160:167], v0
ds_read_b128 v[16:19], v1 offset:9216
v_smfmac_f32_16x16x64_bf16 v[64:67], v[36:39], v[168:175], v0
ds_read_b128 v[20:23], v1 offset:10240
v_smfmac_f32_16x16x64_bf16 v[60:63], v[40:43], v[176:183], v0
s_waitcnt lgkmcnt(3)
ds_read_b128 v[24:27], v1 offset:11264
v_smfmac_f32_16x16x64_bf16 v[64:67], v[40:43], v[184:191], v0
ds_read_b128 v[12:15], v1 offset:12288
v_mfma_f32_16x16x32_bf16 v[76:79], v[44:47], v[44:47], 0
ds_read_b128 v[28:31], v1 offset:13312
v_add_f32 v60, v60, v62
v_lshrrev_b32 v41, 1, v1
v_mfma_f32_16x16x32_bf16 v[76:79], v[48:51], v[48:51], v[76:79]
ds_read_b128 v[32:35], v1 offset:14336
v_add_f32 v61, v61, v63
v_mfma_f32_16x16x32_bf16 v[76:79], v[52:55], v[52:55], v[76:79]
s_waitcnt lgkmcnt(3)
ds_read_b128 v[36:39], v1 offset:15360
v_add_f32 v64, v64, v66
v_add_f32 v65, v65, v67
v_mfma_f32_16x16x32_bf16 v[76:79], v[56:59], v[56:59], v[76:79]
s_waitcnt lgkmcnt(3)
v_cvt_pk_bf16_f32 v42, v60, v61
v_cvt_pk_bf16_f32 v43, v64, v65
v_mfma_f32_16x16x32_bf16 v[8:11], v[8:11], v[44:47], 0
v_mfma_f32_16x16x32_bf16 v[8:11], v[16:19], v[48:51], v[8:11]
s_andn2_b64 exec, exec, s[44:45]
buffer_store_dwordx4 v[48:51], v5, s[4:7], s42 offen sc1
s_mov_b64 exec, -1
v_mfma_f32_16x16x32_bf16 v[8:11], v[20:23], v[52:55], v[8:11]
v_mfma_f32_16x16x32_bf16 v[8:11], v[24:27], v[56:59], v[8:11]
buffer_store_dwordx2 v[42:43], v41, s[4:7], s39 offen offset:512 sc1
v_mfma_f32_16x16x32_bf16 v[12:15], v[12:15], v[44:47], 0
s_waitcnt lgkmcnt(0)
v_mov_b32 v16, 0x3f803f80
v_mov_b32 v17, v16
v_mfma_f32_16x16x32_bf16 v[12:15], v[28:31], v[48:51], v[12:15]
v_mov_b64 v[18:19], v[16:17]
v_max3_f32 v40, v76, v77, v8
v_mfma_f32_16x16x32_bf16 v[12:15], v[32:35], v[52:55], v[12:15]
v_max3_f32 v40, v40, v9, v10
v_max_f32 v40, v40, v11
v_mfma_f32_16x16x32_bf16 v[12:15], v[36:39], v[56:59], v[12:15]
ds_read_b128 v[44:47], v6 offset:16384
ds_read_b128 v[48:51], v6 offset:17408
v_mov_b32 v21, 0
v_mov_b32 v22, 0
s_cmp_eq_u32 s37, 63
s_cbranch_scc1 CHn1_end
s_nop 1
v_max3_f32 v40, v40, v12, v13
v_max3_f32 v41, v40, v14, v15
v_max3_f32 v40, v40, v14, v15
ds_read_b128 v[52:55], v6 offset:20480
ds_read_b128 v[56:59], v6 offset:21504
v_permlane16_swap_b32 v40, v41
v_max_f32 v40, v40, v41
v_max_f32 v41, v40, v41
ds_read_b128 v[32:35], v6 offset:18432
ds_read_b128 v[36:39], v6 offset:19456
v_permlane32_swap_b32 v40, v41
v_max_f32 v40, v40, v41
v_mul_f32 v40, s30, v40
v_pk_fma_f32 v[76:77], v[76:77], s[30:31], v[40:41] op_sel_hi:[1,0,0] neg_lo:[0,0,1] neg_hi:[0,0,1]
v_pk_fma_f32 v[8:9], v[8:9], s[30:31], v[40:41] op_sel_hi:[1,0,0] neg_lo:[0,0,1] neg_hi:[0,0,1]
v_pk_fma_f32 v[10:11], v[10:11], s[30:31], v[40:41] op_sel_hi:[1,0,0] neg_lo:[0,0,1] neg_hi:[0,0,1]
v_pk_fma_f32 v[12:13], v[12:13], s[30:31], v[40:41] op_sel_hi:[1,0,0] neg_lo:[0,0,1] neg_hi:[0,0,1]
v_pk_fma_f32 v[14:15], v[14:15], s[30:31], v[40:41] op_sel_hi:[1,0,0] neg_lo:[0,0,1] neg_hi:[0,0,1]
v_exp_f32 v76, v76
v_exp_f32 v77, v77
v_exp_f32 v8, v8
v_cvt_pk_bf16_f32 v20, v76, v77
v_cvt_pk_bf16_f32 v23, v76, v77
v_exp_f32 v9, v9
v_exp_f32 v10, v10
v_mfma_f32_16x16x16_bf16 v[28:31], v[16:17], v[20:21], 0
v_exp_f32 v11, v11
v_mfma_f32_16x16x16_bf16 v[60:63], v[42:43], v[20:21], 0
v_exp_f32 v12, v12
v_mfma_f32_16x16x16_bf16 v[64:67], v[42:43], v[22:23], 0
v_exp_f32 v13, v13
v_exp_f32 v14, v14
v_exp_f32 v15, v15
v_cvt_pk_bf16_f32 v24, v8, v9
v_cvt_pk_bf16_f32 v25, v10, v11
v_cvt_pk_bf16_f32 v26, v12, v13
v_cvt_pk_bf16_f32 v27, v14, v15
v_mov_b64 v[8:9], 0
v_mov_b64 v[10:11], 0
v_mfma_f32_16x16x32_bf16 v[28:31], v[16:19], v[24:27], v[28:31]
v_mov_b64 v[12:13], 0
v_mov_b64 v[14:15], 0
v_mfma_f32_16x16x32_bf16 v[60:63], v[68:71], v[24:27], v[60:63]
v_mov_b64 v[20:21], 0
v_mov_b64 v[22:23], 0
v_mfma_f32_16x16x32_bf16 v[64:67], v[72:75], v[24:27], v[64:67]
v_rcp_f32 v40, v28
v_mov_b64 v[16:17], 0
v_mov_b64 v[18:19], 0
s_mov_b64 exec, s[44:45]
v_mul_f32 v60, v60, v40
v_mul_f32 v61, v61, v40
v_mul_f32 v62, v62, v40
v_mul_f32 v63, v63, v40
v_cvt_pk_bf16_f32 v76, v60, v61
v_cvt_pk_bf16_f32 v77, v62, v63
ds_write_b64 v5, v[76:77] offset:0
v_pk_mul_f32 v[64:65], v[64:65], v[40:41] op_sel_hi:[1,0]
v_pk_mul_f32 v[66:67], v[66:67], v[40:41] op_sel_hi:[1,0]
v_cvt_pk_bf16_f32 v78, v64, v65
v_cvt_pk_bf16_f32 v79, v66, v67
ds_write_b64 v5, v[78:79] offset:8
s_mov_b64 exec, s[46:47]
v_mov_b32 v41, -1
buffer_store_dword v41, v3, s[4:7], s58 offen
s_mov_b64 exec, -1
ds_read_b128 v[60:63], v6 offset:22528
ds_read_b128 v[64:67], v6 offset:23552
v_mov_b64 v[24:25], 0
v_mov_b64 v[26:27], 0
v_mov_b64 v[28:29], 0
v_mov_b64 v[30:31], 0
v_mov_b32 v43, s31
s_waitcnt lgkmcnt(2)
s_barrier
ds_read_b128 v[68:71], v1 offset:0
ds_read_b128 v[72:75], v1 offset:1024
v_mov_b32 v79, s31
s_waitcnt lgkmcnt(1)
v_smfmac_f32_16x16x64_bf16 v[8:11], v[68:71], v[44:51], v0
s_waitcnt lgkmcnt(0)
ds_read_b128 v[44:47], v6 offset:24576
v_smfmac_f32_16x16x64_bf16 v[8:11], v[72:75], v[52:59], v0
ds_read_b128 v[48:51], v6 offset:25600
v_smfmac_f32_16x16x64_bf16 v[12:15], v[68:71], v[32:39], v0
ds_read_b128 v[52:55], v6 offset:28672
v_smfmac_f32_16x16x64_bf16 v[12:15], v[72:75], v[60:67], v0
ds_read_b128 v[56:59], v6 offset:29696
v_add_f32 v8, v8, v10
v_add_f32 v9, v9, v11
v_smfmac_f32_16x16x64_bf16 v[16:19], v[68:71], v[192:199], v0
ds_read_b128 v[32:35], v6 offset:26624
v_cvt_pk_bf16_f32 v40, v8, v9
v_smfmac_f32_16x16x64_bf16 v[16:19], v[72:75], v[200:207], v0
ds_read_b128 v[36:39], v6 offset:27648
v_add_f32 v12, v12, v14
v_add_f32 v13, v13, v15
v_smfmac_f32_16x16x64_bf16 v[20:23], v[68:71], v[208:215], v0
ds_read_b128 v[60:63], v6 offset:30720
v_cvt_pk_bf16_f32 v41, v12, v13
v_mov_b64 v[8:9], 0
v_smfmac_f32_16x16x64_bf16 v[20:23], v[72:75], v[216:223], v0
s_waitcnt lgkmcnt(5)
ds_read_b128 v[64:67], v6 offset:31744
v_add_f32 v16, v16, v18
v_add_f32 v17, v17, v19
v_cvt_pk_bf16_f32 v42, v16, v17
v_smfmac_f32_16x16x64_bf16 v[24:27], v[68:71], v[44:51], v0
s_waitcnt lgkmcnt(4)
ds_read_b128 v[44:47], v6 offset:32768
buffer_store_dwordx4 v[40:43], v2, s[4:7], s60 offen
v_mov_b64 v[16:17], 0
v_mov_b64 v[10:11], 0
v_smfmac_f32_16x16x64_bf16 v[24:27], v[72:75], v[52:59], v0
s_waitcnt lgkmcnt(3)
ds_read_b128 v[48:51], v6 offset:33792
v_add_f32 v20, v20, v22
v_add_f32 v21, v21, v23
v_smfmac_f32_16x16x64_bf16 v[28:31], v[68:71], v[32:39], v0
s_waitcnt lgkmcnt(2)
ds_read_b128 v[52:55], v6 offset:34816
v_cvt_pk_bf16_f32 v76, v20, v21
v_mov_b64 v[18:19], 0
v_smfmac_f32_16x16x64_bf16 v[28:31], v[72:75], v[60:67], v0
ds_read_b128 v[56:59], v6 offset:35840
v_add_f32 v24, v24, v26
v_add_f32 v25, v25, v27
v_smfmac_f32_16x16x64_bf16 v[16:19], v[68:71], v[240:247], v0
v_cvt_pk_bf16_f32 v77, v24, v25
v_mov_b64 v[12:13], 0
v_smfmac_f32_16x16x64_bf16 v[16:19], v[72:75], v[248:255], v0
v_add_f32 v28, v28, v30
v_add_f32 v29, v29, v31
v_cvt_pk_bf16_f32 v78, v28, v29
v_smfmac_f32_16x16x64_bf16 v[8:11], v[68:71], v[224:231], v0
s_waitcnt lgkmcnt(2)
buffer_store_dwordx4 v[76:79], v2, s[4:7], s61 offen
v_mov_b64 v[14:15], 0
v_smfmac_f32_16x16x64_bf16 v[8:11], v[72:75], v[44:51], v0
v_add_f32 v16, v16, v18
v_add_f32 v17, v17, v19
v_smfmac_f32_16x16x64_bf16 v[12:15], v[68:71], v[232:239], v0
s_waitcnt lgkmcnt(0)
s_add_u32 s43, s43, 4
s_add_u32 s37, s37, 1
v_cvt_pk_bf16_f32 v42, v16, v17
v_smfmac_f32_16x16x64_bf16 v[12:15], v[72:75], v[52:59], v0
s_add_u32 s38, s38, 16384
s_add_u32 s42, s42, 4096
v_add_f32 v8, v8, v10
v_add_f32 v9, v9, v11
v_cvt_pk_bf16_f32 v40, v8, v9
s_nop 2
v_pk_add_f32 v[12:13], v[12:13], v[14:15]
v_cvt_pk_bf16_f32 v41, v12, v13
buffer_store_dwordx4 v[40:43], v2, s[4:7], s62 offen
v_and_b32 v33, 16, v1
v_bfe_u32 v32, v1, 5, 3
v_lshlrev_b32 v33, v33, s55
v_mov_b32 v63, 0
v_cmp_eq_u32 vcc, 0, v32
s_nop 1
v_cndmask_b32 v60, 0, v33, vcc
v_cmp_eq_u32 vcc, 1, v32
s_nop 1
v_cndmask_b32 v61, 0, v33, vcc
v_cmp_eq_u32 vcc, 2, v32
s_nop 1
v_cndmask_b32 v62, 0, v33, vcc
s_waitcnt vmcnt(0)
buffer_load_dwordx4 v[44:47], v1, s[4:7], s59 offen offset:0 sc1
buffer_load_dwordx4 v[48:51], v1, s[4:7], s59 offen offset:1024 sc1
buffer_load_dwordx4 v[52:55], v1, s[4:7], s59 offen offset:2048 sc1
buffer_load_dwordx4 v[56:59], v1, s[4:7], s59 offen offset:3072 sc1
s_waitcnt lgkmcnt(0)
s_mov_b32 s29, 0
Lpc37:
s_waitcnt vmcnt(3)
v_mfma_f32_16x16x32_bf16 v[64:67], v[44:47], v[60:63], 0
v_cmp_ne_u32 s[48:49], s31, v47
s_waitcnt vmcnt(2)
v_mfma_f32_16x16x32_bf16 v[64:67], v[48:51], v[60:63], v[64:67]
v_cmp_ne_u32 s[50:51], s31, v51
s_waitcnt vmcnt(1)
v_mfma_f32_16x16x32_bf16 v[64:67], v[52:55], v[60:63], v[64:67]
v_cmp_ne_u32 s[94:95], s31, v55
s_or_b64 s[68:69], s[48:49], s[50:51]
s_waitcnt vmcnt(0)
v_mfma_f32_16x16x32_bf16 v[64:67], v[56:59], v[60:63], v[64:67]
v_cmp_ne_u32 vcc, s31, v59
s_or_b64 s[68:69], s[68:69], s[94:95]
s_or_b64 s[68:69], s[68:69], vcc
s_cbranch_scc0 Lpd38
s_mov_b64 exec, s[48:49]
buffer_load_dwordx4 v[44:47], v1, s[4:7], s59 offen offset:0 sc1
s_mov_b64 exec, s[50:51]
buffer_load_dwordx4 v[48:51], v1, s[4:7], s59 offen offset:1024 sc1
s_mov_b64 exec, s[94:95]
buffer_load_dwordx4 v[52:55], v1, s[4:7], s59 offen offset:2048 sc1
s_mov_b64 exec, vcc
buffer_load_dwordx4 v[56:59], v1, s[4:7], s59 offen offset:3072 sc1
s_mov_b64 exec, -1
s_add_u32 s29, s29, 1
s_add_u32 s91, s91, 1
s_cmp_lt_u32 s29, s25
s_cbranch_scc1 Lpc37
s_mov_b32 s25, 0
s_waitcnt vmcnt(0)
Lpd38:
v_mov_b64 v[44:45], 0
v_mov_b64 v[46:47], 0
v_mov_b64 v[48:49], 0
v_mov_b64 v[50:51], 0
v_permlane32_swap_b32 v64, v66
v_permlane32_swap_b32 v65, v67
v_pk_add_f32 v[64:65], v[64:65], v[66:67]
v_cvt_pk_bf16_f32 v76, v64, v65
s_mov_b64 exec, s[46:47]
buffer_store_dword v76, v3, s[4:7], s57 offen
s_mov_b64 exec, -1
v_mov_b64 v[52:53], 0
v_mov_b64 v[54:55], 0
v_mov_b64 v[56:57], 0
v_mov_b64 v[58:59], 0
ds_read_b128 v[60:63], v6 offset:4096
ds_read_b128 v[64:67], v6 offset:5120
ds_read_b128 v[68:71], v6 offset:6144
ds_read_b128 v[72:75], v6 offset:7168
s_mov_b32 s26, s56
s_mov_b32 s56, s57
s_mov_b32 s57, s58
s_mov_b32 s58, s26
s_add_u32 s31, s31, 1
s_add_u32 s40, s56, 3072
s_add_u32 s41, s38, 1024
s_mov_b32 m0, 11264
s_nop 0
buffer_load_dwordx4 v1, s[4:7], s41 offen offset:0 sc1 lds
buffer_load_dwordx4 v1, s[4:7], s41 offen offset:1024 sc1 lds
buffer_load_dwordx4 v1, s[4:7], s41 offen offset:2048 sc1 lds
s_waitcnt vmcnt(3)
s_barrier
buffer_load_dwordx4 v[20:23], v1, s[4:7], s40 offen offset:0 sc1
buffer_load_dwordx4 v[24:27], v1, s[4:7], s40 offen offset:1024 sc1
s_branch CHn1_step
CHn1_end:
s_mov_b64 exec, s[46:47]
v_mov_b32 v40, -1
buffer_store_dword v40, v3, s[4:7], s58 offen
s_mov_b64 exec, -1
s_waitcnt lgkmcnt(0) vmcnt(0)
s_barrier
s_waitcnt vmcnt(0)
s_barrier
s_mov_b32 s26, s56
s_mov_b32 s56, s57
s_mov_b32 s57, s58
s_mov_b32 s58, s26
s_add_u32 s36, s36, 1
s_cmp_lt_u32 s36, 2
s_cbranch_scc1 CHn1_layer
s_branch END
s_nop 7
CHn2_layer:
s_mov_b32 s37, 0
s_lshl_b32 s43, s52, 1
s_add_u32 s43, s43, s36
s_lshl_b32 s43, s43, 8
s_lshl_b32 s42, s36, 5
s_add_u32 s42, s42, s52
s_lshl_b32 s38, s42, 20
s_add_u32 s38, s38, 58724352
s_lshl_b32 s42, s42, 18
s_add_u32 s42, s42, 25165824
v_bfe_u32 v76, v1, 6, 2
v_bfe_u32 v77, v1, 4, 1
v_lshl_add_u32 v76, v76, 1, v77
v_mul_u32_u24 v76, 1152, v76
v_bfe_u32 v77, v1, 5, 1
v_lshl_add_u32 v76, v77, 4, v76
v_lshrrev_b32 v77, 8, v1
v_lshl_add_u32 v76, v77, 5, v76
buffer_load_dwordx4 v[16:19], v76, s[32:35], 0 offen offset:256
buffer_load_dwordx4 v[28:31], v76, s[32:35], 0 offen offset:640
buffer_load_dwordx4 v[32:35], v76, s[32:35], 0 offen offset:768
s_barrier
s_add_u32 s41, s38, 2048
s_mov_b32 m0, 14336
s_nop 0
buffer_load_dwordx4 v1, s[4:7], s41 offen offset:0 sc1 lds
buffer_load_dwordx4 v1, s[4:7], s41 offen offset:1024 sc1 lds
s_add_u32 s40, s56, 5120
v_mov_b64 v[44:45], 0
v_mov_b64 v[46:47], 0
v_mov_b64 v[48:49], 0
v_mov_b64 v[50:51], 0
v_mov_b64 v[52:53], 0
v_mov_b64 v[54:55], 0
v_mov_b64 v[56:57], 0
v_mov_b64 v[58:59], 0
ds_read_b128 v[60:63], v6 offset:8192
ds_read_b128 v[64:67], v6 offset:9216
ds_read_b128 v[68:71], v6 offset:10240
ds_read_b128 v[72:75], v6 offset:11264
CHn2_step:
s_mov_b32 s29, 0
s_waitcnt vmcnt(0)
Lgc39:
v_max3_u32 v76, v28, v29, v30
v_max3_u32 v77, v32, v33, v34
v_max_u32 v76, v76, v31
v_max_u32 v77, v77, v35
v_cmp_eq_u32 s[94:95], -1, v76
v_cmp_eq_u32 vcc, -1, v77
s_or_b64 s[68:69], s[94:95], vcc
s_cbranch_scc0 Lgd40
s_mov_b64 exec, s[94:95]
buffer_load_dwordx4 v[28:31], v1, s[4:7], s40 offen offset:0 sc1
s_mov_b64 exec, vcc
buffer_load_dwordx4 v[32:35], v1, s[4:7], s40 offen offset:1024 sc1
s_mov_b64 exec, -1
s_add_u32 s29, s29, 1
s_add_u32 s90, s90, 1
s_cmp_lt_u32 s29, s25
s_waitcnt vmcnt(0)
s_cbranch_scc1 Lgc39
s_mov_b32 s25, 0
Lgd40:
ds_write_b128 v1, v[28:31] offset:4096
ds_write_b128 v1, v[32:35] offset:5120
s_add_u32 s41, s38, 8192
s_add_u32 s39, s56, 2048
s_cmp_eq_u32 s37, 0
s_waitcnt lgkmcnt(4)
v_smfmac_f32_16x16x64_bf16 v[44:47], v[28:31], v[60:67], v0
s_waitcnt lgkmcnt(2)
ds_read_b128 v[60:63], v6 offset:12288
v_smfmac_f32_16x16x64_bf16 v[48:51], v[28:31], v[68:75], v0
ds_read_b128 v[64:67], v6 offset:13312
v_smfmac_f32_16x16x64_bf16 v[52:55], v[28:31], a[160:167], v0
s_waitcnt lgkmcnt(2)
s_barrier
ds_read_b128 v[36:39], v1 offset:6144
v_smfmac_f32_16x16x64_bf16 v[56:59], v[28:31], a[168:175], v0
s_cbranch_scc1 CHn2_n8
buffer_load_dwordx4 v[16:19], v1, s[4:7], s39 offen sc1
CHn2_n8:
ds_read_b128 v[40:43], v1 offset:7168
v_smfmac_f32_16x16x64_bf16 v[52:55], v[32:35], a[176:183], v0
ds_read_b128 v[8:11], v1 offset:0
buffer_load_dwordx4 v[68:71], v1, s[4:7], s41 offen offset:0 sc1
v_smfmac_f32_16x16x64_bf16 v[56:59], v[32:35], a[184:191], v0
ds_read_b128 v[12:15], v1 offset:1024
buffer_load_dwordx4 v[72:75], v1, s[4:7], s41 offen offset:1024 sc1
v_smfmac_f32_16x16x64_bf16 v[44:47], v[32:35], a[48:55], v0
ds_read_b128 v[20:23], v1 offset:2048
v_smfmac_f32_16x16x64_bf16 v[48:51], v[32:35], a[56:63], v0
s_waitcnt lgkmcnt(4)
ds_read_b128 v[24:27], v1 offset:3072
v_smfmac_f32_16x16x64_bf16 v[44:47], v[36:39], v[60:67], v0
ds_read_b128 v[60:63], v6 offset:14336
ds_read_b128 v[64:67], v6 offset:15360
v_smfmac_f32_16x16x64_bf16 v[52:55], v[36:39], a[192:199], v0
v_smfmac_f32_16x16x64_bf16 v[56:59], v[36:39], a[200:207], v0
s_waitcnt lgkmcnt(6)
v_smfmac_f32_16x16x64_bf16 v[52:55], v[40:43], a[208:215], v0
v_smfmac_f32_16x16x64_bf16 v[56:59], v[40:43], a[216:223], v0
s_waitcnt lgkmcnt(0)
v_smfmac_f32_16x16x64_bf16 v[48:51], v[36:39], v[60:67], v0
ds_read_b128 v[60:63], v6 offset:0
ds_read_b128 v[64:67], v6 offset:1024
v_smfmac_f32_16x16x64_bf16 v[52:55], v[8:11], a[80:87], v0
s_barrier
v_smfmac_f32_16x16x64_bf16 v[56:59], v[8:11], a[88:95], v0
v_smfmac_f32_16x16x64_bf16 v[52:55], v[12:15], a[96:103], v0
v_smfmac_f32_16x16x64_bf16 v[56:59], v[12:15], a[104:111], v0
s_waitcnt lgkmcnt(0)
v_smfmac_f32_16x16x64_bf16 v[44:47], v[8:11], v[60:67], v0
ds_read_b128 v[60:63], v6 offset:2048
ds_read_b128 v[64:67], v6 offset:3072
v_smfmac_f32_16x16x64_bf16 v[52:55], v[20:23], a[128:135], v0
v_smfmac_f32_16x16x64_bf16 v[56:59], v[20:23], a[136:143], v0
v_smfmac_f32_16x16x64_bf16 v[52:55], v[24:27], a[144:151], v0
v_smfmac_f32_16x16x64_bf16 v[56:59], v[24:27], a[152:159], v0
s_waitcnt lgkmcnt(0)
v_smfmac_f32_16x16x64_bf16 v[48:51], v[8:11], v[60:67], v0
s_waitcnt vmcnt(2)
ds_read_b128 v[60:63], v6 offset:4096
ds_read_b128 v[64:67], v6 offset:5120
v_smfmac_f32_16x16x64_bf16 v[52:55], v[16:19], a[112:119], v0
v_smfmac_f32_16x16x64_bf16 v[56:59], v[16:19], a[120:127], v0
v_smfmac_f32_16x16x64_bf16 v[44:47], v[40:43], a[64:71], v0
v_add_f32 v52, v52, v54
v_smfmac_f32_16x16x64_bf16 v[48:51], v[40:43], a[72:79], v0
s_waitcnt lgkmcnt(0)
v_add_f32 v56, v56, v58
v_smfmac_f32_16x16x64_bf16 v[44:47], v[20:23], v[60:67], v0
ds_read_b128 v[60:63], v6 offset:6144
ds_read_b128 v[64:67], v6 offset:7168
v_add_f32 v53, v53, v55
v_smfmac_f32_16x16x64_bf16 v[44:47], v[12:15], a[0:7], v0
v_add_f32 v57, v57, v59
v_smfmac_f32_16x16x64_bf16 v[48:51], v[12:15], a[8:15], v0
v_cvt_pk_bf16_f32 v78, v52, v56
v_smfmac_f32_16x16x64_bf16 v[44:47], v[24:27], a[32:39], v0
s_waitcnt lgkmcnt(0)
v_cvt_pk_bf16_f32 v79, v53, v57
v_smfmac_f32_16x16x64_bf16 v[48:51], v[20:23], v[60:67], v0
v_smfmac_f32_16x16x64_bf16 v[48:51], v[24:27], a[40:47], v0
ds_write2_b32 v4, v78, v79 offset0:0 offset1:4
v_mov_b64 v[60:61], 0
v_smfmac_f32_16x16x64_bf16 v[44:47], v[16:19], a[16:23], v0
v_mov_b64 v[62:63], 0
v_smfmac_f32_16x16x64_bf16 v[48:51], v[16:19], a[24:31], v0
v_mov_b64 v[64:65], 0
v_mov_b64 v[66:67], 0
v_smfmac_f32_16x16x64_bf16 v[60:63], v[8:11], a[224:231], v0
v_add_f32 v44, v44, v46
v_add_f32 v45, v45, v47
v_smfmac_f32_16x16x64_bf16 v[64:67], v[8:11], a[232:239], v0
v_add_f32 v48, v48, v50
v_add_f32 v49, v49, v51
v_smfmac_f32_16x16x64_bf16 v[60:63], v[12:15], a[240:247], v0
v_cvt_pk_bf16_f32 v76, v44, v48
v_cvt_pk_bf16_f32 v77, v45, v49
v_smfmac_f32_16x16x64_bf16 v[64:67], v[12:15], a[248:255], v0
ds_write2_b32 v4, v76, v77 offset0:8 offset1:12
v_smfmac_f32_16x16x64_bf16 v[60:63], v[16:19], v[80:87], v0
v_smfmac_f32_16x16x64_bf16 v[64:67], v[16:19], v[88:95], v0
s_waitcnt vmcnt(0)
v_smfmac_f32_16x16x64_bf16 v[60:63], v[20:23], v[96:103], v0
s_add_u32 s39, s42, 2048
v_smfmac_f32_16x16x64_bf16 v[64:67], v[20:23], v[104:111], v0
v_smfmac_f32_16x16x64_bf16 v[60:63], v[24:27], v[112:119], v0
v_smfmac_f32_16x16x64_bf16 v[64:67], v[24:27], v[120:127], v0
s_waitcnt lgkmcnt(0)
s_barrier
ds_read_b128 v[44:47], v1 offset:3072
v_smfmac_f32_16x16x64_bf16 v[60:63], v[28:31], v[128:135], v0
ds_read_b128 v[48:51], v1 offset:4096
v_smfmac_f32_16x16x64_bf16 v[64:67], v[28:31], v[136:143], v0
ds_read_b128 v[52:55], v1 offset:5120
v_smfmac_f32_16x16x64_bf16 v[60:63], v[32:35], v[144:151], v0
ds_read_b128 v[56:59], v1 offset:6144
v_smfmac_f32_16x16x64_bf16 v[64:67], v[32:35], v[152:159], v0
ds_read_b128 v[8:11], v1 offset:8192
v_smfmac_f32_16x16x64_bf16 v[60:63], v[36:39], v[160:167], v0
ds_read_b128 v[16:19], v1 offset:9216
v_smfmac_f32_16x16x64_bf16 v[64:67], v[36:39], v[168:175], v0
ds_read_b128 v[20:23], v1 offset:10240
v_smfmac_f32_16x16x64_bf16 v[60:63], v[40:43], v[176:183], v0
s_waitcnt lgkmcnt(3)
ds_read_b128 v[24:27], v1 offset:11264
v_smfmac_f32_16x16x64_bf16 v[64:67], v[40:43], v[184:191], v0
ds_read_b128 v[12:15], v1 offset:12288
v_mfma_f32_16x16x32_bf16 v[76:79], v[44:47], v[44:47], 0
ds_read_b128 v[28:31], v1 offset:13312
v_add_f32 v60, v60, v62
v_lshrrev_b32 v41, 1, v1
v_mfma_f32_16x16x32_bf16 v[76:79], v[48:51], v[48:51], v[76:79]
ds_read_b128 v[32:35], v1 offset:14336
v_add_f32 v61, v61, v63
v_mfma_f32_16x16x32_bf16 v[76:79], v[52:55], v[52:55], v[76:79]
s_waitcnt lgkmcnt(3)
ds_read_b128 v[36:39], v1 offset:15360
v_add_f32 v64, v64, v66
v_add_f32 v65, v65, v67
v_mfma_f32_16x16x32_bf16 v[76:79], v[56:59], v[56:59], v[76:79]
s_waitcnt lgkmcnt(3)
v_cvt_pk_bf16_f32 v42, v60, v61
v_cvt_pk_bf16_f32 v43, v64, v65
v_mfma_f32_16x16x32_bf16 v[8:11], v[8:11], v[44:47], 0
buffer_store_dwordx2 v[42:43], v41, s[4:7], s39 offen offset:1024 sc1
v_mfma_f32_16x16x32_bf16 v[8:11], v[16:19], v[48:51], v[8:11]
v_mfma_f32_16x16x32_bf16 v[8:11], v[20:23], v[52:55], v[8:11]
s_andn2_b64 exec, exec, s[44:45]
buffer_store_dwordx4 v[52:55], v5, s[4:7], s42 offen sc1
s_mov_b64 exec, -1
v_mfma_f32_16x16x32_bf16 v[8:11], v[24:27], v[56:59], v[8:11]
v_mfma_f32_16x16x32_bf16 v[12:15], v[12:15], v[44:47], 0
s_waitcnt lgkmcnt(0)
v_mov_b32 v16, 0x3f803f80
v_mov_b32 v17, v16
v_mfma_f32_16x16x32_bf16 v[12:15], v[28:31], v[48:51], v[12:15]
v_mov_b64 v[18:19], v[16:17]
v_max3_f32 v40, v76, v77, v8
v_mfma_f32_16x16x32_bf16 v[12:15], v[32:35], v[52:55], v[12:15]
v_max3_f32 v40, v40, v9, v10
v_max_f32 v40, v40, v11
v_mfma_f32_16x16x32_bf16 v[12:15], v[36:39], v[56:59], v[12:15]
ds_read_b128 v[44:47], v6 offset:16384
ds_read_b128 v[48:51], v6 offset:17408
v_mov_b32 v21, 0
v_mov_b32 v22, 0
s_cmp_eq_u32 s37, 63
s_cbranch_scc1 CHn2_end
s_nop 1
v_max3_f32 v40, v40, v12, v13
v_max3_f32 v41, v40, v14, v15
v_max3_f32 v40, v40, v14, v15
ds_read_b128 v[52:55], v6 offset:20480
ds_read_b128 v[56:59], v6 offset:21504
v_permlane16_swap_b32 v40, v41
v_max_f32 v40, v40, v41
v_max_f32 v41, v40, v41
ds_read_b128 v[32:35], v6 offset:18432
ds_read_b128 v[36:39], v6 offset:19456
v_permlane32_swap_b32 v40, v41
v_max_f32 v40, v40, v41
v_mul_f32 v40, s30, v40
v_pk_fma_f32 v[76:77], v[76:77], s[30:31], v[40:41] op_sel_hi:[1,0,0] neg_lo:[0,0,1] neg_hi:[0,0,1]
v_pk_fma_f32 v[8:9], v[8:9], s[30:31], v[40:41] op_sel_hi:[1,0,0] neg_lo:[0,0,1] neg_hi:[0,0,1]
v_pk_fma_f32 v[10:11], v[10:11], s[30:31], v[40:41] op_sel_hi:[1,0,0] neg_lo:[0,0,1] neg_hi:[0,0,1]
v_pk_fma_f32 v[12:13], v[12:13], s[30:31], v[40:41] op_sel_hi:[1,0,0] neg_lo:[0,0,1] neg_hi:[0,0,1]
v_pk_fma_f32 v[14:15], v[14:15], s[30:31], v[40:41] op_sel_hi:[1,0,0] neg_lo:[0,0,1] neg_hi:[0,0,1]
v_exp_f32 v76, v76
v_exp_f32 v77, v77
v_exp_f32 v8, v8
v_cvt_pk_bf16_f32 v20, v76, v77
v_cvt_pk_bf16_f32 v23, v76, v77
v_exp_f32 v9, v9
v_exp_f32 v10, v10
v_mfma_f32_16x16x16_bf16 v[28:31], v[16:17], v[20:21], 0
v_exp_f32 v11, v11
v_mfma_f32_16x16x16_bf16 v[60:63], v[42:43], v[20:21], 0
v_exp_f32 v12, v12
v_mfma_f32_16x16x16_bf16 v[64:67], v[42:43], v[22:23], 0
v_exp_f32 v13, v13
v_exp_f32 v14, v14
v_exp_f32 v15, v15
v_cvt_pk_bf16_f32 v24, v8, v9
v_cvt_pk_bf16_f32 v25, v10, v11
v_cvt_pk_bf16_f32 v26, v12, v13
v_cvt_pk_bf16_f32 v27, v14, v15
v_mov_b64 v[8:9], 0
v_mov_b64 v[10:11], 0
v_mfma_f32_16x16x32_bf16 v[28:31], v[16:19], v[24:27], v[28:31]
v_mov_b64 v[12:13], 0
v_mov_b64 v[14:15], 0
v_mfma_f32_16x16x32_bf16 v[60:63], v[68:71], v[24:27], v[60:63]
v_mov_b64 v[20:21], 0
v_mov_b64 v[22:23], 0
v_mfma_f32_16x16x32_bf16 v[64:67], v[72:75], v[24:27], v[64:67]
v_rcp_f32 v40, v28
v_mov_b64 v[16:17], 0
v_mov_b64 v[18:19], 0
s_mov_b64 exec, s[44:45]
v_mul_f32 v60, v60, v40
v_mul_f32 v61, v61, v40
v_mul_f32 v62, v62, v40
v_mul_f32 v63, v63, v40
v_cvt_pk_bf16_f32 v76, v60, v61
v_cvt_pk_bf16_f32 v77, v62, v63
ds_write_b64 v5, v[76:77] offset:0
v_pk_mul_f32 v[64:65], v[64:65], v[40:41] op_sel_hi:[1,0]
v_pk_mul_f32 v[66:67], v[66:67], v[40:41] op_sel_hi:[1,0]
v_cvt_pk_bf16_f32 v78, v64, v65
v_cvt_pk_bf16_f32 v79, v66, v67
ds_write_b64 v5, v[78:79] offset:8
s_mov_b64 exec, s[46:47]
v_mov_b32 v41, -1
buffer_store_dword v41, v3, s[4:7], s58 offen
s_mov_b64 exec, -1
ds_read_b128 v[60:63], v6 offset:22528
ds_read_b128 v[64:67], v6 offset:23552
v_mov_b64 v[24:25], 0
v_mov_b64 v[26:27], 0
v_mov_b64 v[28:29], 0
v_mov_b64 v[30:31], 0
v_mov_b32 v43, s31
s_waitcnt lgkmcnt(2)
s_barrier
ds_read_b128 v[68:71], v1 offset:0
ds_read_b128 v[72:75], v1 offset:1024
v_mov_b32 v79, s31
s_waitcnt lgkmcnt(1)
v_smfmac_f32_16x16x64_bf16 v[8:11], v[68:71], v[44:51], v0
s_waitcnt lgkmcnt(0)
ds_read_b128 v[44:47], v6 offset:24576
v_smfmac_f32_16x16x64_bf16 v[8:11], v[72:75], v[52:59], v0
ds_read_b128 v[48:51], v6 offset:25600
v_smfmac_f32_16x16x64_bf16 v[12:15], v[68:71], v[32:39], v0
ds_read_b128 v[52:55], v6 offset:28672
v_smfmac_f32_16x16x64_bf16 v[12:15], v[72:75], v[60:67], v0
ds_read_b128 v[56:59], v6 offset:29696
v_add_f32 v8, v8, v10
v_add_f32 v9, v9, v11
v_smfmac_f32_16x16x64_bf16 v[16:19], v[68:71], v[192:199], v0
ds_read_b128 v[32:35], v6 offset:26624
v_cvt_pk_bf16_f32 v40, v8, v9
v_smfmac_f32_16x16x64_bf16 v[16:19], v[72:75], v[200:207], v0
ds_read_b128 v[36:39], v6 offset:27648
v_add_f32 v12, v12, v14
v_add_f32 v13, v13, v15
v_smfmac_f32_16x16x64_bf16 v[20:23], v[68:71], v[208:215], v0
ds_read_b128 v[60:63], v6 offset:30720
v_cvt_pk_bf16_f32 v41, v12, v13
v_mov_b64 v[8:9], 0
v_smfmac_f32_16x16x64_bf16 v[20:23], v[72:75], v[216:223], v0
s_waitcnt lgkmcnt(5)
ds_read_b128 v[64:67], v6 offset:31744
v_add_f32 v16, v16, v18
v_add_f32 v17, v17, v19
v_cvt_pk_bf16_f32 v42, v16, v17
v_smfmac_f32_16x16x64_bf16 v[24:27], v[68:71], v[44:51], v0
s_waitcnt lgkmcnt(4)
ds_read_b128 v[44:47], v6 offset:32768
buffer_store_dwordx4 v[40:43], v2, s[4:7], s60 offen
v_mov_b64 v[16:17], 0
v_mov_b64 v[10:11], 0
v_smfmac_f32_16x16x64_bf16 v[24:27], v[72:75], v[52:59], v0
s_waitcnt lgkmcnt(3)
ds_read_b128 v[48:51], v6 offset:33792
v_add_f32 v20, v20, v22
v_add_f32 v21, v21, v23
v_smfmac_f32_16x16x64_bf16 v[28:31], v[68:71], v[32:39], v0
s_waitcnt lgkmcnt(2)
ds_read_b128 v[52:55], v6 offset:34816
v_cvt_pk_bf16_f32 v76, v20, v21
v_mov_b64 v[18:19], 0
v_smfmac_f32_16x16x64_bf16 v[28:31], v[72:75], v[60:67], v0
ds_read_b128 v[56:59], v6 offset:35840
v_add_f32 v24, v24, v26
v_add_f32 v25, v25, v27
v_smfmac_f32_16x16x64_bf16 v[16:19], v[68:71], v[240:247], v0
v_cvt_pk_bf16_f32 v77, v24, v25
v_mov_b64 v[12:13], 0
v_smfmac_f32_16x16x64_bf16 v[16:19], v[72:75], v[248:255], v0
v_add_f32 v28, v28, v30
v_add_f32 v29, v29, v31
v_cvt_pk_bf16_f32 v78, v28, v29
v_smfmac_f32_16x16x64_bf16 v[8:11], v[68:71], v[224:231], v0
s_waitcnt lgkmcnt(2)
buffer_store_dwordx4 v[76:79], v2, s[4:7], s61 offen
v_mov_b64 v[14:15], 0
v_smfmac_f32_16x16x64_bf16 v[8:11], v[72:75], v[44:51], v0
v_add_f32 v16, v16, v18
v_add_f32 v17, v17, v19
v_smfmac_f32_16x16x64_bf16 v[12:15], v[68:71], v[232:239], v0
s_waitcnt lgkmcnt(0)
s_add_u32 s43, s43, 4
s_add_u32 s37, s37, 1
v_cvt_pk_bf16_f32 v42, v16, v17
v_smfmac_f32_16x16x64_bf16 v[12:15], v[72:75], v[52:59], v0
s_add_u32 s38, s38, 16384
s_add_u32 s42, s42, 4096
v_add_f32 v8, v8, v10
v_add_f32 v9, v9, v11
v_cvt_pk_bf16_f32 v40, v8, v9
s_nop 2
v_pk_add_f32 v[12:13], v[12:13], v[14:15]
v_cvt_pk_bf16_f32 v41, v12, v13
buffer_store_dwordx4 v[40:43], v2, s[4:7], s62 offen
v_and_b32 v33, 16, v1
v_bfe_u32 v32, v1, 5, 3
v_lshlrev_b32 v33, v33, s55
v_mov_b32 v63, 0
v_cmp_eq_u32 vcc, 0, v32
s_nop 1
v_cndmask_b32 v60, 0, v33, vcc
v_cmp_eq_u32 vcc, 1, v32
s_nop 1
v_cndmask_b32 v61, 0, v33, vcc
v_cmp_eq_u32 vcc, 2, v32
s_nop 1
v_cndmask_b32 v62, 0, v33, vcc
s_waitcnt vmcnt(0)
buffer_load_dwordx4 v[44:47], v1, s[4:7], s59 offen offset:0 sc1
buffer_load_dwordx4 v[48:51], v1, s[4:7], s59 offen offset:1024 sc1
buffer_load_dwordx4 v[52:55], v1, s[4:7], s59 offen offset:2048 sc1
buffer_load_dwordx4 v[56:59], v1, s[4:7], s59 offen offset:3072 sc1
s_waitcnt lgkmcnt(0)
s_mov_b32 s29, 0
Lpc41:
s_waitcnt vmcnt(3)
v_mfma_f32_16x16x32_bf16 v[64:67], v[44:47], v[60:63], 0
v_cmp_ne_u32 s[48:49], s31, v47
s_waitcnt vmcnt(2)
v_mfma_f32_16x16x32_bf16 v[64:67], v[48:51], v[60:63], v[64:67]
v_cmp_ne_u32 s[50:51], s31, v51
s_waitcnt vmcnt(1)
v_mfma_f32_16x16x32_bf16 v[64:67], v[52:55], v[60:63], v[64:67]
v_cmp_ne_u32 s[94:95], s31, v55
s_or_b64 s[68:69], s[48:49], s[50:51]
s_waitcnt vmcnt(0)
v_mfma_f32_16x16x32_bf16 v[64:67], v[56:59], v[60:63], v[64:67]
v_cmp_ne_u32 vcc, s31, v59
s_or_b64 s[68:69], s[68:69], s[94:95]
s_or_b64 s[68:69], s[68:69], vcc
s_cbranch_scc0 Lpd42
s_mov_b64 exec, s[48:49]
buffer_load_dwordx4 v[44:47], v1, s[4:7], s59 offen offset:0 sc1
s_mov_b64 exec, s[50:51]
buffer_load_dwordx4 v[48:51], v1, s[4:7], s59 offen offset:1024 sc1
s_mov_b64 exec, s[94:95]
buffer_load_dwordx4 v[52:55], v1, s[4:7], s59 offen offset:2048 sc1
s_mov_b64 exec, vcc
buffer_load_dwordx4 v[56:59], v1, s[4:7], s59 offen offset:3072 sc1
s_mov_b64 exec, -1
s_add_u32 s29, s29, 1
s_add_u32 s91, s91, 1
s_cmp_lt_u32 s29, s25
s_cbranch_scc1 Lpc41
s_mov_b32 s25, 0
s_waitcnt vmcnt(0)
Lpd42:
v_mov_b64 v[44:45], 0
v_mov_b64 v[46:47], 0
v_mov_b64 v[48:49], 0
v_mov_b64 v[50:51], 0
v_permlane32_swap_b32 v64, v66
v_permlane32_swap_b32 v65, v67
v_pk_add_f32 v[64:65], v[64:65], v[66:67]
v_cvt_pk_bf16_f32 v76, v64, v65
s_mov_b64 exec, s[46:47]
buffer_store_dword v76, v3, s[4:7], s57 offen
s_mov_b64 exec, -1
v_mov_b64 v[52:53], 0
v_mov_b64 v[54:55], 0
v_mov_b64 v[56:57], 0
v_mov_b64 v[58:59], 0
ds_read_b128 v[60:63], v6 offset:8192
ds_read_b128 v[64:67], v6 offset:9216
ds_read_b128 v[68:71], v6 offset:10240
ds_read_b128 v[72:75], v6 offset:11264
s_mov_b32 s26, s56
s_mov_b32 s56, s57
s_mov_b32 s57, s58
s_mov_b32 s58, s26
s_add_u32 s31, s31, 1
s_add_u32 s40, s56, 5120
s_add_u32 s41, s38, 2048
s_mov_b32 m0, 14336
s_nop 0
buffer_load_dwordx4 v1, s[4:7], s41 offen offset:0 sc1 lds
buffer_load_dwordx4 v1, s[4:7], s41 offen offset:1024 sc1 lds
s_waitcnt vmcnt(2)
s_barrier
buffer_load_dwordx4 v[28:31], v1, s[4:7], s40 offen offset:0 sc1
buffer_load_dwordx4 v[32:35], v1, s[4:7], s40 offen offset:1024 sc1
s_branch CHn2_step
CHn2_end:
s_mov_b64 exec, s[46:47]
v_mov_b32 v40, -1
buffer_store_dword v40, v3, s[4:7], s58 offen
s_mov_b64 exec, -1
s_waitcnt lgkmcnt(0) vmcnt(0)
s_barrier
s_waitcnt vmcnt(0)
s_barrier
s_mov_b32 s26, s56
s_mov_b32 s56, s57
s_mov_b32 s57, s58
s_mov_b32 s58, s26
s_add_u32 s36, s36, 1
s_cmp_lt_u32 s36, 2
s_cbranch_scc1 CHn2_layer
s_branch END
s_nop 7
CHn3_layer:
s_mov_b32 s37, 0
s_lshl_b32 s43, s52, 1
s_add_u32 s43, s43, s36
s_lshl_b32 s43, s43, 8
s_lshl_b32 s42, s36, 5
s_add_u32 s42, s42, s52
s_lshl_b32 s38, s42, 20
s_add_u32 s38, s38, 58726400
s_lshl_b32 s42, s42, 18
s_add_u32 s42, s42, 25165824
v_bfe_u32 v76, v1, 4, 1
v_lshlrev_b32 v76, 2, v76
s_mov_b32 s29, 0
Lwf43:
buffer_load_dword v77, v76, s[4:7], s43 offen sc1
s_add_u32 s29, s29, 1
s_waitcnt vmcnt(0)
v_cmp_eq_u32 vcc, 0, v77
s_cbranch_vccz Lwd44
s_sleep 1
s_cmp_lt_u32 s29, s25
s_cbranch_scc1 Lwf43
s_mov_b32 s25, 0
Lwd44:
v_bfe_u32 v76, v1, 6, 2
v_bfe_u32 v77, v1, 4, 1
v_lshl_add_u32 v76, v76, 1, v77
v_mul_u32_u24 v76, 1152, v76
v_bfe_u32 v77, v1, 5, 1
v_lshl_add_u32 v76, v77, 4, v76
v_lshrrev_b32 v77, 8, v1
v_lshl_add_u32 v76, v77, 5, v76
buffer_load_dwordx4 v[16:19], v76, s[32:35], 0 offen offset:256
buffer_load_dwordx4 v[36:39], v76, s[32:35], 0 offen offset:896
buffer_load_dwordx4 v[40:43], v76, s[32:35], 0 offen offset:1024
s_barrier
s_add_u32 s40, s56, 7168
v_mov_b64 v[44:45], 0
v_mov_b64 v[46:47], 0
v_mov_b64 v[48:49], 0
v_mov_b64 v[50:51], 0
v_mov_b64 v[52:53], 0
v_mov_b64 v[54:55], 0
v_mov_b64 v[56:57], 0
v_mov_b64 v[58:59], 0
ds_read_b128 v[60:63], v6 offset:12288
ds_read_b128 v[64:67], v6 offset:13312
ds_read_b128 v[68:71], v6 offset:14336
ds_read_b128 v[72:75], v6 offset:15360
CHn3_step:
s_mov_b32 s29, 0
s_waitcnt vmcnt(0)
Lgc45:
v_max3_u32 v76, v36, v37, v38
v_max3_u32 v77, v40, v41, v42
v_max_u32 v76, v76, v39
v_max_u32 v77, v77, v43
v_cmp_eq_u32 s[94:95], -1, v76
v_cmp_eq_u32 vcc, -1, v77
s_or_b64 s[68:69], s[94:95], vcc
s_cbranch_scc0 Lgd46
s_mov_b64 exec, s[94:95]
buffer_load_dwordx4 v[36:39], v1, s[4:7], s40 offen offset:0 sc1
s_mov_b64 exec, vcc
buffer_load_dwordx4 v[40:43], v1, s[4:7], s40 offen offset:1024 sc1
s_mov_b64 exec, -1
s_add_u32 s29, s29, 1
s_add_u32 s90, s90, 1
s_cmp_lt_u32 s29, s25
s_waitcnt vmcnt(0)
s_cbranch_scc1 Lgc45
s_mov_b32 s25, 0
Lgd46:
ds_write_b128 v1, v[36:39] offset:6144
ds_write_b128 v1, v[40:43] offset:7168
s_add_u32 s41, s38, 8192
s_add_u32 s39, s56, 2048
s_cmp_eq_u32 s37, 0
s_waitcnt lgkmcnt(4)
v_smfmac_f32_16x16x64_bf16 v[44:47], v[36:39], v[60:67], v0
s_waitcnt lgkmcnt(2)
ds_read_b128 v[60:63], v6 offset:0
v_smfmac_f32_16x16x64_bf16 v[48:51], v[36:39], v[68:75], v0
ds_read_b128 v[64:67], v6 offset:1024
v_smfmac_f32_16x16x64_bf16 v[52:55], v[36:39], a[192:199], v0
s_waitcnt lgkmcnt(2)
s_barrier
ds_read_b128 v[8:11], v1 offset:0
v_smfmac_f32_16x16x64_bf16 v[56:59], v[36:39], a[200:207], v0
s_cbranch_scc1 CHn3_n8
buffer_load_dwordx4 v[16:19], v1, s[4:7], s39 offen sc1
CHn3_n8:
ds_read_b128 v[12:15], v1 offset:1024
v_smfmac_f32_16x16x64_bf16 v[52:55], v[40:43], a[208:215], v0
ds_read_b128 v[20:23], v1 offset:2048
buffer_load_dwordx4 v[68:71], v1, s[4:7], s41 offen offset:0 sc1
v_smfmac_f32_16x16x64_bf16 v[56:59], v[40:43], a[216:223], v0
ds_read_b128 v[24:27], v1 offset:3072
buffer_load_dwordx4 v[72:75], v1, s[4:7], s41 offen offset:1024 sc1
v_smfmac_f32_16x16x64_bf16 v[44:47], v[40:43], a[64:71], v0
ds_read_b128 v[28:31], v1 offset:4096
v_smfmac_f32_16x16x64_bf16 v[48:51], v[40:43], a[72:79], v0
s_waitcnt lgkmcnt(4)
ds_read_b128 v[32:35], v1 offset:5120
v_smfmac_f32_16x16x64_bf16 v[44:47], v[8:11], v[60:67], v0
ds_read_b128 v[60:63], v6 offset:2048
ds_read_b128 v[64:67], v6 offset:3072
v_smfmac_f32_16x16x64_bf16 v[52:55], v[8:11], a[80:87], v0
v_smfmac_f32_16x16x64_bf16 v[56:59], v[8:11], a[88:95], v0
s_waitcnt lgkmcnt(6)
buffer_load_dword v3, off, s[4:7], s43 offset:8 sc1
v_smfmac_f32_16x16x64_bf16 v[52:55], v[12:15], a[96:103], v0
v_smfmac_f32_16x16x64_bf16 v[56:59], v[12:15], a[104:111], v0
s_waitcnt lgkmcnt(0)
v_smfmac_f32_16x16x64_bf16 v[48:51], v[8:11], v[60:67], v0
ds_read_b128 v[60:63], v6 offset:4096
ds_read_b128 v[64:67], v6 offset:5120
v_smfmac_f32_16x16x64_bf16 v[52:55], v[20:23], a[128:135], v0
s_barrier
v_smfmac_f32_16x16x64_bf16 v[56:59], v[20:23], a[136:143], v0
s_lshr_b32 s41, s42, 10
s_sub_u32 s41, s41, 8196
v_smfmac_f32_16x16x64_bf16 v[52:55], v[24:27], a[144:151], v0
s_cmp_lg_u32 s37, 0
s_cselect_b64 s[48:49], 1, 0
v_smfmac_f32_16x16x64_bf16 v[56:59], v[24:27], a[152:159], v0
s_waitcnt lgkmcnt(0)
v_smfmac_f32_16x16x64_bf16 v[44:47], v[20:23], v[60:67], v0
ds_read_b128 v[60:63], v6 offset:6144
ds_read_b128 v[64:67], v6 offset:7168
v_smfmac_f32_16x16x64_bf16 v[52:55], v[28:31], a[160:167], v0
v_smfmac_f32_16x16x64_bf16 v[56:59], v[28:31], a[168:175], v0
v_smfmac_f32_16x16x64_bf16 v[52:55], v[32:35], a[176:183], v0
v_smfmac_f32_16x16x64_bf16 v[56:59], v[32:35], a[184:191], v0
s_waitcnt lgkmcnt(0)
v_smfmac_f32_16x16x64_bf16 v[48:51], v[20:23], v[60:67], v0
s_waitcnt vmcnt(3)
ds_read_b128 v[60:63], v6 offset:8192
ds_read_b128 v[64:67], v6 offset:9216
v_smfmac_f32_16x16x64_bf16 v[52:55], v[16:19], a[112:119], v0
v_smfmac_f32_16x16x64_bf16 v[56:59], v[16:19], a[120:127], v0
v_smfmac_f32_16x16x64_bf16 v[44:47], v[12:15], a[0:7], v0
v_add_f32 v52, v52, v54
v_smfmac_f32_16x16x64_bf16 v[48:51], v[12:15], a[8:15], v0
s_waitcnt lgkmcnt(0)
v_add_f32 v56, v56, v58
v_smfmac_f32_16x16x64_bf16 v[44:47], v[28:31], v[60:67], v0
ds_read_b128 v[60:63], v6 offset:10240
ds_read_b128 v[64:67], v6 offset:11264
v_add_f32 v53, v53, v55
v_smfmac_f32_16x16x64_bf16 v[44:47], v[24:27], a[32:39], v0
v_add_f32 v57, v57, v59
v_smfmac_f32_16x16x64_bf16 v[48:51], v[24:27], a[40:47], v0
v_cvt_pk_bf16_f32 v78, v52, v56
v_smfmac_f32_16x16x64_bf16 v[44:47], v[32:35], a[48:55], v0
s_waitcnt lgkmcnt(0)
v_cvt_pk_bf16_f32 v79, v53, v57
v_smfmac_f32_16x16x64_bf16 v[48:51], v[28:31], v[60:67], v0
v_smfmac_f32_16x16x64_bf16 v[48:51], v[32:35], a[56:63], v0
ds_write2_b32 v4, v78, v79 offset0:0 offset1:4
v_mov_b64 v[60:61], 0
v_smfmac_f32_16x16x64_bf16 v[44:47], v[16:19], a[16:23], v0
v_mov_b64 v[62:63], 0
v_smfmac_f32_16x16x64_bf16 v[48:51], v[16:19], a[24:31], v0
v_mov_b64 v[64:65], 0
v_mov_b64 v[66:67], 0
v_smfmac_f32_16x16x64_bf16 v[60:63], v[8:11], a[224:231], v0
v_add_f32 v44, v44, v46
v_add_f32 v45, v45, v47
v_smfmac_f32_16x16x64_bf16 v[64:67], v[8:11], a[232:239], v0
v_add_f32 v48, v48, v50
v_add_f32 v49, v49, v51
v_smfmac_f32_16x16x64_bf16 v[60:63], v[12:15], a[240:247], v0
v_cvt_pk_bf16_f32 v76, v44, v48
v_cvt_pk_bf16_f32 v77, v45, v49
v_smfmac_f32_16x16x64_bf16 v[64:67], v[12:15], a[248:255], v0
ds_write2_b32 v4, v76, v77 offset0:8 offset1:12
v_smfmac_f32_16x16x64_bf16 v[60:63], v[16:19], v[80:87], v0
v_smfmac_f32_16x16x64_bf16 v[64:67], v[16:19], v[88:95], v0
s_waitcnt vmcnt(1)
v_smfmac_f32_16x16x64_bf16 v[60:63], v[20:23], v[96:103], v0
s_add_u32 s39, s42, 2048
v_smfmac_f32_16x16x64_bf16 v[64:67], v[20:23], v[104:111], v0
s_mov_b64 exec, s[48:49]
buffer_store_dword v0, off, s[4:7], s41 sc1
s_mov_b64 exec, -1
v_smfmac_f32_16x16x64_bf16 v[60:63], v[24:27], v[112:119], v0
v_smfmac_f32_16x16x64_bf16 v[64:67], v[24:27], v[120:127], v0
s_waitcnt lgkmcnt(0)
s_barrier
ds_read_b128 v[44:47], v1 offset:3072
v_smfmac_f32_16x16x64_bf16 v[60:63], v[28:31], v[128:135], v0
ds_read_b128 v[48:51], v1 offset:4096
v_smfmac_f32_16x16x64_bf16 v[64:67], v[28:31], v[136:143], v0
ds_read_b128 v[52:55], v1 offset:5120
v_smfmac_f32_16x16x64_bf16 v[60:63], v[32:35], v[144:151], v0
ds_read_b128 v[56:59], v1 offset:6144
v_smfmac_f32_16x16x64_bf16 v[64:67], v[32:35], v[152:159], v0
ds_read_b128 v[8:11], v1 offset:8192
v_smfmac_f32_16x16x64_bf16 v[60:63], v[36:39], v[160:167], v0
ds_read_b128 v[16:19], v1 offset:9216
v_smfmac_f32_16x16x64_bf16 v[64:67], v[36:39], v[168:175], v0
ds_read_b128 v[20:23], v1 offset:10240
v_smfmac_f32_16x16x64_bf16 v[60:63], v[40:43], v[176:183], v0
s_waitcnt lgkmcnt(3)
ds_read_b128 v[24:27], v1 offset:11264
v_smfmac_f32_16x16x64_bf16 v[64:67], v[40:43], v[184:191], v0
ds_read_b128 v[12:15], v1 offset:12288
v_mfma_f32_16x16x32_bf16 v[76:79], v[44:47], v[44:47], 0
ds_read_b128 v[28:31], v1 offset:13312
v_add_f32 v60, v60, v62
v_lshrrev_b32 v41, 1, v1
v_mfma_f32_16x16x32_bf16 v[76:79], v[48:51], v[48:51], v[76:79]
ds_read_b128 v[32:35], v1 offset:14336
v_add_f32 v61, v61, v63
v_mfma_f32_16x16x32_bf16 v[76:79], v[52:55], v[52:55], v[76:79]
s_waitcnt lgkmcnt(3)
ds_read_b128 v[36:39], v1 offset:15360
v_add_f32 v64, v64, v66
v_add_f32 v65, v65, v67
v_mfma_f32_16x16x32_bf16 v[76:79], v[56:59], v[56:59], v[76:79]
s_waitcnt lgkmcnt(3)
v_cvt_pk_bf16_f32 v42, v60, v61
v_cvt_pk_bf16_f32 v43, v64, v65
v_mfma_f32_16x16x32_bf16 v[8:11], v[8:11], v[44:47], 0
v_mfma_f32_16x16x32_bf16 v[8:11], v[16:19], v[48:51], v[8:11]
buffer_store_dwordx2 v[42:43], v41, s[4:7], s39 offen offset:1536 sc1
v_mfma_f32_16x16x32_bf16 v[8:11], v[20:23], v[52:55], v[8:11]
v_mfma_f32_16x16x32_bf16 v[8:11], v[24:27], v[56:59], v[8:11]
s_andn2_b64 exec, exec, s[44:45]
buffer_store_dwordx4 v[56:59], v5, s[4:7], s42 offen sc1
s_mov_b64 exec, -1
v_mfma_f32_16x16x32_bf16 v[12:15], v[12:15], v[44:47], 0
s_waitcnt lgkmcnt(0)
v_mov_b32 v16, 0x3f803f80
v_mov_b32 v17, v16
v_mfma_f32_16x16x32_bf16 v[12:15], v[28:31], v[48:51], v[12:15]
v_mov_b64 v[18:19], v[16:17]
v_max3_f32 v40, v76, v77, v8
v_mfma_f32_16x16x32_bf16 v[12:15], v[32:35], v[52:55], v[12:15]
v_max3_f32 v40, v40, v9, v10
v_max_f32 v40, v40, v11
v_mfma_f32_16x16x32_bf16 v[12:15], v[36:39], v[56:59], v[12:15]
ds_read_b128 v[44:47], v6 offset:16384
ds_read_b128 v[48:51], v6 offset:17408
v_mov_b32 v21, 0
v_mov_b32 v22, 0
s_cmp_eq_u32 s37, 63
s_cbranch_scc1 CHn3_end
s_nop 1
v_max3_f32 v40, v40, v12, v13
v_max3_f32 v41, v40, v14, v15
v_max3_f32 v40, v40, v14, v15
ds_read_b128 v[52:55], v6 offset:20480
ds_read_b128 v[56:59], v6 offset:21504
v_permlane16_swap_b32 v40, v41
v_max_f32 v40, v40, v41
v_max_f32 v41, v40, v41
ds_read_b128 v[32:35], v6 offset:18432
ds_read_b128 v[36:39], v6 offset:19456
v_permlane32_swap_b32 v40, v41
v_max_f32 v40, v40, v41
v_mul_f32 v40, s30, v40
v_pk_fma_f32 v[76:77], v[76:77], s[30:31], v[40:41] op_sel_hi:[1,0,0] neg_lo:[0,0,1] neg_hi:[0,0,1]
v_pk_fma_f32 v[8:9], v[8:9], s[30:31], v[40:41] op_sel_hi:[1,0,0] neg_lo:[0,0,1] neg_hi:[0,0,1]
v_pk_fma_f32 v[10:11], v[10:11], s[30:31], v[40:41] op_sel_hi:[1,0,0] neg_lo:[0,0,1] neg_hi:[0,0,1]
v_pk_fma_f32 v[12:13], v[12:13], s[30:31], v[40:41] op_sel_hi:[1,0,0] neg_lo:[0,0,1] neg_hi:[0,0,1]
v_pk_fma_f32 v[14:15], v[14:15], s[30:31], v[40:41] op_sel_hi:[1,0,0] neg_lo:[0,0,1] neg_hi:[0,0,1]
v_exp_f32 v76, v76
v_exp_f32 v77, v77
v_exp_f32 v8, v8
v_cvt_pk_bf16_f32 v20, v76, v77
v_cvt_pk_bf16_f32 v23, v76, v77
v_exp_f32 v9, v9
v_exp_f32 v10, v10
v_mfma_f32_16x16x16_bf16 v[28:31], v[16:17], v[20:21], 0
v_exp_f32 v11, v11
v_mfma_f32_16x16x16_bf16 v[60:63], v[42:43], v[20:21], 0
v_exp_f32 v12, v12
v_mfma_f32_16x16x16_bf16 v[64:67], v[42:43], v[22:23], 0
v_exp_f32 v13, v13
v_exp_f32 v14, v14
v_exp_f32 v15, v15
v_cvt_pk_bf16_f32 v24, v8, v9
v_cvt_pk_bf16_f32 v25, v10, v11
v_cvt_pk_bf16_f32 v26, v12, v13
v_cvt_pk_bf16_f32 v27, v14, v15
v_mov_b64 v[8:9], 0
v_mov_b64 v[10:11], 0
v_mfma_f32_16x16x32_bf16 v[28:31], v[16:19], v[24:27], v[28:31]
v_mov_b64 v[12:13], 0
v_mov_b64 v[14:15], 0
v_mfma_f32_16x16x32_bf16 v[60:63], v[68:71], v[24:27], v[60:63]
v_mov_b64 v[20:21], 0
v_mov_b64 v[22:23], 0
v_mfma_f32_16x16x32_bf16 v[64:67], v[72:75], v[24:27], v[64:67]
v_rcp_f32 v40, v28
v_mov_b64 v[16:17], 0
v_mov_b64 v[18:19], 0
s_mov_b64 exec, s[44:45]
v_mul_f32 v60, v60, v40
v_mul_f32 v61, v61, v40
v_mul_f32 v62, v62, v40
v_mul_f32 v63, v63, v40
v_cvt_pk_bf16_f32 v76, v60, v61
v_cvt_pk_bf16_f32 v77, v62, v63
ds_write_b64 v5, v[76:77] offset:0
v_pk_mul_f32 v[64:65], v[64:65], v[40:41] op_sel_hi:[1,0]
v_pk_mul_f32 v[66:67], v[66:67], v[40:41] op_sel_hi:[1,0]
v_cvt_pk_bf16_f32 v78, v64, v65
v_cvt_pk_bf16_f32 v79, v66, v67
ds_write_b64 v5, v[78:79] offset:8
s_mov_b64 exec, -1
ds_read_b128 v[60:63], v6 offset:22528
ds_read_b128 v[64:67], v6 offset:23552
v_mov_b64 v[24:25], 0
v_mov_b64 v[26:27], 0
v_mov_b64 v[28:29], 0
v_mov_b64 v[30:31], 0
v_mov_b32 v43, s31
s_waitcnt lgkmcnt(2)
s_barrier
ds_read_b128 v[68:71], v1 offset:0
ds_read_b128 v[72:75], v1 offset:1024
v_mov_b32 v79, s31
s_waitcnt lgkmcnt(1)
v_smfmac_f32_16x16x64_bf16 v[8:11], v[68:71], v[44:51], v0
s_waitcnt lgkmcnt(0)
ds_read_b128 v[44:47], v6 offset:24576
v_smfmac_f32_16x16x64_bf16 v[8:11], v[72:75], v[52:59], v0
ds_read_b128 v[48:51], v6 offset:25600
v_smfmac_f32_16x16x64_bf16 v[12:15], v[68:71], v[32:39], v0
ds_read_b128 v[52:55], v6 offset:28672
v_smfmac_f32_16x16x64_bf16 v[12:15], v[72:75], v[60:67], v0
ds_read_b128 v[56:59], v6 offset:29696
v_add_f32 v8, v8, v10
v_add_f32 v9, v9, v11
v_smfmac_f32_16x16x64_bf16 v[16:19], v[68:71], v[192:199], v0
ds_read_b128 v[32:35], v6 offset:26624
v_cvt_pk_bf16_f32 v40, v8, v9
v_smfmac_f32_16x16x64_bf16 v[16:19], v[72:75], v[200:207], v0
ds_read_b128 v[36:39], v6 offset:27648
v_add_f32 v12, v12, v14
v_add_f32 v13, v13, v15
v_smfmac_f32_16x16x64_bf16 v[20:23], v[68:71], v[208:215], v0
ds_read_b128 v[60:63], v6 offset:30720
v_cvt_pk_bf16_f32 v41, v12, v13
v_mov_b64 v[8:9], 0
v_smfmac_f32_16x16x64_bf16 v[20:23], v[72:75], v[216:223], v0
s_waitcnt lgkmcnt(5)
ds_read_b128 v[64:67], v6 offset:31744
v_add_f32 v16, v16, v18
v_add_f32 v17, v17, v19
v_cvt_pk_bf16_f32 v42, v16, v17
v_smfmac_f32_16x16x64_bf16 v[24:27], v[68:71], v[44:51], v0
s_waitcnt lgkmcnt(4)
ds_read_b128 v[44:47], v6 offset:32768
buffer_store_dwordx4 v[40:43], v2, s[4:7], s60 offen
v_mov_b64 v[16:17], 0
v_mov_b64 v[10:11], 0
v_smfmac_f32_16x16x64_bf16 v[24:27], v[72:75], v[52:59], v0
s_waitcnt lgkmcnt(3)
ds_read_b128 v[48:51], v6 offset:33792
v_add_f32 v20, v20, v22
v_add_f32 v21, v21, v23
v_smfmac_f32_16x16x64_bf16 v[28:31], v[68:71], v[32:39], v0
s_waitcnt lgkmcnt(2)
ds_read_b128 v[52:55], v6 offset:34816
v_cvt_pk_bf16_f32 v76, v20, v21
v_mov_b64 v[18:19], 0
v_smfmac_f32_16x16x64_bf16 v[28:31], v[72:75], v[60:67], v0
ds_read_b128 v[56:59], v6 offset:35840
v_add_f32 v24, v24, v26
v_add_f32 v25, v25, v27
v_smfmac_f32_16x16x64_bf16 v[16:19], v[68:71], v[240:247], v0
v_cvt_pk_bf16_f32 v77, v24, v25
v_mov_b64 v[12:13], 0
v_smfmac_f32_16x16x64_bf16 v[16:19], v[72:75], v[248:255], v0
v_add_f32 v28, v28, v30
v_add_f32 v29, v29, v31
v_cvt_pk_bf16_f32 v78, v28, v29
v_smfmac_f32_16x16x64_bf16 v[8:11], v[68:71], v[224:231], v0
s_waitcnt lgkmcnt(2)
buffer_store_dwordx4 v[76:79], v2, s[4:7], s61 offen
v_mov_b64 v[14:15], 0
v_smfmac_f32_16x16x64_bf16 v[8:11], v[72:75], v[44:51], v0
v_add_f32 v16, v16, v18
v_add_f32 v17, v17, v19
v_smfmac_f32_16x16x64_bf16 v[12:15], v[68:71], v[232:239], v0
s_waitcnt lgkmcnt(0)
s_add_u32 s43, s43, 4
s_add_u32 s37, s37, 1
v_cvt_pk_bf16_f32 v42, v16, v17
v_smfmac_f32_16x16x64_bf16 v[12:15], v[72:75], v[52:59], v0
s_add_u32 s38, s38, 16384
s_add_u32 s42, s42, 4096
v_add_f32 v8, v8, v10
v_add_f32 v9, v9, v11
v_cvt_pk_bf16_f32 v40, v8, v9
s_nop 2
v_pk_add_f32 v[12:13], v[12:13], v[14:15]
v_cvt_pk_bf16_f32 v41, v12, v13
buffer_store_dwordx4 v[40:43], v2, s[4:7], s62 offen
s_waitcnt vmcnt(5)
s_cmp_ge_u32 s37, 63
s_cbranch_scc1 CHn3_kv
v_cmp_eq_u32 vcc, 0, v3
s_cbranch_vccz CHn3_kv
s_add_u32 s90, s90, 1
s_add_u32 s41, s43, 4
v_mov_b32 v76, 0
s_mov_b32 s29, 0
Lwf47:
buffer_load_dword v77, v76, s[4:7], s41 offen sc1
s_add_u32 s29, s29, 1
s_waitcnt vmcnt(0)
v_cmp_eq_u32 vcc, 0, v77
s_cbranch_vccz Lwd48
s_sleep 1
s_cmp_lt_u32 s29, s25
s_cbranch_scc1 Lwf47
s_mov_b32 s25, 0
Lwd48:
CHn3_kv:
v_mov_b64 v[44:45], 0
v_mov_b64 v[46:47], 0
v_mov_b64 v[48:49], 0
v_mov_b64 v[50:51], 0
v_mov_b64 v[52:53], 0
v_mov_b64 v[54:55], 0
v_mov_b64 v[56:57], 0
v_mov_b64 v[58:59], 0
ds_read_b128 v[60:63], v6 offset:12288
ds_read_b128 v[64:67], v6 offset:13312
ds_read_b128 v[68:71], v6 offset:14336
ds_read_b128 v[72:75], v6 offset:15360
s_mov_b32 s26, s56
s_mov_b32 s56, s57
s_mov_b32 s57, s58
s_mov_b32 s58, s26
s_add_u32 s31, s31, 1
s_add_u32 s40, s56, 7168
s_barrier
buffer_load_dwordx4 v[36:39], v1, s[4:7], s40 offen offset:0 sc1
buffer_load_dwordx4 v[40:43], v1, s[4:7], s40 offen offset:1024 sc1
s_branch CHn3_step
CHn3_end:
s_waitcnt lgkmcnt(0)
s_barrier
s_lshr_b32 s41, s42, 10
s_sub_u32 s41, s41, 8192
s_waitcnt vmcnt(0)
v_mov_b32 v76, 1
s_mov_b64 exec, 1
buffer_store_dword v76, off, s[4:7], s41 sc1
s_mov_b64 exec, -1
s_waitcnt vmcnt(0)
s_barrier
s_mov_b32 s26, s56
s_mov_b32 s56, s57
s_mov_b32 s57, s58
s_mov_b32 s58, s26
s_add_u32 s36, s36, 1
s_cmp_lt_u32 s36, 2
s_cbranch_scc1 CHn3_layer
s_branch END
s_nop 7
CHf0_layer:
s_mov_b32 s37, 0
s_lshl_b32 s43, s52, 1
s_add_u32 s43, s43, s36
s_lshl_b32 s43, s43, 8
s_lshl_b32 s42, s36, 5
s_add_u32 s42, s42, s52
s_lshl_b32 s38, s42, 20
s_add_u32 s38, s38, 58720256
s_lshl_b32 s42, s42, 18
s_add_u32 s42, s42, 25165824
v_bfe_u32 v76, v1, 6, 2
v_bfe_u32 v77, v1, 4, 1
v_lshl_add_u32 v76, v76, 1, v77
v_mul_u32_u24 v76, 1152, v76
v_bfe_u32 v77, v1, 5, 1
v_lshl_add_u32 v76, v77, 4, v76
v_lshrrev_b32 v77, 8, v1
v_lshl_add_u32 v76, v77, 5, v76
buffer_load_dwordx4 v[8:11], v76, s[32:35], 0 offen offset:0
buffer_load_dwordx4 v[12:15], v76, s[32:35], 0 offen offset:128
buffer_load_dwordx4 v[16:19], v76, s[32:35], 0 offen offset:256
s_barrier
s_add_u32 s41, s38, 0
s_mov_b32 m0, 8192
s_nop 0
buffer_load_dwordx4 v1, s[4:7], s41 offen offset:0 sc1 lds
buffer_load_dwordx4 v1, s[4:7], s41 offen offset:1024 sc1 lds
buffer_load_dwordx4 v1, s[4:7], s41 offen offset:2048 sc1 lds
s_add_u32 s40, s56, 0
v_mov_b64 v[44:45], 0
v_mov_b64 v[46:47], 0
v_mov_b64 v[48:49], 0
v_mov_b64 v[50:51], 0
v_mov_b64 v[52:53], 0
v_mov_b64 v[54:55], 0
v_mov_b64 v[56:57], 0
v_mov_b64 v[58:59], 0
ds_read_b128 v[60:63], v6 offset:0
ds_read_b128 v[64:67], v6 offset:1024
ds_read_b128 v[68:71], v6 offset:2048
ds_read_b128 v[72:75], v6 offset:3072
CHf0_step:
s_mov_b32 s29, 0
s_waitcnt vmcnt(0)
Lgc49:
v_max3_u32 v76, v8, v9, v10
v_max3_u32 v77, v12, v13, v14
v_max3_u32 v78, v16, v17, v18
v_max_u32 v76, v76, v11
v_max_u32 v77, v77, v15
v_max_u32 v78, v78, v19
v_cmp_eq_u32 s[94:95], -1, v76
v_cmp_eq_u32 vcc, -1, v77
v_cmp_eq_u32 s[50:51], -1, v78
s_or_b64 s[68:69], s[94:95], vcc
s_or_b64 s[68:69], s[68:69], s[50:51]
s_cbranch_scc0 Lgd50
s_mov_b64 exec, s[94:95]
buffer_load_dwordx4 v[8:11], v1, s[4:7], s40 offen offset:0 sc1
s_mov_b64 exec, vcc
buffer_load_dwordx4 v[12:15], v1, s[4:7], s40 offen offset:1024 sc1
s_mov_b64 exec, s[50:51]
buffer_load_dwordx4 v[16:19], v1, s[4:7], s40 offen offset:2048 sc1
s_mov_b64 exec, -1
s_add_u32 s29, s29, 1
s_add_u32 s90, s90, 1
s_cmp_lt_u32 s29, s25
s_waitcnt vmcnt(0)
s_cbranch_scc1 Lgc49
s_mov_b32 s25, 0
Lgd50:
ds_write_b128 v1, v[8:11] offset:0
ds_write_b128 v1, v[12:15] offset:1024
s_cmp_lt_u32 s37, 63
s_cselect_b32 s40, 16384, 0
s_add_u32 s40, s40, s38
s_add_u32 s40, s40, 0
v_lshlrev_b32 v7, 3, v1
s_add_u32 s41, s38, 8192
s_add_u32 s39, s56, 2048
s_cmp_eq_u32 s37, 0
s_waitcnt lgkmcnt(4)
v_smfmac_f32_16x16x64_bf16 v[44:47], v[8:11], v[60:67], v0
s_waitcnt lgkmcnt(2)
ds_read_b128 v[60:63], v6 offset:4096
v_smfmac_f32_16x16x64_bf16 v[48:51], v[8:11], v[68:75], v0
ds_read_b128 v[64:67], v6 offset:5120
v_smfmac_f32_16x16x64_bf16 v[52:55], v[8:11], a[80:87], v0
s_waitcnt lgkmcnt(2)
s_barrier
ds_read_b128 v[20:23], v1 offset:2048
v_smfmac_f32_16x16x64_bf16 v[56:59], v[8:11], a[88:95], v0
ds_read_b128 v[24:27], v1 offset:3072
v_smfmac_f32_16x16x64_bf16 v[52:55], v[12:15], a[96:103], v0
ds_read_b128 v[28:31], v1 offset:4096
buffer_load_dwordx4 v[68:71], v1, s[4:7], s41 offen offset:0 sc1
v_smfmac_f32_16x16x64_bf16 v[56:59], v[12:15], a[104:111], v0
ds_read_b128 v[32:35], v1 offset:5120
buffer_load_dwordx4 v[72:75], v1, s[4:7], s41 offen offset:1024 sc1
v_smfmac_f32_16x16x64_bf16 v[52:55], v[16:19], a[112:119], v0
ds_read_b128 v[36:39], v1 offset:6144
v_smfmac_f32_16x16x64_bf16 v[56:59], v[16:19], a[120:127], v0
s_waitcnt lgkmcnt(4)
ds_read_b128 v[40:43], v1 offset:7168
v_smfmac_f32_16x16x64_bf16 v[44:47], v[20:23], v[60:67], v0
ds_read_b128 v[60:63], v6 offset:6144
ds_read_b128 v[64:67], v6 offset:7168
v_smfmac_f32_16x16x64_bf16 v[52:55], v[20:23], a[128:135], v0
v_smfmac_f32_16x16x64_bf16 v[56:59], v[20:23], a[136:143], v0
s_waitcnt lgkmcnt(6)
buffer_load_dword v7, v7, s[4:7], s40 offen sc1
v_smfmac_f32_16x16x64_bf16 v[52:55], v[24:27], a[144:151], v0
v_smfmac_f32_16x16x64_bf16 v[56:59], v[24:27], a[152:159], v0
s_waitcnt lgkmcnt(0)
v_smfmac_f32_16x16x64_bf16 v[48:51], v[20:23], v[60:67], v0
ds_read_b128 v[60:63], v6 offset:8192
ds_read_b128 v[64:67], v6 offset:9216
v_smfmac_f32_16x16x64_bf16 v[52:55], v[28:31], a[160:167], v0
s_barrier
v_smfmac_f32_16x16x64_bf16 v[56:59], v[28:31], a[168:175], v0
v_smfmac_f32_16x16x64_bf16 v[52:55], v[32:35], a[176:183], v0
v_smfmac_f32_16x16x64_bf16 v[56:59], v[32:35], a[184:191], v0
s_waitcnt lgkmcnt(0)
v_smfmac_f32_16x16x64_bf16 v[44:47], v[28:31], v[60:67], v0
ds_read_b128 v[60:63], v6 offset:10240
ds_read_b128 v[64:67], v6 offset:11264
v_smfmac_f32_16x16x64_bf16 v[52:55], v[36:39], a[192:199], v0
v_smfmac_f32_16x16x64_bf16 v[56:59], v[36:39], a[200:207], v0
v_smfmac_f32_16x16x64_bf16 v[52:55], v[40:43], a[208:215], v0
v_smfmac_f32_16x16x64_bf16 v[56:59], v[40:43], a[216:223], v0
s_waitcnt lgkmcnt(0)
v_smfmac_f32_16x16x64_bf16 v[48:51], v[28:31], v[60:67], v0
ds_read_b128 v[60:63], v6 offset:12288
ds_read_b128 v[64:67], v6 offset:13312
v_smfmac_f32_16x16x64_bf16 v[44:47], v[12:15], a[0:7], v0
v_smfmac_f32_16x16x64_bf16 v[48:51], v[12:15], a[8:15], v0
v_smfmac_f32_16x16x64_bf16 v[44:47], v[16:19], a[16:23], v0
v_add_f32 v52, v52, v54
v_smfmac_f32_16x16x64_bf16 v[48:51], v[16:19], a[24:31], v0
s_waitcnt lgkmcnt(0)
v_add_f32 v56, v56, v58
v_smfmac_f32_16x16x64_bf16 v[44:47], v[36:39], v[60:67], v0
ds_read_b128 v[60:63], v6 offset:14336
ds_read_b128 v[64:67], v6 offset:15360
v_add_f32 v53, v53, v55
v_smfmac_f32_16x16x64_bf16 v[44:47], v[24:27], a[32:39], v0
v_add_f32 v57, v57, v59
v_smfmac_f32_16x16x64_bf16 v[48:51], v[24:27], a[40:47], v0
v_cvt_pk_bf16_f32 v78, v52, v56
v_smfmac_f32_16x16x64_bf16 v[44:47], v[32:35], a[48:55], v0
s_waitcnt lgkmcnt(0)
v_cvt_pk_bf16_f32 v79, v53, v57
v_smfmac_f32_16x16x64_bf16 v[48:51], v[36:39], v[60:67], v0
v_smfmac_f32_16x16x64_bf16 v[48:51], v[32:35], a[56:63], v0
ds_write2_b32 v4, v78, v79 offset0:0 offset1:4
v_mov_b64 v[60:61], 0
v_smfmac_f32_16x16x64_bf16 v[44:47], v[40:43], a[64:71], v0
v_mov_b64 v[62:63], 0
v_smfmac_f32_16x16x64_bf16 v[48:51], v[40:43], a[72:79], v0
v_mov_b64 v[64:65], 0
v_mov_b64 v[66:67], 0
v_smfmac_f32_16x16x64_bf16 v[60:63], v[8:11], a[224:231], v0
v_add_f32 v44, v44, v46
v_add_f32 v45, v45, v47
v_smfmac_f32_16x16x64_bf16 v[64:67], v[8:11], a[232:239], v0
v_add_f32 v48, v48, v50
v_add_f32 v49, v49, v51
v_smfmac_f32_16x16x64_bf16 v[60:63], v[12:15], a[240:247], v0
v_cvt_pk_bf16_f32 v76, v44, v48
v_cvt_pk_bf16_f32 v77, v45, v49
v_smfmac_f32_16x16x64_bf16 v[64:67], v[12:15], a[248:255], v0
ds_write2_b32 v4, v76, v77 offset0:8 offset1:12
v_smfmac_f32_16x16x64_bf16 v[60:63], v[16:19], v[80:87], v0
v_smfmac_f32_16x16x64_bf16 v[64:67], v[16:19], v[88:95], v0
s_waitcnt vmcnt(1)
v_smfmac_f32_16x16x64_bf16 v[60:63], v[20:23], v[96:103], v0
s_add_u32 s39, s42, 2048
v_smfmac_f32_16x16x64_bf16 v[64:67], v[20:23], v[104:111], v0
v_smfmac_f32_16x16x64_bf16 v[60:63], v[24:27], v[112:119], v0
v_smfmac_f32_16x16x64_bf16 v[64:67], v[24:27], v[120:127], v0
s_waitcnt lgkmcnt(0)
s_barrier
ds_read_b128 v[44:47], v1 offset:3072
v_smfmac_f32_16x16x64_bf16 v[60:63], v[28:31], v[128:135], v0
ds_read_b128 v[48:51], v1 offset:4096
v_smfmac_f32_16x16x64_bf16 v[64:67], v[28:31], v[136:143], v0
ds_read_b128 v[52:55], v1 offset:5120
v_smfmac_f32_16x16x64_bf16 v[60:63], v[32:35], v[144:151], v0
ds_read_b128 v[56:59], v1 offset:6144
v_smfmac_f32_16x16x64_bf16 v[64:67], v[32:35], v[152:159], v0
ds_read_b128 v[8:11], v1 offset:8192
v_smfmac_f32_16x16x64_bf16 v[60:63], v[36:39], v[160:167], v0
ds_read_b128 v[16:19], v1 offset:9216
v_smfmac_f32_16x16x64_bf16 v[64:67], v[36:39], v[168:175], v0
ds_read_b128 v[20:23], v1 offset:10240
v_smfmac_f32_16x16x64_bf16 v[60:63], v[40:43], v[176:183], v0
s_waitcnt lgkmcnt(3)
ds_read_b128 v[24:27], v1 offset:11264
v_smfmac_f32_16x16x64_bf16 v[64:67], v[40:43], v[184:191], v0
ds_read_b128 v[12:15], v1 offset:12288
v_mfma_f32_16x16x32_bf16 v[76:79], v[44:47], v[44:47], 0
ds_read_b128 v[28:31], v1 offset:13312
v_add_f32 v60, v60, v62
v_lshrrev_b32 v41, 1, v1
v_mfma_f32_16x16x32_bf16 v[76:79], v[48:51], v[48:51], v[76:79]
ds_read_b128 v[32:35], v1 offset:14336
v_add_f32 v61, v61, v63
v_mfma_f32_16x16x32_bf16 v[76:79], v[52:55], v[52:55], v[76:79]
s_waitcnt lgkmcnt(3)
ds_read_b128 v[36:39], v1 offset:15360
v_add_f32 v64, v64, v66
v_add_f32 v65, v65, v67
v_mfma_f32_16x16x32_bf16 v[76:79], v[56:59], v[56:59], v[76:79]
s_waitcnt lgkmcnt(3)
v_cvt_pk_bf16_f32 v42, v60, v61
v_cvt_pk_bf16_f32 v43, v64, v65
v_mfma_f32_16x16x32_bf16 v[8:11], v[8:11], v[44:47], 0
s_andn2_b64 exec, exec, s[44:45]
buffer_store_dwordx4 v[44:47], v5, s[4:7], s42 offen sc1
s_mov_b64 exec, -1
v_mfma_f32_16x16x32_bf16 v[8:11], v[16:19], v[48:51], v[8:11]
v_mfma_f32_16x16x32_bf16 v[8:11], v[20:23], v[52:55], v[8:11]
buffer_store_dwordx2 v[42:43], v41, s[4:7], s39 offen offset:0 sc1
v_mfma_f32_16x16x32_bf16 v[8:11], v[24:27], v[56:59], v[8:11]
v_mfma_f32_16x16x32_bf16 v[12:15], v[12:15], v[44:47], 0
s_waitcnt lgkmcnt(0)
v_mov_b32 v16, 0x3f803f80
v_mov_b32 v17, v16
v_mfma_f32_16x16x32_bf16 v[12:15], v[28:31], v[48:51], v[12:15]
v_mov_b64 v[18:19], v[16:17]
v_max3_f32 v40, v76, v77, v8
v_mfma_f32_16x16x32_bf16 v[12:15], v[32:35], v[52:55], v[12:15]
v_max3_f32 v40, v40, v9, v10
v_max_f32 v40, v40, v11
v_mfma_f32_16x16x32_bf16 v[12:15], v[36:39], v[56:59], v[12:15]
ds_read_b128 v[44:47], v6 offset:16384
ds_read_b128 v[48:51], v6 offset:17408
v_mov_b32 v21, 0
v_mov_b32 v22, 0
s_cmp_eq_u32 s37, 63
s_cbranch_scc1 CHf0_end
s_nop 1
v_max3_f32 v40, v40, v12, v13
v_max3_f32 v41, v40, v14, v15
v_max3_f32 v40, v40, v14, v15
ds_read_b128 v[52:55], v6 offset:20480
ds_read_b128 v[56:59], v6 offset:21504
v_permlane16_swap_b32 v40, v41
v_max_f32 v40, v40, v41
v_max_f32 v41, v40, v41
ds_read_b128 v[32:35], v6 offset:18432
ds_read_b128 v[36:39], v6 offset:19456
v_permlane32_swap_b32 v40, v41
v_max_f32 v40, v40, v41
v_mul_f32 v40, s30, v40
v_pk_fma_f32 v[76:77], v[76:77], s[30:31], v[40:41] op_sel_hi:[1,0,0] neg_lo:[0,0,1] neg_hi:[0,0,1]
v_pk_fma_f32 v[8:9], v[8:9], s[30:31], v[40:41] op_sel_hi:[1,0,0] neg_lo:[0,0,1] neg_hi:[0,0,1]
v_pk_fma_f32 v[10:11], v[10:11], s[30:31], v[40:41] op_sel_hi:[1,0,0] neg_lo:[0,0,1] neg_hi:[0,0,1]
v_pk_fma_f32 v[12:13], v[12:13], s[30:31], v[40:41] op_sel_hi:[1,0,0] neg_lo:[0,0,1] neg_hi:[0,0,1]
v_pk_fma_f32 v[14:15], v[14:15], s[30:31], v[40:41] op_sel_hi:[1,0,0] neg_lo:[0,0,1] neg_hi:[0,0,1]
v_exp_f32 v76, v76
v_exp_f32 v77, v77
v_exp_f32 v8, v8
v_cvt_pk_bf16_f32 v20, v76, v77
v_cvt_pk_bf16_f32 v23, v76, v77
v_exp_f32 v9, v9
v_exp_f32 v10, v10
v_mfma_f32_16x16x16_bf16 v[28:31], v[16:17], v[20:21], 0
v_exp_f32 v11, v11
v_mfma_f32_16x16x16_bf16 v[60:63], v[42:43], v[20:21], 0
v_exp_f32 v12, v12
v_mfma_f32_16x16x16_bf16 v[64:67], v[42:43], v[22:23], 0
v_exp_f32 v13, v13
v_exp_f32 v14, v14
v_exp_f32 v15, v15
v_cvt_pk_bf16_f32 v24, v8, v9
v_cvt_pk_bf16_f32 v25, v10, v11
v_cvt_pk_bf16_f32 v26, v12, v13
v_cvt_pk_bf16_f32 v27, v14, v15
v_mov_b64 v[8:9], 0
v_mov_b64 v[10:11], 0
v_mfma_f32_16x16x32_bf16 v[28:31], v[16:19], v[24:27], v[28:31]
v_mov_b64 v[12:13], 0
v_mov_b64 v[14:15], 0
v_mfma_f32_16x16x32_bf16 v[60:63], v[68:71], v[24:27], v[60:63]
v_mov_b64 v[20:21], 0
v_mov_b64 v[22:23], 0
v_mfma_f32_16x16x32_bf16 v[64:67], v[72:75], v[24:27], v[64:67]
v_rcp_f32 v40, v28
v_mov_b64 v[16:17], 0
v_mov_b64 v[18:19], 0
s_mov_b64 exec, s[44:45]
v_mul_f32 v60, v60, v40
v_mul_f32 v61, v61, v40
v_mul_f32 v62, v62, v40
v_mul_f32 v63, v63, v40
v_cvt_pk_bf16_f32 v76, v60, v61
v_cvt_pk_bf16_f32 v77, v62, v63
ds_write_b64 v5, v[76:77] offset:0
v_pk_mul_f32 v[64:65], v[64:65], v[40:41] op_sel_hi:[1,0]
v_pk_mul_f32 v[66:67], v[66:67], v[40:41] op_sel_hi:[1,0]
v_cvt_pk_bf16_f32 v78, v64, v65
v_cvt_pk_bf16_f32 v79, v66, v67
ds_write_b64 v5, v[78:79] offset:8
s_mov_b64 exec, s[46:47]
v_mov_b32 v41, -1
buffer_store_dword v41, v3, s[4:7], s58 offen sc1
s_mov_b64 exec, -1
ds_read_b128 v[60:63], v6 offset:22528
ds_read_b128 v[64:67], v6 offset:23552
v_mov_b64 v[24:25], 0
v_mov_b64 v[26:27], 0
v_mov_b64 v[28:29], 0
v_mov_b64 v[30:31], 0
v_mov_b32 v43, s31
s_waitcnt lgkmcnt(2)
s_barrier
ds_read_b128 v[68:71], v1 offset:0
ds_read_b128 v[72:75], v1 offset:1024
v_mov_b32 v79, s31
s_waitcnt lgkmcnt(1)
v_smfmac_f32_16x16x64_bf16 v[8:11], v[68:71], v[44:51], v0
s_waitcnt lgkmcnt(0)
ds_read_b128 v[44:47], v6 offset:24576
v_smfmac_f32_16x16x64_bf16 v[8:11], v[72:75], v[52:59], v0
ds_read_b128 v[48:51], v6 offset:25600
v_smfmac_f32_16x16x64_bf16 v[12:15], v[68:71], v[32:39], v0
ds_read_b128 v[52:55], v6 offset:28672
v_smfmac_f32_16x16x64_bf16 v[12:15], v[72:75], v[60:67], v0
ds_read_b128 v[56:59], v6 offset:29696
v_add_f32 v8, v8, v10
v_add_f32 v9, v9, v11
v_smfmac_f32_16x16x64_bf16 v[16:19], v[68:71], v[192:199], v0
ds_read_b128 v[32:35], v6 offset:26624
v_cvt_pk_bf16_f32 v40, v8, v9
v_smfmac_f32_16x16x64_bf16 v[16:19], v[72:75], v[200:207], v0
ds_read_b128 v[36:39], v6 offset:27648
v_add_f32 v12, v12, v14
v_add_f32 v13, v13, v15
v_smfmac_f32_16x16x64_bf16 v[20:23], v[68:71], v[208:215], v0
ds_read_b128 v[60:63], v6 offset:30720
v_cvt_pk_bf16_f32 v41, v12, v13
v_mov_b64 v[8:9], 0
v_smfmac_f32_16x16x64_bf16 v[20:23], v[72:75], v[216:223], v0
s_waitcnt lgkmcnt(5)
ds_read_b128 v[64:67], v6 offset:31744
v_add_f32 v16, v16, v18
v_add_f32 v17, v17, v19
v_cvt_pk_bf16_f32 v42, v16, v17
v_smfmac_f32_16x16x64_bf16 v[24:27], v[68:71], v[44:51], v0
s_waitcnt lgkmcnt(4)
ds_read_b128 v[44:47], v6 offset:32768
buffer_store_dwordx4 v[40:43], v2, s[4:7], s60 offen sc1
v_mov_b64 v[16:17], 0
v_mov_b64 v[10:11], 0
v_smfmac_f32_16x16x64_bf16 v[24:27], v[72:75], v[52:59], v0
s_waitcnt lgkmcnt(3)
ds_read_b128 v[48:51], v6 offset:33792
v_add_f32 v20, v20, v22
v_add_f32 v21, v21, v23
v_smfmac_f32_16x16x64_bf16 v[28:31], v[68:71], v[32:39], v0
s_waitcnt lgkmcnt(2)
ds_read_b128 v[52:55], v6 offset:34816
v_cvt_pk_bf16_f32 v76, v20, v21
v_mov_b64 v[18:19], 0
v_smfmac_f32_16x16x64_bf16 v[28:31], v[72:75], v[60:67], v0
ds_read_b128 v[56:59], v6 offset:35840
v_add_f32 v24, v24, v26
v_add_f32 v25, v25, v27
v_smfmac_f32_16x16x64_bf16 v[16:19], v[68:71], v[240:247], v0
v_cvt_pk_bf16_f32 v77, v24, v25
v_mov_b64 v[12:13], 0
v_smfmac_f32_16x16x64_bf16 v[16:19], v[72:75], v[248:255], v0
v_add_f32 v28, v28, v30
v_add_f32 v29, v29, v31
v_cvt_pk_bf16_f32 v78, v28, v29
v_smfmac_f32_16x16x64_bf16 v[8:11], v[68:71], v[224:231], v0
s_waitcnt lgkmcnt(2)
buffer_store_dwordx4 v[76:79], v2, s[4:7], s61 offen sc1
v_mov_b64 v[14:15], 0
v_smfmac_f32_16x16x64_bf16 v[8:11], v[72:75], v[44:51], v0
v_add_f32 v16, v16, v18
v_add_f32 v17, v17, v19
v_smfmac_f32_16x16x64_bf16 v[12:15], v[68:71], v[232:239], v0
s_waitcnt lgkmcnt(0)
s_add_u32 s43, s43, 4
s_add_u32 s37, s37, 1
v_cvt_pk_bf16_f32 v42, v16, v17
v_smfmac_f32_16x16x64_bf16 v[12:15], v[72:75], v[52:59], v0
s_add_u32 s38, s38, 16384
s_add_u32 s42, s42, 4096
v_add_f32 v8, v8, v10
v_add_f32 v9, v9, v11
v_cvt_pk_bf16_f32 v40, v8, v9
s_nop 2
v_pk_add_f32 v[12:13], v[12:13], v[14:15]
v_cvt_pk_bf16_f32 v41, v12, v13
buffer_store_dwordx4 v[40:43], v2, s[4:7], s62 offen sc1
v_and_b32 v33, 16, v1
v_bfe_u32 v32, v1, 5, 3
v_lshlrev_b32 v33, v33, s55
v_mov_b32 v63, 0
v_cmp_eq_u32 vcc, 0, v32
s_nop 1
v_cndmask_b32 v60, 0, v33, vcc
v_cmp_eq_u32 vcc, 1, v32
s_nop 1
v_cndmask_b32 v61, 0, v33, vcc
v_cmp_eq_u32 vcc, 2, v32
s_nop 1
v_cndmask_b32 v62, 0, v33, vcc
s_waitcnt vmcnt(2)
buffer_load_dwordx4 v[44:47], v1, s[4:7], s59 offen offset:0 sc1
buffer_load_dwordx4 v[48:51], v1, s[4:7], s59 offen offset:1024 sc1
buffer_load_dwordx4 v[52:55], v1, s[4:7], s59 offen offset:2048 sc1
buffer_load_dwordx4 v[56:59], v1, s[4:7], s59 offen offset:3072 sc1
s_waitcnt lgkmcnt(0)
s_mov_b32 s29, 0
Lpc51:
s_waitcnt vmcnt(3)
v_mfma_f32_16x16x32_bf16 v[64:67], v[44:47], v[60:63], 0
v_cmp_ne_u32 s[48:49], s31, v47
s_waitcnt vmcnt(2)
v_mfma_f32_16x16x32_bf16 v[64:67], v[48:51], v[60:63], v[64:67]
v_cmp_ne_u32 s[50:51], s31, v51
s_waitcnt vmcnt(1)
v_mfma_f32_16x16x32_bf16 v[64:67], v[52:55], v[60:63], v[64:67]
v_cmp_ne_u32 s[94:95], s31, v55
s_or_b64 s[68:69], s[48:49], s[50:51]
s_waitcnt vmcnt(0)
v_mfma_f32_16x16x32_bf16 v[64:67], v[56:59], v[60:63], v[64:67]
v_cmp_ne_u32 vcc, s31, v59
s_or_b64 s[68:69], s[68:69], s[94:95]
s_or_b64 s[68:69], s[68:69], vcc
s_cbranch_scc0 Lpd52
s_mov_b64 exec, s[48:49]
buffer_load_dwordx4 v[44:47], v1, s[4:7], s59 offen offset:0 sc1
s_mov_b64 exec, s[50:51]
buffer_load_dwordx4 v[48:51], v1, s[4:7], s59 offen offset:1024 sc1
s_mov_b64 exec, s[94:95]
buffer_load_dwordx4 v[52:55], v1, s[4:7], s59 offen offset:2048 sc1
s_mov_b64 exec, vcc
buffer_load_dwordx4 v[56:59], v1, s[4:7], s59 offen offset:3072 sc1
s_mov_b64 exec, -1
s_add_u32 s29, s29, 1
s_add_u32 s91, s91, 1
s_cmp_lt_u32 s29, s25
s_cbranch_scc1 Lpc51
s_mov_b32 s25, 0
s_waitcnt vmcnt(0)
Lpd52:
v_mov_b64 v[44:45], 0
v_mov_b64 v[46:47], 0
v_mov_b64 v[48:49], 0
v_mov_b64 v[50:51], 0
v_permlane32_swap_b32 v64, v66
v_permlane32_swap_b32 v65, v67
v_pk_add_f32 v[64:65], v[64:65], v[66:67]
v_cvt_pk_bf16_f32 v76, v64, v65
s_mov_b64 exec, s[46:47]
buffer_store_dword v76, v3, s[4:7], s57 offen sc1
s_mov_b64 exec, -1
v_mov_b64 v[52:53], 0
v_mov_b64 v[54:55], 0
v_mov_b64 v[56:57], 0
v_mov_b64 v[58:59], 0
ds_read_b128 v[60:63], v6 offset:0
ds_read_b128 v[64:67], v6 offset:1024
ds_read_b128 v[68:71], v6 offset:2048
ds_read_b128 v[72:75], v6 offset:3072
s_mov_b32 s26, s56
s_mov_b32 s56, s57
s_mov_b32 s57, s58
s_mov_b32 s58, s26
s_add_u32 s31, s31, 1
s_add_u32 s40, s56, 0
s_add_u32 s41, s38, 0
s_mov_b32 m0, 8192
s_nop 0
buffer_load_dwordx4 v1, s[4:7], s41 offen offset:0 sc1 lds
buffer_load_dwordx4 v1, s[4:7], s41 offen offset:1024 sc1 lds
buffer_load_dwordx4 v1, s[4:7], s41 offen offset:2048 sc1 lds
s_waitcnt vmcnt(3)
s_barrier
buffer_load_dwordx4 v[8:11], v1, s[4:7], s40 offen offset:0 sc1
buffer_load_dwordx4 v[12:15], v1, s[4:7], s40 offen offset:1024 sc1
buffer_load_dwordx4 v[16:19], v1, s[4:7], s40 offen offset:2048 sc1
s_branch CHf0_step
CHf0_end:
s_mov_b64 exec, s[46:47]
v_mov_b32 v40, -1
buffer_store_dword v40, v3, s[4:7], s58 offen sc1
s_mov_b64 exec, -1
s_waitcnt lgkmcnt(0) vmcnt(0)
s_barrier
s_waitcnt vmcnt(0)
s_barrier
s_mov_b32 s26, s56
s_mov_b32 s56, s57
s_mov_b32 s57, s58
s_mov_b32 s58, s26
s_add_u32 s36, s36, 1
s_cmp_lt_u32 s36, 2
s_cbranch_scc1 CHf0_layer
s_branch END
s_nop 7
CHf1_layer:
s_mov_b32 s37, 0
s_lshl_b32 s43, s52, 1
s_add_u32 s43, s43, s36
s_lshl_b32 s43, s43, 8
s_lshl_b32 s42, s36, 5
s_add_u32 s42, s42, s52
s_lshl_b32 s38, s42, 20
s_add_u32 s38, s38, 58722304
s_lshl_b32 s42, s42, 18
s_add_u32 s42, s42, 25165824
v_bfe_u32 v76, v1, 6, 2
v_bfe_u32 v77, v1, 4, 1
v_lshl_add_u32 v76, v76, 1, v77
v_mul_u32_u24 v76, 1152, v76
v_bfe_u32 v77, v1, 5, 1
v_lshl_add_u32 v76, v77, 4, v76
v_lshrrev_b32 v77, 8, v1
v_lshl_add_u32 v76, v77, 5, v76
buffer_load_dwordx4 v[16:19], v76, s[32:35], 0 offen offset:256
buffer_load_dwordx4 v[20:23], v76, s[32:35], 0 offen offset:384
buffer_load_dwordx4 v[24:27], v76, s[32:35], 0 offen offset:512
s_barrier
s_add_u32 s41, s38, 1024
s_mov_b32 m0, 11264
s_nop 0
buffer_load_dwordx4 v1, s[4:7], s41 offen offset:0 sc1 lds
buffer_load_dwordx4 v1, s[4:7], s41 offen offset:1024 sc1 lds
buffer_load_dwordx4 v1, s[4:7], s41 offen offset:2048 sc1 lds
s_add_u32 s40, s56, 3072
v_mov_b64 v[44:45], 0
v_mov_b64 v[46:47], 0
v_mov_b64 v[48:49], 0
v_mov_b64 v[50:51], 0
v_mov_b64 v[52:53], 0
v_mov_b64 v[54:55], 0
v_mov_b64 v[56:57], 0
v_mov_b64 v[58:59], 0
ds_read_b128 v[60:63], v6 offset:4096
ds_read_b128 v[64:67], v6 offset:5120
ds_read_b128 v[68:71], v6 offset:6144
ds_read_b128 v[72:75], v6 offset:7168
CHf1_step:
s_mov_b32 s29, 0
s_waitcnt vmcnt(0)
Lgc53:
v_max3_u32 v76, v20, v21, v22
v_max3_u32 v77, v24, v25, v26
v_max_u32 v76, v76, v23
v_max_u32 v77, v77, v27
v_cmp_eq_u32 s[94:95], -1, v76
v_cmp_eq_u32 vcc, -1, v77
s_or_b64 s[68:69], s[94:95], vcc
s_cbranch_scc0 Lgd54
s_mov_b64 exec, s[94:95]
buffer_load_dwordx4 v[20:23], v1, s[4:7], s40 offen offset:0 sc1
s_mov_b64 exec, vcc
buffer_load_dwordx4 v[24:27], v1, s[4:7], s40 offen offset:1024 sc1
s_mov_b64 exec, -1
s_add_u32 s29, s29, 1
s_add_u32 s90, s90, 1
s_cmp_lt_u32 s29, s25
s_waitcnt vmcnt(0)
s_cbranch_scc1 Lgc53
s_mov_b32 s25, 0
Lgd54:
ds_write_b128 v1, v[20:23] offset:2048
ds_write_b128 v1, v[24:27] offset:3072
s_cmp_lt_u32 s37, 63
s_cselect_b32 s40, 16384, 0
s_add_u32 s40, s40, s38
s_add_u32 s40, s40, 6144
v_lshlrev_b32 v7, 3, v1
s_add_u32 s41, s38, 8192
s_add_u32 s39, s56, 2048
s_cmp_eq_u32 s37, 0
s_waitcnt lgkmcnt(4)
v_smfmac_f32_16x16x64_bf16 v[44:47], v[20:23], v[60:67], v0
s_waitcnt lgkmcnt(2)
ds_read_b128 v[60:63], v6 offset:8192
v_smfmac_f32_16x16x64_bf16 v[48:51], v[20:23], v[68:75], v0
ds_read_b128 v[64:67], v6 offset:9216
v_smfmac_f32_16x16x64_bf16 v[52:55], v[20:23], a[128:135], v0
s_waitcnt lgkmcnt(2)
s_barrier
ds_read_b128 v[28:31], v1 offset:4096
v_smfmac_f32_16x16x64_bf16 v[56:59], v[20:23], a[136:143], v0
s_cbranch_scc1 CHf1_n8
buffer_load_dwordx4 v[16:19], v1, s[4:7], s39 offen sc1
CHf1_n8:
ds_read_b128 v[32:35], v1 offset:5120
v_smfmac_f32_16x16x64_bf16 v[52:55], v[24:27], a[144:151], v0
ds_read_b128 v[36:39], v1 offset:6144
buffer_load_dwordx4 v[68:71], v1, s[4:7], s41 offen offset:0 sc1
v_smfmac_f32_16x16x64_bf16 v[56:59], v[24:27], a[152:159], v0
ds_read_b128 v[40:43], v1 offset:7168
buffer_load_dwordx4 v[72:75], v1, s[4:7], s41 offen offset:1024 sc1
v_smfmac_f32_16x16x64_bf16 v[44:47], v[24:27], a[32:39], v0
ds_read_b128 v[8:11], v1 offset:0
v_smfmac_f32_16x16x64_bf16 v[48:51], v[24:27], a[40:47], v0
s_waitcnt lgkmcnt(4)
ds_read_b128 v[12:15], v1 offset:1024
v_smfmac_f32_16x16x64_bf16 v[44:47], v[28:31], v[60:67], v0
ds_read_b128 v[60:63], v6 offset:10240
ds_read_b128 v[64:67], v6 offset:11264
v_smfmac_f32_16x16x64_bf16 v[52:55], v[28:31], a[160:167], v0
v_smfmac_f32_16x16x64_bf16 v[56:59], v[28:31], a[168:175], v0
s_waitcnt lgkmcnt(6)
buffer_load_dword v7, v7, s[4:7], s40 offen sc1
v_smfmac_f32_16x16x64_bf16 v[52:55], v[32:35], a[176:183], v0
v_smfmac_f32_16x16x64_bf16 v[56:59], v[32:35], a[184:191], v0
s_waitcnt lgkmcnt(0)
v_smfmac_f32_16x16x64_bf16 v[48:51], v[28:31], v[60:67], v0
ds_read_b128 v[60:63], v6 offset:12288
ds_read_b128 v[64:67], v6 offset:13312
v_smfmac_f32_16x16x64_bf16 v[52:55], v[36:39], a[192:199], v0
s_barrier
v_smfmac_f32_16x16x64_bf16 v[56:59], v[36:39], a[200:207], v0
v_smfmac_f32_16x16x64_bf16 v[52:55], v[40:43], a[208:215], v0
v_smfmac_f32_16x16x64_bf16 v[56:59], v[40:43], a[216:223], v0
s_waitcnt lgkmcnt(0)
v_smfmac_f32_16x16x64_bf16 v[44:47], v[36:39], v[60:67], v0
ds_read_b128 v[60:63], v6 offset:14336
ds_read_b128 v[64:67], v6 offset:15360
v_smfmac_f32_16x16x64_bf16 v[52:55], v[8:11], a[80:87], v0
v_smfmac_f32_16x16x64_bf16 v[56:59], v[8:11], a[88:95], v0
v_smfmac_f32_16x16x64_bf16 v[52:55], v[12:15], a[96:103], v0
v_smfmac_f32_16x16x64_bf16 v[56:59], v[12:15], a[104:111], v0
s_waitcnt lgkmcnt(0)
v_smfmac_f32_16x16x64_bf16 v[48:51], v[36:39], v[60:67], v0
s_waitcnt vmcnt(3)
ds_read_b128 v[60:63], v6 offset:0
ds_read_b128 v[64:67], v6 offset:1024
v_smfmac_f32_16x16x64_bf16 v[52:55], v[16:19], a[112:119], v0
v_smfmac_f32_16x16x64_bf16 v[56:59], v[16:19], a[120:127], v0
v_smfmac_f32_16x16x64_bf16 v[44:47], v[32:35], a[48:55], v0
v_add_f32 v52, v52, v54
v_smfmac_f32_16x16x64_bf16 v[48:51], v[32:35], a[56:63], v0
s_waitcnt lgkmcnt(0)
v_add_f32 v56, v56, v58
v_smfmac_f32_16x16x64_bf16 v[44:47], v[8:11], v[60:67], v0
ds_read_b128 v[60:63], v6 offset:2048
ds_read_b128 v[64:67], v6 offset:3072
v_add_f32 v53, v53, v55
v_smfmac_f32_16x16x64_bf16 v[44:47], v[40:43], a[64:71], v0
v_add_f32 v57, v57, v59
v_smfmac_f32_16x16x64_bf16 v[48:51], v[40:43], a[72:79], v0
v_cvt_pk_bf16_f32 v78, v52, v56
v_smfmac_f32_16x16x64_bf16 v[44:47], v[12:15], a[0:7], v0
s_waitcnt lgkmcnt(0)
v_cvt_pk_bf16_f32 v79, v53, v57
v_smfmac_f32_16x16x64_bf16 v[48:51], v[8:11], v[60:67], v0
v_smfmac_f32_16x16x64_bf16 v[48:51], v[12:15], a[8:15], v0
ds_write2_b32 v4, v78, v79 offset0:0 offset1:4
v_mov_b64 v[60:61], 0
v_smfmac_f32_16x16x64_bf16 v[44:47], v[16:19], a[16:23], v0
v_mov_b64 v[62:63], 0
v_smfmac_f32_16x16x64_bf16 v[48:51], v[16:19], a[24:31], v0
v_mov_b64 v[64:65], 0
v_mov_b64 v[66:67], 0
v_smfmac_f32_16x16x64_bf16 v[60:63], v[8:11], a[224:231], v0
v_add_f32 v44, v44, v46
v_add_f32 v45, v45, v47
v_smfmac_f32_16x16x64_bf16 v[64:67], v[8:11], a[232:239], v0
v_add_f32 v48, v48, v50
v_add_f32 v49, v49, v51
v_smfmac_f32_16x16x64_bf16 v[60:63], v[12:15], a[240:247], v0
v_cvt_pk_bf16_f32 v76, v44, v48
v_cvt_pk_bf16_f32 v77, v45, v49
v_smfmac_f32_16x16x64_bf16 v[64:67], v[12:15], a[248:255], v0
ds_write2_b32 v4, v76, v77 offset0:8 offset1:12
v_smfmac_f32_16x16x64_bf16 v[60:63], v[16:19], v[80:87], v0
v_smfmac_f32_16x16x64_bf16 v[64:67], v[16:19], v[88:95], v0
s_waitcnt vmcnt(1)
v_smfmac_f32_16x16x64_bf16 v[60:63], v[20:23], v[96:103], v0
s_add_u32 s39, s42, 2048
v_smfmac_f32_16x16x64_bf16 v[64:67], v[20:23], v[104:111], v0
v_smfmac_f32_16x16x64_bf16 v[60:63], v[24:27], v[112:119], v0
v_smfmac_f32_16x16x64_bf16 v[64:67], v[24:27], v[120:127], v0
s_waitcnt lgkmcnt(0)
s_barrier
ds_read_b128 v[44:47], v1 offset:3072
v_smfmac_f32_16x16x64_bf16 v[60:63], v[28:31], v[128:135], v0
ds_read_b128 v[48:51], v1 offset:4096
v_smfmac_f32_16x16x64_bf16 v[64:67], v[28:31], v[136:143], v0
ds_read_b128 v[52:55], v1 offset:5120
v_smfmac_f32_16x16x64_bf16 v[60:63], v[32:35], v[144:151], v0
ds_read_b128 v[56:59], v1 offset:6144
v_smfmac_f32_16x16x64_bf16 v[64:67], v[32:35], v[152:159], v0
ds_read_b128 v[8:11], v1 offset:8192
v_smfmac_f32_16x16x64_bf16 v[60:63], v[36:39], v[160:167], v0
ds_read_b128 v[16:19], v1 offset:9216
v_smfmac_f32_16x16x64_bf16 v[64:67], v[36:39], v[168:175], v0
ds_read_b128 v[20:23], v1 offset:10240
v_smfmac_f32_16x16x64_bf16 v[60:63], v[40:43], v[176:183], v0
s_waitcnt lgkmcnt(3)
ds_read_b128 v[24:27], v1 offset:11264
v_smfmac_f32_16x16x64_bf16 v[64:67], v[40:43], v[184:191], v0
ds_read_b128 v[12:15], v1 offset:12288
v_mfma_f32_16x16x32_bf16 v[76:79], v[44:47], v[44:47], 0
ds_read_b128 v[28:31], v1 offset:13312
v_add_f32 v60, v60, v62
v_lshrrev_b32 v41, 1, v1
v_mfma_f32_16x16x32_bf16 v[76:79], v[48:51], v[48:51], v[76:79]
ds_read_b128 v[32:35], v1 offset:14336
v_add_f32 v61, v61, v63
v_mfma_f32_16x16x32_bf16 v[76:79], v[52:55], v[52:55], v[76:79]
s_waitcnt lgkmcnt(3)
ds_read_b128 v[36:39], v1 offset:15360
v_add_f32 v64, v64, v66
v_add_f32 v65, v65, v67
v_mfma_f32_16x16x32_bf16 v[76:79], v[56:59], v[56:59], v[76:79]
s_waitcnt lgkmcnt(3)
v_cvt_pk_bf16_f32 v42, v60, v61
v_cvt_pk_bf16_f32 v43, v64, v65
v_mfma_f32_16x16x32_bf16 v[8:11], v[8:11], v[44:47], 0
v_mfma_f32_16x16x32_bf16 v[8:11], v[16:19], v[48:51], v[8:11]
s_andn2_b64 exec, exec, s[44:45]
buffer_store_dwordx4 v[48:51], v5, s[4:7], s42 offen sc1
s_mov_b64 exec, -1
v_mfma_f32_16x16x32_bf16 v[8:11], v[20:23], v[52:55], v[8:11]
v_mfma_f32_16x16x32_bf16 v[8:11], v[24:27], v[56:59], v[8:11]
buffer_store_dwordx2 v[42:43], v41, s[4:7], s39 offen offset:512 sc1
v_mfma_f32_16x16x32_bf16 v[12:15], v[12:15], v[44:47], 0
s_waitcnt lgkmcnt(0)
v_mov_b32 v16, 0x3f803f80
v_mov_b32 v17, v16
v_mfma_f32_16x16x32_bf16 v[12:15], v[28:31], v[48:51], v[12:15]
v_mov_b64 v[18:19], v[16:17]
v_max3_f32 v40, v76, v77, v8
v_mfma_f32_16x16x32_bf16 v[12:15], v[32:35], v[52:55], v[12:15]
v_max3_f32 v40, v40, v9, v10
v_max_f32 v40, v40, v11
v_mfma_f32_16x16x32_bf16 v[12:15], v[36:39], v[56:59], v[12:15]
ds_read_b128 v[44:47], v6 offset:16384
ds_read_b128 v[48:51], v6 offset:17408
v_mov_b32 v21, 0
v_mov_b32 v22, 0
s_cmp_eq_u32 s37, 63
s_cbranch_scc1 CHf1_end
s_nop 1
v_max3_f32 v40, v40, v12, v13
v_max3_f32 v41, v40, v14, v15
v_max3_f32 v40, v40, v14, v15
ds_read_b128 v[52:55], v6 offset:20480
ds_read_b128 v[56:59], v6 offset:21504
v_permlane16_swap_b32 v40, v41
v_max_f32 v40, v40, v41
v_max_f32 v41, v40, v41
ds_read_b128 v[32:35], v6 offset:18432
ds_read_b128 v[36:39], v6 offset:19456
v_permlane32_swap_b32 v40, v41
v_max_f32 v40, v40, v41
v_mul_f32 v40, s30, v40
v_pk_fma_f32 v[76:77], v[76:77], s[30:31], v[40:41] op_sel_hi:[1,0,0] neg_lo:[0,0,1] neg_hi:[0,0,1]
v_pk_fma_f32 v[8:9], v[8:9], s[30:31], v[40:41] op_sel_hi:[1,0,0] neg_lo:[0,0,1] neg_hi:[0,0,1]
v_pk_fma_f32 v[10:11], v[10:11], s[30:31], v[40:41] op_sel_hi:[1,0,0] neg_lo:[0,0,1] neg_hi:[0,0,1]
v_pk_fma_f32 v[12:13], v[12:13], s[30:31], v[40:41] op_sel_hi:[1,0,0] neg_lo:[0,0,1] neg_hi:[0,0,1]
v_pk_fma_f32 v[14:15], v[14:15], s[30:31], v[40:41] op_sel_hi:[1,0,0] neg_lo:[0,0,1] neg_hi:[0,0,1]
v_exp_f32 v76, v76
v_exp_f32 v77, v77
v_exp_f32 v8, v8
v_cvt_pk_bf16_f32 v20, v76, v77
v_cvt_pk_bf16_f32 v23, v76, v77
v_exp_f32 v9, v9
v_exp_f32 v10, v10
v_mfma_f32_16x16x16_bf16 v[28:31], v[16:17], v[20:21], 0
v_exp_f32 v11, v11
v_mfma_f32_16x16x16_bf16 v[60:63], v[42:43], v[20:21], 0
v_exp_f32 v12, v12
v_mfma_f32_16x16x16_bf16 v[64:67], v[42:43], v[22:23], 0
v_exp_f32 v13, v13
v_exp_f32 v14, v14
v_exp_f32 v15, v15
v_cvt_pk_bf16_f32 v24, v8, v9
v_cvt_pk_bf16_f32 v25, v10, v11
v_cvt_pk_bf16_f32 v26, v12, v13
v_cvt_pk_bf16_f32 v27, v14, v15
v_mov_b64 v[8:9], 0
v_mov_b64 v[10:11], 0
v_mfma_f32_16x16x32_bf16 v[28:31], v[16:19], v[24:27], v[28:31]
v_mov_b64 v[12:13], 0
v_mov_b64 v[14:15], 0
v_mfma_f32_16x16x32_bf16 v[60:63], v[68:71], v[24:27], v[60:63]
v_mov_b64 v[20:21], 0
v_mov_b64 v[22:23], 0
v_mfma_f32_16x16x32_bf16 v[64:67], v[72:75], v[24:27], v[64:67]
v_rcp_f32 v40, v28
v_mov_b64 v[16:17], 0
v_mov_b64 v[18:19], 0
s_mov_b64 exec, s[44:45]
v_mul_f32 v60, v60, v40
v_mul_f32 v61, v61, v40
v_mul_f32 v62, v62, v40
v_mul_f32 v63, v63, v40
v_cvt_pk_bf16_f32 v76, v60, v61
v_cvt_pk_bf16_f32 v77, v62, v63
ds_write_b64 v5, v[76:77] offset:0
v_pk_mul_f32 v[64:65], v[64:65], v[40:41] op_sel_hi:[1,0]
v_pk_mul_f32 v[66:67], v[66:67], v[40:41] op_sel_hi:[1,0]
v_cvt_pk_bf16_f32 v78, v64, v65
v_cvt_pk_bf16_f32 v79, v66, v67
ds_write_b64 v5, v[78:79] offset:8
s_mov_b64 exec, s[46:47]
v_mov_b32 v41, -1
buffer_store_dword v41, v3, s[4:7], s58 offen sc1
s_mov_b64 exec, -1
ds_read_b128 v[60:63], v6 offset:22528
ds_read_b128 v[64:67], v6 offset:23552
v_mov_b64 v[24:25], 0
v_mov_b64 v[26:27], 0
v_mov_b64 v[28:29], 0
v_mov_b64 v[30:31], 0
v_mov_b32 v43, s31
s_waitcnt lgkmcnt(2)
s_barrier
ds_read_b128 v[68:71], v1 offset:0
ds_read_b128 v[72:75], v1 offset:1024
v_mov_b32 v79, s31
s_waitcnt lgkmcnt(1)
v_smfmac_f32_16x16x64_bf16 v[8:11], v[68:71], v[44:51], v0
s_waitcnt lgkmcnt(0)
ds_read_b128 v[44:47], v6 offset:24576
v_smfmac_f32_16x16x64_bf16 v[8:11], v[72:75], v[52:59], v0
ds_read_b128 v[48:51], v6 offset:25600
v_smfmac_f32_16x16x64_bf16 v[12:15], v[68:71], v[32:39], v0
ds_read_b128 v[52:55], v6 offset:28672
v_smfmac_f32_16x16x64_bf16 v[12:15], v[72:75], v[60:67], v0
ds_read_b128 v[56:59], v6 offset:29696
v_add_f32 v8, v8, v10
v_add_f32 v9, v9, v11
v_smfmac_f32_16x16x64_bf16 v[16:19], v[68:71], v[192:199], v0
ds_read_b128 v[32:35], v6 offset:26624
v_cvt_pk_bf16_f32 v40, v8, v9
v_smfmac_f32_16x16x64_bf16 v[16:19], v[72:75], v[200:207], v0
ds_read_b128 v[36:39], v6 offset:27648
v_add_f32 v12, v12, v14
v_add_f32 v13, v13, v15
v_smfmac_f32_16x16x64_bf16 v[20:23], v[68:71], v[208:215], v0
ds_read_b128 v[60:63], v6 offset:30720
v_cvt_pk_bf16_f32 v41, v12, v13
v_mov_b64 v[8:9], 0
v_smfmac_f32_16x16x64_bf16 v[20:23], v[72:75], v[216:223], v0
s_waitcnt lgkmcnt(5)
ds_read_b128 v[64:67], v6 offset:31744
v_add_f32 v16, v16, v18
v_add_f32 v17, v17, v19
v_cvt_pk_bf16_f32 v42, v16, v17
v_smfmac_f32_16x16x64_bf16 v[24:27], v[68:71], v[44:51], v0
s_waitcnt lgkmcnt(4)
ds_read_b128 v[44:47], v6 offset:32768
buffer_store_dwordx4 v[40:43], v2, s[4:7], s60 offen sc1
v_mov_b64 v[16:17], 0
v_mov_b64 v[10:11], 0
v_smfmac_f32_16x16x64_bf16 v[24:27], v[72:75], v[52:59], v0
s_waitcnt lgkmcnt(3)
ds_read_b128 v[48:51], v6 offset:33792
v_add_f32 v20, v20, v22
v_add_f32 v21, v21, v23
v_smfmac_f32_16x16x64_bf16 v[28:31], v[68:71], v[32:39], v0
s_waitcnt lgkmcnt(2)
ds_read_b128 v[52:55], v6 offset:34816
v_cvt_pk_bf16_f32 v76, v20, v21
v_mov_b64 v[18:19], 0
v_smfmac_f32_16x16x64_bf16 v[28:31], v[72:75], v[60:67], v0
ds_read_b128 v[56:59], v6 offset:35840
v_add_f32 v24, v24, v26
v_add_f32 v25, v25, v27
v_smfmac_f32_16x16x64_bf16 v[16:19], v[68:71], v[240:247], v0
v_cvt_pk_bf16_f32 v77, v24, v25
v_mov_b64 v[12:13], 0
v_smfmac_f32_16x16x64_bf16 v[16:19], v[72:75], v[248:255], v0
v_add_f32 v28, v28, v30
v_add_f32 v29, v29, v31
v_cvt_pk_bf16_f32 v78, v28, v29
v_smfmac_f32_16x16x64_bf16 v[8:11], v[68:71], v[224:231], v0
s_waitcnt lgkmcnt(2)
buffer_store_dwordx4 v[76:79], v2, s[4:7], s61 offen sc1
v_mov_b64 v[14:15], 0
v_smfmac_f32_16x16x64_bf16 v[8:11], v[72:75], v[44:51], v0
v_add_f32 v16, v16, v18
v_add_f32 v17, v17, v19
v_smfmac_f32_16x16x64_bf16 v[12:15], v[68:71], v[232:239], v0
s_waitcnt lgkmcnt(0)
s_add_u32 s43, s43, 4
s_add_u32 s37, s37, 1
v_cvt_pk_bf16_f32 v42, v16, v17
v_smfmac_f32_16x16x64_bf16 v[12:15], v[72:75], v[52:59], v0
s_add_u32 s38, s38, 16384
s_add_u32 s42, s42, 4096
v_add_f32 v8, v8, v10
v_add_f32 v9, v9, v11
v_cvt_pk_bf16_f32 v40, v8, v9
s_nop 2
v_pk_add_f32 v[12:13], v[12:13], v[14:15]
v_cvt_pk_bf16_f32 v41, v12, v13
buffer_store_dwordx4 v[40:43], v2, s[4:7], s62 offen sc1
v_and_b32 v33, 16, v1
v_bfe_u32 v32, v1, 5, 3
v_lshlrev_b32 v33, v33, s55
v_mov_b32 v63, 0
v_cmp_eq_u32 vcc, 0, v32
s_nop 1
v_cndmask_b32 v60, 0, v33, vcc
v_cmp_eq_u32 vcc, 1, v32
s_nop 1
v_cndmask_b32 v61, 0, v33, vcc
v_cmp_eq_u32 vcc, 2, v32
s_nop 1
v_cndmask_b32 v62, 0, v33, vcc
s_waitcnt vmcnt(0)
buffer_load_dwordx4 v[44:47], v1, s[4:7], s59 offen offset:0 sc1
buffer_load_dwordx4 v[48:51], v1, s[4:7], s59 offen offset:1024 sc1
buffer_load_dwordx4 v[52:55], v1, s[4:7], s59 offen offset:2048 sc1
buffer_load_dwordx4 v[56:59], v1, s[4:7], s59 offen offset:3072 sc1
s_waitcnt lgkmcnt(0)
s_mov_b32 s29, 0
Lpc55:
s_waitcnt vmcnt(3)
v_mfma_f32_16x16x32_bf16 v[64:67], v[44:47], v[60:63], 0
v_cmp_ne_u32 s[48:49], s31, v47
s_waitcnt vmcnt(2)
v_mfma_f32_16x16x32_bf16 v[64:67], v[48:51], v[60:63], v[64:67]
v_cmp_ne_u32 s[50:51], s31, v51
s_waitcnt vmcnt(1)
v_mfma_f32_16x16x32_bf16 v[64:67], v[52:55], v[60:63], v[64:67]
v_cmp_ne_u32 s[94:95], s31, v55
s_or_b64 s[68:69], s[48:49], s[50:51]
s_waitcnt vmcnt(0)
v_mfma_f32_16x16x32_bf16 v[64:67], v[56:59], v[60:63], v[64:67]
v_cmp_ne_u32 vcc, s31, v59
s_or_b64 s[68:69], s[68:69], s[94:95]
s_or_b64 s[68:69], s[68:69], vcc
s_cbranch_scc0 Lpd56
s_mov_b64 exec, s[48:49]
buffer_load_dwordx4 v[44:47], v1, s[4:7], s59 offen offset:0 sc1
s_mov_b64 exec, s[50:51]
buffer_load_dwordx4 v[48:51], v1, s[4:7], s59 offen offset:1024 sc1
s_mov_b64 exec, s[94:95]
buffer_load_dwordx4 v[52:55], v1, s[4:7], s59 offen offset:2048 sc1
s_mov_b64 exec, vcc
buffer_load_dwordx4 v[56:59], v1, s[4:7], s59 offen offset:3072 sc1
s_mov_b64 exec, -1
s_add_u32 s29, s29, 1
s_add_u32 s91, s91, 1
s_cmp_lt_u32 s29, s25
s_cbranch_scc1 Lpc55
s_mov_b32 s25, 0
s_waitcnt vmcnt(0)
Lpd56:
v_mov_b64 v[44:45], 0
v_mov_b64 v[46:47], 0
v_mov_b64 v[48:49], 0
v_mov_b64 v[50:51], 0
v_permlane32_swap_b32 v64, v66
v_permlane32_swap_b32 v65, v67
v_pk_add_f32 v[64:65], v[64:65], v[66:67]
v_cvt_pk_bf16_f32 v76, v64, v65
s_mov_b64 exec, s[46:47]
buffer_store_dword v76, v3, s[4:7], s57 offen sc1
s_mov_b64 exec, -1
v_mov_b64 v[52:53], 0
v_mov_b64 v[54:55], 0
v_mov_b64 v[56:57], 0
v_mov_b64 v[58:59], 0
ds_read_b128 v[60:63], v6 offset:4096
ds_read_b128 v[64:67], v6 offset:5120
ds_read_b128 v[68:71], v6 offset:6144
ds_read_b128 v[72:75], v6 offset:7168
s_mov_b32 s26, s56
s_mov_b32 s56, s57
s_mov_b32 s57, s58
s_mov_b32 s58, s26
s_add_u32 s31, s31, 1
s_add_u32 s40, s56, 3072
s_add_u32 s41, s38, 1024
s_mov_b32 m0, 11264
s_nop 0
buffer_load_dwordx4 v1, s[4:7], s41 offen offset:0 sc1 lds
buffer_load_dwordx4 v1, s[4:7], s41 offen offset:1024 sc1 lds
buffer_load_dwordx4 v1, s[4:7], s41 offen offset:2048 sc1 lds
s_waitcnt vmcnt(3)
s_barrier
buffer_load_dwordx4 v[20:23], v1, s[4:7], s40 offen offset:0 sc1
buffer_load_dwordx4 v[24:27], v1, s[4:7], s40 offen offset:1024 sc1
s_branch CHf1_step
CHf1_end:
s_mov_b64 exec, s[46:47]
v_mov_b32 v40, -1
buffer_store_dword v40, v3, s[4:7], s58 offen sc1
s_mov_b64 exec, -1
s_waitcnt lgkmcnt(0) vmcnt(0)
s_barrier
s_waitcnt vmcnt(0)
s_barrier
s_mov_b32 s26, s56
s_mov_b32 s56, s57
s_mov_b32 s57, s58
s_mov_b32 s58, s26
s_add_u32 s36, s36, 1
s_cmp_lt_u32 s36, 2
s_cbranch_scc1 CHf1_layer
s_branch END
s_nop 7
CHf2_layer:
s_mov_b32 s37, 0
s_lshl_b32 s43, s52, 1
s_add_u32 s43, s43, s36
s_lshl_b32 s43, s43, 8
s_lshl_b32 s42, s36, 5
s_add_u32 s42, s42, s52
s_lshl_b32 s38, s42, 20
s_add_u32 s38, s38, 58724352
s_lshl_b32 s42, s42, 18
s_add_u32 s42, s42, 25165824
v_bfe_u32 v76, v1, 6, 2
v_bfe_u32 v77, v1, 4, 1
v_lshl_add_u32 v76, v76, 1, v77
v_mul_u32_u24 v76, 1152, v76
v_bfe_u32 v77, v1, 5, 1
v_lshl_add_u32 v76, v77, 4, v76
v_lshrrev_b32 v77, 8, v1
v_lshl_add_u32 v76, v77, 5, v76
buffer_load_dwordx4 v[16:19], v76, s[32:35], 0 offen offset:256
buffer_load_dwordx4 v[28:31], v76, s[32:35], 0 offen offset:640
buffer_load_dwordx4 v[32:35], v76, s[32:35], 0 offen offset:768
s_barrier
s_add_u32 s41, s38, 2048
s_mov_b32 m0, 14336
s_nop 0
buffer_load_dwordx4 v1, s[4:7], s41 offen offset:0 sc1 lds
buffer_load_dwordx4 v1, s[4:7], s41 offen offset:1024 sc1 lds
s_add_u32 s40, s56, 5120
v_mov_b64 v[44:45], 0
v_mov_b64 v[46:47], 0
v_mov_b64 v[48:49], 0
v_mov_b64 v[50:51], 0
v_mov_b64 v[52:53], 0
v_mov_b64 v[54:55], 0
v_mov_b64 v[56:57], 0
v_mov_b64 v[58:59], 0
ds_read_b128 v[60:63], v6 offset:8192
ds_read_b128 v[64:67], v6 offset:9216
ds_read_b128 v[68:71], v6 offset:10240
ds_read_b128 v[72:75], v6 offset:11264
CHf2_step:
s_mov_b32 s29, 0
s_waitcnt vmcnt(0)
Lgc57:
v_max3_u32 v76, v28, v29, v30
v_max3_u32 v77, v32, v33, v34
v_max_u32 v76, v76, v31
v_max_u32 v77, v77, v35
v_cmp_eq_u32 s[94:95], -1, v76
v_cmp_eq_u32 vcc, -1, v77
s_or_b64 s[68:69], s[94:95], vcc
s_cbranch_scc0 Lgd58
s_mov_b64 exec, s[94:95]
buffer_load_dwordx4 v[28:31], v1, s[4:7], s40 offen offset:0 sc1
s_mov_b64 exec, vcc
buffer_load_dwordx4 v[32:35], v1, s[4:7], s40 offen offset:1024 sc1
s_mov_b64 exec, -1
s_add_u32 s29, s29, 1
s_add_u32 s90, s90, 1
s_cmp_lt_u32 s29, s25
s_waitcnt vmcnt(0)
s_cbranch_scc1 Lgc57
s_mov_b32 s25, 0
Lgd58:
ds_write_b128 v1, v[28:31] offset:4096
ds_write_b128 v1, v[32:35] offset:5120
s_add_u32 s41, s38, 8192
s_add_u32 s39, s56, 2048
s_cmp_eq_u32 s37, 0
s_waitcnt lgkmcnt(4)
v_smfmac_f32_16x16x64_bf16 v[44:47], v[28:31], v[60:67], v0
s_waitcnt lgkmcnt(2)
ds_read_b128 v[60:63], v6 offset:12288
v_smfmac_f32_16x16x64_bf16 v[48:51], v[28:31], v[68:75], v0
ds_read_b128 v[64:67], v6 offset:13312
v_smfmac_f32_16x16x64_bf16 v[52:55], v[28:31], a[160:167], v0
s_waitcnt lgkmcnt(2)
s_barrier
ds_read_b128 v[36:39], v1 offset:6144
v_smfmac_f32_16x16x64_bf16 v[56:59], v[28:31], a[168:175], v0
s_cbranch_scc1 CHf2_n8
buffer_load_dwordx4 v[16:19], v1, s[4:7], s39 offen sc1
CHf2_n8:
ds_read_b128 v[40:43], v1 offset:7168
v_smfmac_f32_16x16x64_bf16 v[52:55], v[32:35], a[176:183], v0
ds_read_b128 v[8:11], v1 offset:0
buffer_load_dwordx4 v[68:71], v1, s[4:7], s41 offen offset:0 sc1
v_smfmac_f32_16x16x64_bf16 v[56:59], v[32:35], a[184:191], v0
ds_read_b128 v[12:15], v1 offset:1024
buffer_load_dwordx4 v[72:75], v1, s[4:7], s41 offen offset:1024 sc1
v_smfmac_f32_16x16x64_bf16 v[44:47], v[32:35], a[48:55], v0
ds_read_b128 v[20:23], v1 offset:2048
v_smfmac_f32_16x16x64_bf16 v[48:51], v[32:35], a[56:63], v0
s_waitcnt lgkmcnt(4)
ds_read_b128 v[24:27], v1 offset:3072
v_smfmac_f32_16x16x64_bf16 v[44:47], v[36:39], v[60:67], v0
ds_read_b128 v[60:63], v6 offset:14336
ds_read_b128 v[64:67], v6 offset:15360
v_smfmac_f32_16x16x64_bf16 v[52:55], v[36:39], a[192:199], v0
v_smfmac_f32_16x16x64_bf16 v[56:59], v[36:39], a[200:207], v0
s_waitcnt lgkmcnt(6)
v_smfmac_f32_16x16x64_bf16 v[52:55], v[40:43], a[208:215], v0
v_smfmac_f32_16x16x64_bf16 v[56:59], v[40:43], a[216:223], v0
s_waitcnt lgkmcnt(0)
v_smfmac_f32_16x16x64_bf16 v[48:51], v[36:39], v[60:67], v0
ds_read_b128 v[60:63], v6 offset:0
ds_read_b128 v[64:67], v6 offset:1024
v_smfmac_f32_16x16x64_bf16 v[52:55], v[8:11], a[80:87], v0
s_barrier
v_smfmac_f32_16x16x64_bf16 v[56:59], v[8:11], a[88:95], v0
v_smfmac_f32_16x16x64_bf16 v[52:55], v[12:15], a[96:103], v0
v_smfmac_f32_16x16x64_bf16 v[56:59], v[12:15], a[104:111], v0
s_waitcnt lgkmcnt(0)
v_smfmac_f32_16x16x64_bf16 v[44:47], v[8:11], v[60:67], v0
ds_read_b128 v[60:63], v6 offset:2048
ds_read_b128 v[64:67], v6 offset:3072
v_smfmac_f32_16x16x64_bf16 v[52:55], v[20:23], a[128:135], v0
v_smfmac_f32_16x16x64_bf16 v[56:59], v[20:23], a[136:143], v0
v_smfmac_f32_16x16x64_bf16 v[52:55], v[24:27], a[144:151], v0
v_smfmac_f32_16x16x64_bf16 v[56:59], v[24:27], a[152:159], v0
s_waitcnt lgkmcnt(0)
v_smfmac_f32_16x16x64_bf16 v[48:51], v[8:11], v[60:67], v0
s_waitcnt vmcnt(2)
ds_read_b128 v[60:63], v6 offset:4096
ds_read_b128 v[64:67], v6 offset:5120
v_smfmac_f32_16x16x64_bf16 v[52:55], v[16:19], a[112:119], v0
v_smfmac_f32_16x16x64_bf16 v[56:59], v[16:19], a[120:127], v0
v_smfmac_f32_16x16x64_bf16 v[44:47], v[40:43], a[64:71], v0
v_add_f32 v52, v52, v54
v_smfmac_f32_16x16x64_bf16 v[48:51], v[40:43], a[72:79], v0
s_waitcnt lgkmcnt(0)
v_add_f32 v56, v56, v58
v_smfmac_f32_16x16x64_bf16 v[44:47], v[20:23], v[60:67], v0
ds_read_b128 v[60:63], v6 offset:6144
ds_read_b128 v[64:67], v6 offset:7168
v_add_f32 v53, v53, v55
v_smfmac_f32_16x16x64_bf16 v[44:47], v[12:15], a[0:7], v0
v_add_f32 v57, v57, v59
v_smfmac_f32_16x16x64_bf16 v[48:51], v[12:15], a[8:15], v0
v_cvt_pk_bf16_f32 v78, v52, v56
v_smfmac_f32_16x16x64_bf16 v[44:47], v[24:27], a[32:39], v0
s_waitcnt lgkmcnt(0)
v_cvt_pk_bf16_f32 v79, v53, v57
v_smfmac_f32_16x16x64_bf16 v[48:51], v[20:23], v[60:67], v0
v_smfmac_f32_16x16x64_bf16 v[48:51], v[24:27], a[40:47], v0
ds_write2_b32 v4, v78, v79 offset0:0 offset1:4
v_mov_b64 v[60:61], 0
v_smfmac_f32_16x16x64_bf16 v[44:47], v[16:19], a[16:23], v0
v_mov_b64 v[62:63], 0
v_smfmac_f32_16x16x64_bf16 v[48:51], v[16:19], a[24:31], v0
v_mov_b64 v[64:65], 0
v_mov_b64 v[66:67], 0
v_smfmac_f32_16x16x64_bf16 v[60:63], v[8:11], a[224:231], v0
v_add_f32 v44, v44, v46
v_add_f32 v45, v45, v47
v_smfmac_f32_16x16x64_bf16 v[64:67], v[8:11], a[232:239], v0
v_add_f32 v48, v48, v50
v_add_f32 v49, v49, v51
v_smfmac_f32_16x16x64_bf16 v[60:63], v[12:15], a[240:247], v0
v_cvt_pk_bf16_f32 v76, v44, v48
v_cvt_pk_bf16_f32 v77, v45, v49
v_smfmac_f32_16x16x64_bf16 v[64:67], v[12:15], a[248:255], v0
ds_write2_b32 v4, v76, v77 offset0:8 offset1:12
v_smfmac_f32_16x16x64_bf16 v[60:63], v[16:19], v[80:87], v0
v_smfmac_f32_16x16x64_bf16 v[64:67], v[16:19], v[88:95], v0
s_waitcnt vmcnt(0)
v_smfmac_f32_16x16x64_bf16 v[60:63], v[20:23], v[96:103], v0
s_add_u32 s39, s42, 2048
v_smfmac_f32_16x16x64_bf16 v[64:67], v[20:23], v[104:111], v0
v_smfmac_f32_16x16x64_bf16 v[60:63], v[24:27], v[112:119], v0
v_smfmac_f32_16x16x64_bf16 v[64:67], v[24:27], v[120:127], v0
s_waitcnt lgkmcnt(0)
s_barrier
ds_read_b128 v[44:47], v1 offset:3072
v_smfmac_f32_16x16x64_bf16 v[60:63], v[28:31], v[128:135], v0
ds_read_b128 v[48:51], v1 offset:4096
v_smfmac_f32_16x16x64_bf16 v[64:67], v[28:31], v[136:143], v0
ds_read_b128 v[52:55], v1 offset:5120
v_smfmac_f32_16x16x64_bf16 v[60:63], v[32:35], v[144:151], v0
ds_read_b128 v[56:59], v1 offset:6144
v_smfmac_f32_16x16x64_bf16 v[64:67], v[32:35], v[152:159], v0
ds_read_b128 v[8:11], v1 offset:8192
v_smfmac_f32_16x16x64_bf16 v[60:63], v[36:39], v[160:167], v0
ds_read_b128 v[16:19], v1 offset:9216
v_smfmac_f32_16x16x64_bf16 v[64:67], v[36:39], v[168:175], v0
ds_read_b128 v[20:23], v1 offset:10240
v_smfmac_f32_16x16x64_bf16 v[60:63], v[40:43], v[176:183], v0
s_waitcnt lgkmcnt(3)
ds_read_b128 v[24:27], v1 offset:11264
v_smfmac_f32_16x16x64_bf16 v[64:67], v[40:43], v[184:191], v0
ds_read_b128 v[12:15], v1 offset:12288
v_mfma_f32_16x16x32_bf16 v[76:79], v[44:47], v[44:47], 0
ds_read_b128 v[28:31], v1 offset:13312
v_add_f32 v60, v60, v62
v_lshrrev_b32 v41, 1, v1
v_mfma_f32_16x16x32_bf16 v[76:79], v[48:51], v[48:51], v[76:79]
ds_read_b128 v[32:35], v1 offset:14336
v_add_f32 v61, v61, v63
v_mfma_f32_16x16x32_bf16 v[76:79], v[52:55], v[52:55], v[76:79]
s_waitcnt lgkmcnt(3)
ds_read_b128 v[36:39], v1 offset:15360
v_add_f32 v64, v64, v66
v_add_f32 v65, v65, v67
v_mfma_f32_16x16x32_bf16 v[76:79], v[56:59], v[56:59], v[76:79]
s_waitcnt lgkmcnt(3)
v_cvt_pk_bf16_f32 v42, v60, v61
v_cvt_pk_bf16_f32 v43, v64, v65
v_mfma_f32_16x16x32_bf16 v[8:11], v[8:11], v[44:47], 0
buffer_store_dwordx2 v[42:43], v41, s[4:7], s39 offen offset:1024 sc1
v_mfma_f32_16x16x32_bf16 v[8:11], v[16:19], v[48:51], v[8:11]
v_mfma_f32_16x16x32_bf16 v[8:11], v[20:23], v[52:55], v[8:11]
s_andn2_b64 exec, exec, s[44:45]
buffer_store_dwordx4 v[52:55], v5, s[4:7], s42 offen sc1
s_mov_b64 exec, -1
v_mfma_f32_16x16x32_bf16 v[8:11], v[24:27], v[56:59], v[8:11]
v_mfma_f32_16x16x32_bf16 v[12:15], v[12:15], v[44:47], 0
s_waitcnt lgkmcnt(0)
v_mov_b32 v16, 0x3f803f80
v_mov_b32 v17, v16
v_mfma_f32_16x16x32_bf16 v[12:15], v[28:31], v[48:51], v[12:15]
v_mov_b64 v[18:19], v[16:17]
v_max3_f32 v40, v76, v77, v8
v_mfma_f32_16x16x32_bf16 v[12:15], v[32:35], v[52:55], v[12:15]
v_max3_f32 v40, v40, v9, v10
v_max_f32 v40, v40, v11
v_mfma_f32_16x16x32_bf16 v[12:15], v[36:39], v[56:59], v[12:15]
ds_read_b128 v[44:47], v6 offset:16384
ds_read_b128 v[48:51], v6 offset:17408
v_mov_b32 v21, 0
v_mov_b32 v22, 0
s_cmp_eq_u32 s37, 63
s_cbranch_scc1 CHf2_end
s_nop 1
v_max3_f32 v40, v40, v12, v13
v_max3_f32 v41, v40, v14, v15
v_max3_f32 v40, v40, v14, v15
ds_read_b128 v[52:55], v6 offset:20480
ds_read_b128 v[56:59], v6 offset:21504
v_permlane16_swap_b32 v40, v41
v_max_f32 v40, v40, v41
v_max_f32 v41, v40, v41
ds_read_b128 v[32:35], v6 offset:18432
ds_read_b128 v[36:39], v6 offset:19456
v_permlane32_swap_b32 v40, v41
v_max_f32 v40, v40, v41
v_mul_f32 v40, s30, v40
v_pk_fma_f32 v[76:77], v[76:77], s[30:31], v[40:41] op_sel_hi:[1,0,0] neg_lo:[0,0,1] neg_hi:[0,0,1]
v_pk_fma_f32 v[8:9], v[8:9], s[30:31], v[40:41] op_sel_hi:[1,0,0] neg_lo:[0,0,1] neg_hi:[0,0,1]
v_pk_fma_f32 v[10:11], v[10:11], s[30:31], v[40:41] op_sel_hi:[1,0,0] neg_lo:[0,0,1] neg_hi:[0,0,1]
v_pk_fma_f32 v[12:13], v[12:13], s[30:31], v[40:41] op_sel_hi:[1,0,0] neg_lo:[0,0,1] neg_hi:[0,0,1]
v_pk_fma_f32 v[14:15], v[14:15], s[30:31], v[40:41] op_sel_hi:[1,0,0] neg_lo:[0,0,1] neg_hi:[0,0,1]
v_exp_f32 v76, v76
v_exp_f32 v77, v77
v_exp_f32 v8, v8
v_cvt_pk_bf16_f32 v20, v76, v77
v_cvt_pk_bf16_f32 v23, v76, v77
v_exp_f32 v9, v9
v_exp_f32 v10, v10
v_mfma_f32_16x16x16_bf16 v[28:31], v[16:17], v[20:21], 0
v_exp_f32 v11, v11
v_mfma_f32_16x16x16_bf16 v[60:63], v[42:43], v[20:21], 0
v_exp_f32 v12, v12
v_mfma_f32_16x16x16_bf16 v[64:67], v[42:43], v[22:23], 0
v_exp_f32 v13, v13
v_exp_f32 v14, v14
v_exp_f32 v15, v15
v_cvt_pk_bf16_f32 v24, v8, v9
v_cvt_pk_bf16_f32 v25, v10, v11
v_cvt_pk_bf16_f32 v26, v12, v13
v_cvt_pk_bf16_f32 v27, v14, v15
v_mov_b64 v[8:9], 0
v_mov_b64 v[10:11], 0
v_mfma_f32_16x16x32_bf16 v[28:31], v[16:19], v[24:27], v[28:31]
v_mov_b64 v[12:13], 0
v_mov_b64 v[14:15], 0
v_mfma_f32_16x16x32_bf16 v[60:63], v[68:71], v[24:27], v[60:63]
v_mov_b64 v[20:21], 0
v_mov_b64 v[22:23], 0
v_mfma_f32_16x16x32_bf16 v[64:67], v[72:75], v[24:27], v[64:67]
v_rcp_f32 v40, v28
v_mov_b64 v[16:17], 0
v_mov_b64 v[18:19], 0
s_mov_b64 exec, s[44:45]
v_mul_f32 v60, v60, v40
v_mul_f32 v61, v61, v40
v_mul_f32 v62, v62, v40
v_mul_f32 v63, v63, v40
v_cvt_pk_bf16_f32 v76, v60, v61
v_cvt_pk_bf16_f32 v77, v62, v63
ds_write_b64 v5, v[76:77] offset:0
v_pk_mul_f32 v[64:65], v[64:65], v[40:41] op_sel_hi:[1,0]
v_pk_mul_f32 v[66:67], v[66:67], v[40:41] op_sel_hi:[1,0]
v_cvt_pk_bf16_f32 v78, v64, v65
v_cvt_pk_bf16_f32 v79, v66, v67
ds_write_b64 v5, v[78:79] offset:8
s_mov_b64 exec, s[46:47]
v_mov_b32 v41, -1
buffer_store_dword v41, v3, s[4:7], s58 offen sc1
s_mov_b64 exec, -1
ds_read_b128 v[60:63], v6 offset:22528
ds_read_b128 v[64:67], v6 offset:23552
v_mov_b64 v[24:25], 0
v_mov_b64 v[26:27], 0
v_mov_b64 v[28:29], 0
v_mov_b64 v[30:31], 0
v_mov_b32 v43, s31
s_waitcnt lgkmcnt(2)
s_barrier
ds_read_b128 v[68:71], v1 offset:0
ds_read_b128 v[72:75], v1 offset:1024
v_mov_b32 v79, s31
s_waitcnt lgkmcnt(1)
v_smfmac_f32_16x16x64_bf16 v[8:11], v[68:71], v[44:51], v0
s_waitcnt lgkmcnt(0)
ds_read_b128 v[44:47], v6 offset:24576
v_smfmac_f32_16x16x64_bf16 v[8:11], v[72:75], v[52:59], v0
ds_read_b128 v[48:51], v6 offset:25600
v_smfmac_f32_16x16x64_bf16 v[12:15], v[68:71], v[32:39], v0
ds_read_b128 v[52:55], v6 offset:28672
v_smfmac_f32_16x16x64_bf16 v[12:15], v[72:75], v[60:67], v0
ds_read_b128 v[56:59], v6 offset:29696
v_add_f32 v8, v8, v10
v_add_f32 v9, v9, v11
v_smfmac_f32_16x16x64_bf16 v[16:19], v[68:71], v[192:199], v0
ds_read_b128 v[32:35], v6 offset:26624
v_cvt_pk_bf16_f32 v40, v8, v9
v_smfmac_f32_16x16x64_bf16 v[16:19], v[72:75], v[200:207], v0
ds_read_b128 v[36:39], v6 offset:27648
v_add_f32 v12, v12, v14
v_add_f32 v13, v13, v15
v_smfmac_f32_16x16x64_bf16 v[20:23], v[68:71], v[208:215], v0
ds_read_b128 v[60:63], v6 offset:30720
v_cvt_pk_bf16_f32 v41, v12, v13
v_mov_b64 v[8:9], 0
v_smfmac_f32_16x16x64_bf16 v[20:23], v[72:75], v[216:223], v0
s_waitcnt lgkmcnt(5)
ds_read_b128 v[64:67], v6 offset:31744
v_add_f32 v16, v16, v18
v_add_f32 v17, v17, v19
v_cvt_pk_bf16_f32 v42, v16, v17
v_smfmac_f32_16x16x64_bf16 v[24:27], v[68:71], v[44:51], v0
s_waitcnt lgkmcnt(4)
ds_read_b128 v[44:47], v6 offset:32768
buffer_store_dwordx4 v[40:43], v2, s[4:7], s60 offen sc1
v_mov_b64 v[16:17], 0
v_mov_b64 v[10:11], 0
v_smfmac_f32_16x16x64_bf16 v[24:27], v[72:75], v[52:59], v0
s_waitcnt lgkmcnt(3)
ds_read_b128 v[48:51], v6 offset:33792
v_add_f32 v20, v20, v22
v_add_f32 v21, v21, v23
v_smfmac_f32_16x16x64_bf16 v[28:31], v[68:71], v[32:39], v0
s_waitcnt lgkmcnt(2)
ds_read_b128 v[52:55], v6 offset:34816
v_cvt_pk_bf16_f32 v76, v20, v21
v_mov_b64 v[18:19], 0
v_smfmac_f32_16x16x64_bf16 v[28:31], v[72:75], v[60:67], v0
ds_read_b128 v[56:59], v6 offset:35840
v_add_f32 v24, v24, v26
v_add_f32 v25, v25, v27
v_smfmac_f32_16x16x64_bf16 v[16:19], v[68:71], v[240:247], v0
v_cvt_pk_bf16_f32 v77, v24, v25
v_mov_b64 v[12:13], 0
v_smfmac_f32_16x16x64_bf16 v[16:19], v[72:75], v[248:255], v0
v_add_f32 v28, v28, v30
v_add_f32 v29, v29, v31
v_cvt_pk_bf16_f32 v78, v28, v29
v_smfmac_f32_16x16x64_bf16 v[8:11], v[68:71], v[224:231], v0
s_waitcnt lgkmcnt(2)
buffer_store_dwordx4 v[76:79], v2, s[4:7], s61 offen sc1
v_mov_b64 v[14:15], 0
v_smfmac_f32_16x16x64_bf16 v[8:11], v[72:75], v[44:51], v0
v_add_f32 v16, v16, v18
v_add_f32 v17, v17, v19
v_smfmac_f32_16x16x64_bf16 v[12:15], v[68:71], v[232:239], v0
s_waitcnt lgkmcnt(0)
s_add_u32 s43, s43, 4
s_add_u32 s37, s37, 1
v_cvt_pk_bf16_f32 v42, v16, v17
v_smfmac_f32_16x16x64_bf16 v[12:15], v[72:75], v[52:59], v0
s_add_u32 s38, s38, 16384
s_add_u32 s42, s42, 4096
v_add_f32 v8, v8, v10
v_add_f32 v9, v9, v11
v_cvt_pk_bf16_f32 v40, v8, v9
s_nop 2
v_pk_add_f32 v[12:13], v[12:13], v[14:15]
v_cvt_pk_bf16_f32 v41, v12, v13
buffer_store_dwordx4 v[40:43], v2, s[4:7], s62 offen sc1
v_and_b32 v33, 16, v1
v_bfe_u32 v32, v1, 5, 3
v_lshlrev_b32 v33, v33, s55
v_mov_b32 v63, 0
v_cmp_eq_u32 vcc, 0, v32
s_nop 1
v_cndmask_b32 v60, 0, v33, vcc
v_cmp_eq_u32 vcc, 1, v32
s_nop 1
v_cndmask_b32 v61, 0, v33, vcc
v_cmp_eq_u32 vcc, 2, v32
s_nop 1
v_cndmask_b32 v62, 0, v33, vcc
s_waitcnt vmcnt(0)
buffer_load_dwordx4 v[44:47], v1, s[4:7], s59 offen offset:0 sc1
buffer_load_dwordx4 v[48:51], v1, s[4:7], s59 offen offset:1024 sc1
buffer_load_dwordx4 v[52:55], v1, s[4:7], s59 offen offset:2048 sc1
buffer_load_dwordx4 v[56:59], v1, s[4:7], s59 offen offset:3072 sc1
s_waitcnt lgkmcnt(0)
s_mov_b32 s29, 0
Lpc59:
s_waitcnt vmcnt(3)
v_mfma_f32_16x16x32_bf16 v[64:67], v[44:47], v[60:63], 0
v_cmp_ne_u32 s[48:49], s31, v47
s_waitcnt vmcnt(2)
v_mfma_f32_16x16x32_bf16 v[64:67], v[48:51], v[60:63], v[64:67]
v_cmp_ne_u32 s[50:51], s31, v51
s_waitcnt vmcnt(1)
v_mfma_f32_16x16x32_bf16 v[64:67], v[52:55], v[60:63], v[64:67]
v_cmp_ne_u32 s[94:95], s31, v55
s_or_b64 s[68:69], s[48:49], s[50:51]
s_waitcnt vmcnt(0)
v_mfma_f32_16x16x32_bf16 v[64:67], v[56:59], v[60:63], v[64:67]
v_cmp_ne_u32 vcc, s31, v59
s_or_b64 s[68:69], s[68:69], s[94:95]
s_or_b64 s[68:69], s[68:69], vcc
s_cbranch_scc0 Lpd60
s_mov_b64 exec, s[48:49]
buffer_load_dwordx4 v[44:47], v1, s[4:7], s59 offen offset:0 sc1
s_mov_b64 exec, s[50:51]
buffer_load_dwordx4 v[48:51], v1, s[4:7], s59 offen offset:1024 sc1
s_mov_b64 exec, s[94:95]
buffer_load_dwordx4 v[52:55], v1, s[4:7], s59 offen offset:2048 sc1
s_mov_b64 exec, vcc
buffer_load_dwordx4 v[56:59], v1, s[4:7], s59 offen offset:3072 sc1
s_mov_b64 exec, -1
s_add_u32 s29, s29, 1
s_add_u32 s91, s91, 1
s_cmp_lt_u32 s29, s25
s_cbranch_scc1 Lpc59
s_mov_b32 s25, 0
s_waitcnt vmcnt(0)
Lpd60:
v_mov_b64 v[44:45], 0
v_mov_b64 v[46:47], 0
v_mov_b64 v[48:49], 0
v_mov_b64 v[50:51], 0
v_permlane32_swap_b32 v64, v66
v_permlane32_swap_b32 v65, v67
v_pk_add_f32 v[64:65], v[64:65], v[66:67]
v_cvt_pk_bf16_f32 v76, v64, v65
s_mov_b64 exec, s[46:47]
buffer_store_dword v76, v3, s[4:7], s57 offen sc1
s_mov_b64 exec, -1
v_mov_b64 v[52:53], 0
v_mov_b64 v[54:55], 0
v_mov_b64 v[56:57], 0
v_mov_b64 v[58:59], 0
ds_read_b128 v[60:63], v6 offset:8192
ds_read_b128 v[64:67], v6 offset:9216
ds_read_b128 v[68:71], v6 offset:10240
ds_read_b128 v[72:75], v6 offset:11264
s_mov_b32 s26, s56
s_mov_b32 s56, s57
s_mov_b32 s57, s58
s_mov_b32 s58, s26
s_add_u32 s31, s31, 1
s_add_u32 s40, s56, 5120
s_add_u32 s41, s38, 2048
s_mov_b32 m0, 14336
s_nop 0
buffer_load_dwordx4 v1, s[4:7], s41 offen offset:0 sc1 lds
buffer_load_dwordx4 v1, s[4:7], s41 offen offset:1024 sc1 lds
s_waitcnt vmcnt(2)
s_barrier
buffer_load_dwordx4 v[28:31], v1, s[4:7], s40 offen offset:0 sc1
buffer_load_dwordx4 v[32:35], v1, s[4:7], s40 offen offset:1024 sc1
s_branch CHf2_step
CHf2_end:
s_mov_b64 exec, s[46:47]
v_mov_b32 v40, -1
buffer_store_dword v40, v3, s[4:7], s58 offen sc1
s_mov_b64 exec, -1
s_waitcnt lgkmcnt(0) vmcnt(0)
s_barrier
s_waitcnt vmcnt(0)
s_barrier
s_mov_b32 s26, s56
s_mov_b32 s56, s57
s_mov_b32 s57, s58
s_mov_b32 s58, s26
s_add_u32 s36, s36, 1
s_cmp_lt_u32 s36, 2
s_cbranch_scc1 CHf2_layer
s_branch END
s_nop 7
CHf3_layer:
s_mov_b32 s37, 0
s_lshl_b32 s43, s52, 1
s_add_u32 s43, s43, s36
s_lshl_b32 s43, s43, 8
s_lshl_b32 s42, s36, 5
s_add_u32 s42, s42, s52
s_lshl_b32 s38, s42, 20
s_add_u32 s38, s38, 58726400
s_lshl_b32 s42, s42, 18
s_add_u32 s42, s42, 25165824
v_bfe_u32 v76, v1, 4, 1
v_lshlrev_b32 v76, 2, v76
s_mov_b32 s29, 0
Lwf61:
buffer_load_dword v77, v76, s[4:7], s43 offen sc1
s_add_u32 s29, s29, 1
s_waitcnt vmcnt(0)
v_cmp_eq_u32 vcc, 0, v77
s_cbranch_vccz Lwd62
s_sleep 1
s_cmp_lt_u32 s29, s25
s_cbranch_scc1 Lwf61
s_mov_b32 s25, 0
Lwd62:
v_bfe_u32 v76, v1, 6, 2
v_bfe_u32 v77, v1, 4, 1
v_lshl_add_u32 v76, v76, 1, v77
v_mul_u32_u24 v76, 1152, v76
v_bfe_u32 v77, v1, 5, 1
v_lshl_add_u32 v76, v77, 4, v76
v_lshrrev_b32 v77, 8, v1
v_lshl_add_u32 v76, v77, 5, v76
buffer_load_dwordx4 v[16:19], v76, s[32:35], 0 offen offset:256
buffer_load_dwordx4 v[36:39], v76, s[32:35], 0 offen offset:896
buffer_load_dwordx4 v[40:43], v76, s[32:35], 0 offen offset:1024
s_barrier
s_add_u32 s40, s56, 7168
v_mov_b64 v[44:45], 0
v_mov_b64 v[46:47], 0
v_mov_b64 v[48:49], 0
v_mov_b64 v[50:51], 0
v_mov_b64 v[52:53], 0
v_mov_b64 v[54:55], 0
v_mov_b64 v[56:57], 0
v_mov_b64 v[58:59], 0
ds_read_b128 v[60:63], v6 offset:12288
ds_read_b128 v[64:67], v6 offset:13312
ds_read_b128 v[68:71], v6 offset:14336
ds_read_b128 v[72:75], v6 offset:15360
CHf3_step:
s_mov_b32 s29, 0
s_waitcnt vmcnt(0)
Lgc63:
v_max3_u32 v76, v36, v37, v38
v_max3_u32 v77, v40, v41, v42
v_max_u32 v76, v76, v39
v_max_u32 v77, v77, v43
v_cmp_eq_u32 s[94:95], -1, v76
v_cmp_eq_u32 vcc, -1, v77
s_or_b64 s[68:69], s[94:95], vcc
s_cbranch_scc0 Lgd64
s_mov_b64 exec, s[94:95]
buffer_load_dwordx4 v[36:39], v1, s[4:7], s40 offen offset:0 sc1
s_mov_b64 exec, vcc
buffer_load_dwordx4 v[40:43], v1, s[4:7], s40 offen offset:1024 sc1
s_mov_b64 exec, -1
s_add_u32 s29, s29, 1
s_add_u32 s90, s90, 1
s_cmp_lt_u32 s29, s25
s_waitcnt vmcnt(0)
s_cbranch_scc1 Lgc63
s_mov_b32 s25, 0
Lgd64:
ds_write_b128 v1, v[36:39] offset:6144
ds_write_b128 v1, v[40:43] offset:7168
s_add_u32 s41, s38, 8192
s_add_u32 s39, s56, 2048
s_cmp_eq_u32 s37, 0
s_waitcnt lgkmcnt(4)
v_smfmac_f32_16x16x64_bf16 v[44:47], v[36:39], v[60:67], v0
s_waitcnt lgkmcnt(2)
ds_read_b128 v[60:63], v6 offset:0
v_smfmac_f32_16x16x64_bf16 v[48:51], v[36:39], v[68:75], v0
ds_read_b128 v[64:67], v6 offset:1024
v_smfmac_f32_16x16x64_bf16 v[52:55], v[36:39], a[192:199], v0
s_waitcnt lgkmcnt(2)
s_barrier
ds_read_b128 v[8:11], v1 offset:0
v_smfmac_f32_16x16x64_bf16 v[56:59], v[36:39], a[200:207], v0
s_cbranch_scc1 CHf3_n8
buffer_load_dwordx4 v[16:19], v1, s[4:7], s39 offen sc1
CHf3_n8:
ds_read_b128 v[12:15], v1 offset:1024
v_smfmac_f32_16x16x64_bf16 v[52:55], v[40:43], a[208:215], v0
ds_read_b128 v[20:23], v1 offset:2048
buffer_load_dwordx4 v[68:71], v1, s[4:7], s41 offen offset:0 sc1
v_smfmac_f32_16x16x64_bf16 v[56:59], v[40:43], a[216:223], v0
ds_read_b128 v[24:27], v1 offset:3072
buffer_load_dwordx4 v[72:75], v1, s[4:7], s41 offen offset:1024 sc1
v_smfmac_f32_16x16x64_bf16 v[44:47], v[40:43], a[64:71], v0
ds_read_b128 v[28:31], v1 offset:4096
v_smfmac_f32_16x16x64_bf16 v[48:51], v[40:43], a[72:79], v0
s_waitcnt lgkmcnt(4)
ds_read_b128 v[32:35], v1 offset:5120
v_smfmac_f32_16x16x64_bf16 v[44:47], v[8:11], v[60:67], v0
ds_read_b128 v[60:63], v6 offset:2048
ds_read_b128 v[64:67], v6 offset:3072
v_smfmac_f32_16x16x64_bf16 v[52:55], v[8:11], a[80:87], v0
v_smfmac_f32_16x16x64_bf16 v[56:59], v[8:11], a[88:95], v0
s_waitcnt lgkmcnt(6)
buffer_load_dword v3, off, s[4:7], s43 offset:8 sc1
v_smfmac_f32_16x16x64_bf16 v[52:55], v[12:15], a[96:103], v0
v_smfmac_f32_16x16x64_bf16 v[56:59], v[12:15], a[104:111], v0
s_waitcnt lgkmcnt(0)
v_smfmac_f32_16x16x64_bf16 v[48:51], v[8:11], v[60:67], v0
ds_read_b128 v[60:63], v6 offset:4096
ds_read_b128 v[64:67], v6 offset:5120
v_smfmac_f32_16x16x64_bf16 v[52:55], v[20:23], a[128:135], v0
s_barrier
v_smfmac_f32_16x16x64_bf16 v[56:59], v[20:23], a[136:143], v0
s_lshr_b32 s41, s42, 10
s_sub_u32 s41, s41, 8196
v_smfmac_f32_16x16x64_bf16 v[52:55], v[24:27], a[144:151], v0
s_cmp_lg_u32 s37, 0
s_cselect_b64 s[48:49], 1, 0
v_smfmac_f32_16x16x64_bf16 v[56:59], v[24:27], a[152:159], v0
s_waitcnt lgkmcnt(0)
v_smfmac_f32_16x16x64_bf16 v[44:47], v[20:23], v[60:67], v0
ds_read_b128 v[60:63], v6 offset:6144
ds_read_b128 v[64:67], v6 offset:7168
v_smfmac_f32_16x16x64_bf16 v[52:55], v[28:31], a[160:167], v0
v_smfmac_f32_16x16x64_bf16 v[56:59], v[28:31], a[168:175], v0
v_smfmac_f32_16x16x64_bf16 v[52:55], v[32:35], a[176:183], v0
v_smfmac_f32_16x16x64_bf16 v[56:59], v[32:35], a[184:191], v0
s_waitcnt lgkmcnt(0)
v_smfmac_f32_16x16x64_bf16 v[48:51], v[20:23], v[60:67], v0
s_waitcnt vmcnt(3)
ds_read_b128 v[60:63], v6 offset:8192
ds_read_b128 v[64:67], v6 offset:9216
v_smfmac_f32_16x16x64_bf16 v[52:55], v[16:19], a[112:119], v0
v_smfmac_f32_16x16x64_bf16 v[56:59], v[16:19], a[120:127], v0
v_smfmac_f32_16x16x64_bf16 v[44:47], v[12:15], a[0:7], v0
v_add_f32 v52, v52, v54
v_smfmac_f32_16x16x64_bf16 v[48:51], v[12:15], a[8:15], v0
s_waitcnt lgkmcnt(0)
v_add_f32 v56, v56, v58
v_smfmac_f32_16x16x64_bf16 v[44:47], v[28:31], v[60:67], v0
ds_read_b128 v[60:63], v6 offset:10240
ds_read_b128 v[64:67], v6 offset:11264
v_add_f32 v53, v53, v55
v_smfmac_f32_16x16x64_bf16 v[44:47], v[24:27], a[32:39], v0
v_add_f32 v57, v57, v59
v_smfmac_f32_16x16x64_bf16 v[48:51], v[24:27], a[40:47], v0
v_cvt_pk_bf16_f32 v78, v52, v56
v_smfmac_f32_16x16x64_bf16 v[44:47], v[32:35], a[48:55], v0
s_waitcnt lgkmcnt(0)
v_cvt_pk_bf16_f32 v79, v53, v57
v_smfmac_f32_16x16x64_bf16 v[48:51], v[28:31], v[60:67], v0
v_smfmac_f32_16x16x64_bf16 v[48:51], v[32:35], a[56:63], v0
ds_write2_b32 v4, v78, v79 offset0:0 offset1:4
v_mov_b64 v[60:61], 0
v_smfmac_f32_16x16x64_bf16 v[44:47], v[16:19], a[16:23], v0
v_mov_b64 v[62:63], 0
v_smfmac_f32_16x16x64_bf16 v[48:51], v[16:19], a[24:31], v0
v_mov_b64 v[64:65], 0
v_mov_b64 v[66:67], 0
v_smfmac_f32_16x16x64_bf16 v[60:63], v[8:11], a[224:231], v0
v_add_f32 v44, v44, v46
v_add_f32 v45, v45, v47
v_smfmac_f32_16x16x64_bf16 v[64:67], v[8:11], a[232:239], v0
v_add_f32 v48, v48, v50
v_add_f32 v49, v49, v51
v_smfmac_f32_16x16x64_bf16 v[60:63], v[12:15], a[240:247], v0
v_cvt_pk_bf16_f32 v76, v44, v48
v_cvt_pk_bf16_f32 v77, v45, v49
v_smfmac_f32_16x16x64_bf16 v[64:67], v[12:15], a[248:255], v0
ds_write2_b32 v4, v76, v77 offset0:8 offset1:12
v_smfmac_f32_16x16x64_bf16 v[60:63], v[16:19], v[80:87], v0
v_smfmac_f32_16x16x64_bf16 v[64:67], v[16:19], v[88:95], v0
s_waitcnt vmcnt(1)
v_smfmac_f32_16x16x64_bf16 v[60:63], v[20:23], v[96:103], v0
s_add_u32 s39, s42, 2048
v_smfmac_f32_16x16x64_bf16 v[64:67], v[20:23], v[104:111], v0
s_mov_b64 exec, s[48:49]
buffer_store_dword v0, off, s[4:7], s41 sc1
s_mov_b64 exec, -1
v_smfmac_f32_16x16x64_bf16 v[60:63], v[24:27], v[112:119], v0
v_smfmac_f32_16x16x64_bf16 v[64:67], v[24:27], v[120:127], v0
s_waitcnt lgkmcnt(0)
s_barrier
ds_read_b128 v[44:47], v1 offset:3072
v_smfmac_f32_16x16x64_bf16 v[60:63], v[28:31], v[128:135], v0
ds_read_b128 v[48:51], v1 offset:4096
v_smfmac_f32_16x16x64_bf16 v[64:67], v[28:31], v[136:143], v0
ds_read_b128 v[52:55], v1 offset:5120
v_smfmac_f32_16x16x64_bf16 v[60:63], v[32:35], v[144:151], v0
ds_read_b128 v[56:59], v1 offset:6144
v_smfmac_f32_16x16x64_bf16 v[64:67], v[32:35], v[152:159], v0
ds_read_b128 v[8:11], v1 offset:8192
v_smfmac_f32_16x16x64_bf16 v[60:63], v[36:39], v[160:167], v0
ds_read_b128 v[16:19], v1 offset:9216
v_smfmac_f32_16x16x64_bf16 v[64:67], v[36:39], v[168:175], v0
ds_read_b128 v[20:23], v1 offset:10240
v_smfmac_f32_16x16x64_bf16 v[60:63], v[40:43], v[176:183], v0
s_waitcnt lgkmcnt(3)
ds_read_b128 v[24:27], v1 offset:11264
v_smfmac_f32_16x16x64_bf16 v[64:67], v[40:43], v[184:191], v0
ds_read_b128 v[12:15], v1 offset:12288
v_mfma_f32_16x16x32_bf16 v[76:79], v[44:47], v[44:47], 0
ds_read_b128 v[28:31], v1 offset:13312
v_add_f32 v60, v60, v62
v_lshrrev_b32 v41, 1, v1
v_mfma_f32_16x16x32_bf16 v[76:79], v[48:51], v[48:51], v[76:79]
ds_read_b128 v[32:35], v1 offset:14336
v_add_f32 v61, v61, v63
v_mfma_f32_16x16x32_bf16 v[76:79], v[52:55], v[52:55], v[76:79]
s_waitcnt lgkmcnt(3)
ds_read_b128 v[36:39], v1 offset:15360
v_add_f32 v64, v64, v66
v_add_f32 v65, v65, v67
v_mfma_f32_16x16x32_bf16 v[76:79], v[56:59], v[56:59], v[76:79]
s_waitcnt lgkmcnt(3)
v_cvt_pk_bf16_f32 v42, v60, v61
v_cvt_pk_bf16_f32 v43, v64, v65
v_mfma_f32_16x16x32_bf16 v[8:11], v[8:11], v[44:47], 0
v_mfma_f32_16x16x32_bf16 v[8:11], v[16:19], v[48:51], v[8:11]
buffer_store_dwordx2 v[42:43], v41, s[4:7], s39 offen offset:1536 sc1
v_mfma_f32_16x16x32_bf16 v[8:11], v[20:23], v[52:55], v[8:11]
v_mfma_f32_16x16x32_bf16 v[8:11], v[24:27], v[56:59], v[8:11]
s_andn2_b64 exec, exec, s[44:45]
buffer_store_dwordx4 v[56:59], v5, s[4:7], s42 offen sc1
s_mov_b64 exec, -1
v_mfma_f32_16x16x32_bf16 v[12:15], v[12:15], v[44:47], 0
s_waitcnt lgkmcnt(0)
v_mov_b32 v16, 0x3f803f80
v_mov_b32 v17, v16
v_mfma_f32_16x16x32_bf16 v[12:15], v[28:31], v[48:51], v[12:15]
v_mov_b64 v[18:19], v[16:17]
v_max3_f32 v40, v76, v77, v8
v_mfma_f32_16x16x32_bf16 v[12:15], v[32:35], v[52:55], v[12:15]
v_max3_f32 v40, v40, v9, v10
v_max_f32 v40, v40, v11
v_mfma_f32_16x16x32_bf16 v[12:15], v[36:39], v[56:59], v[12:15]
ds_read_b128 v[44:47], v6 offset:16384
ds_read_b128 v[48:51], v6 offset:17408
v_mov_b32 v21, 0
v_mov_b32 v22, 0
s_cmp_eq_u32 s37, 63
s_cbranch_scc1 CHf3_end
s_nop 1
v_max3_f32 v40, v40, v12, v13
v_max3_f32 v41, v40, v14, v15
v_max3_f32 v40, v40, v14, v15
ds_read_b128 v[52:55], v6 offset:20480
ds_read_b128 v[56:59], v6 offset:21504
v_permlane16_swap_b32 v40, v41
v_max_f32 v40, v40, v41
v_max_f32 v41, v40, v41
ds_read_b128 v[32:35], v6 offset:18432
ds_read_b128 v[36:39], v6 offset:19456
v_permlane32_swap_b32 v40, v41
v_max_f32 v40, v40, v41
v_mul_f32 v40, s30, v40
v_pk_fma_f32 v[76:77], v[76:77], s[30:31], v[40:41] op_sel_hi:[1,0,0] neg_lo:[0,0,1] neg_hi:[0,0,1]
v_pk_fma_f32 v[8:9], v[8:9], s[30:31], v[40:41] op_sel_hi:[1,0,0] neg_lo:[0,0,1] neg_hi:[0,0,1]
v_pk_fma_f32 v[10:11], v[10:11], s[30:31], v[40:41] op_sel_hi:[1,0,0] neg_lo:[0,0,1] neg_hi:[0,0,1]
v_pk_fma_f32 v[12:13], v[12:13], s[30:31], v[40:41] op_sel_hi:[1,0,0] neg_lo:[0,0,1] neg_hi:[0,0,1]
v_pk_fma_f32 v[14:15], v[14:15], s[30:31], v[40:41] op_sel_hi:[1,0,0] neg_lo:[0,0,1] neg_hi:[0,0,1]
v_exp_f32 v76, v76
v_exp_f32 v77, v77
v_exp_f32 v8, v8
v_cvt_pk_bf16_f32 v20, v76, v77
v_cvt_pk_bf16_f32 v23, v76, v77
v_exp_f32 v9, v9
v_exp_f32 v10, v10
v_mfma_f32_16x16x16_bf16 v[28:31], v[16:17], v[20:21], 0
v_exp_f32 v11, v11
v_mfma_f32_16x16x16_bf16 v[60:63], v[42:43], v[20:21], 0
v_exp_f32 v12, v12
v_mfma_f32_16x16x16_bf16 v[64:67], v[42:43], v[22:23], 0
v_exp_f32 v13, v13
v_exp_f32 v14, v14
v_exp_f32 v15, v15
v_cvt_pk_bf16_f32 v24, v8, v9
v_cvt_pk_bf16_f32 v25, v10, v11
v_cvt_pk_bf16_f32 v26, v12, v13
v_cvt_pk_bf16_f32 v27, v14, v15
v_mov_b64 v[8:9], 0
v_mov_b64 v[10:11], 0
v_mfma_f32_16x16x32_bf16 v[28:31], v[16:19], v[24:27], v[28:31]
v_mov_b64 v[12:13], 0
v_mov_b64 v[14:15], 0
v_mfma_f32_16x16x32_bf16 v[60:63], v[68:71], v[24:27], v[60:63]
v_mov_b64 v[20:21], 0
v_mov_b64 v[22:23], 0
v_mfma_f32_16x16x32_bf16 v[64:67], v[72:75], v[24:27], v[64:67]
v_rcp_f32 v40, v28
v_mov_b64 v[16:17], 0
v_mov_b64 v[18:19], 0
s_mov_b64 exec, s[44:45]
v_mul_f32 v60, v60, v40
v_mul_f32 v61, v61, v40
v_mul_f32 v62, v62, v40
v_mul_f32 v63, v63, v40
v_cvt_pk_bf16_f32 v76, v60, v61
v_cvt_pk_bf16_f32 v77, v62, v63
ds_write_b64 v5, v[76:77] offset:0
v_pk_mul_f32 v[64:65], v[64:65], v[40:41] op_sel_hi:[1,0]
v_pk_mul_f32 v[66:67], v[66:67], v[40:41] op_sel_hi:[1,0]
v_cvt_pk_bf16_f32 v78, v64, v65
v_cvt_pk_bf16_f32 v79, v66, v67
ds_write_b64 v5, v[78:79] offset:8
s_mov_b64 exec, -1
ds_read_b128 v[60:63], v6 offset:22528
ds_read_b128 v[64:67], v6 offset:23552
v_mov_b64 v[24:25], 0
v_mov_b64 v[26:27], 0
v_mov_b64 v[28:29], 0
v_mov_b64 v[30:31], 0
v_mov_b32 v43, s31
s_waitcnt lgkmcnt(2)
s_barrier
ds_read_b128 v[68:71], v1 offset:0
ds_read_b128 v[72:75], v1 offset:1024
v_mov_b32 v79, s31
s_waitcnt lgkmcnt(1)
v_smfmac_f32_16x16x64_bf16 v[8:11], v[68:71], v[44:51], v0
s_waitcnt lgkmcnt(0)
ds_read_b128 v[44:47], v6 offset:24576
v_smfmac_f32_16x16x64_bf16 v[8:11], v[72:75], v[52:59], v0
ds_read_b128 v[48:51], v6 offset:25600
v_smfmac_f32_16x16x64_bf16 v[12:15], v[68:71], v[32:39], v0
ds_read_b128 v[52:55], v6 offset:28672
v_smfmac_f32_16x16x64_bf16 v[12:15], v[72:75], v[60:67], v0
ds_read_b128 v[56:59], v6 offset:29696
v_add_f32 v8, v8, v10
v_add_f32 v9, v9, v11
v_smfmac_f32_16x16x64_bf16 v[16:19], v[68:71], v[192:199], v0
ds_read_b128 v[32:35], v6 offset:26624
v_cvt_pk_bf16_f32 v40, v8, v9
v_smfmac_f32_16x16x64_bf16 v[16:19], v[72:75], v[200:207], v0
ds_read_b128 v[36:39], v6 offset:27648
v_add_f32 v12, v12, v14
v_add_f32 v13, v13, v15
v_smfmac_f32_16x16x64_bf16 v[20:23], v[68:71], v[208:215], v0
ds_read_b128 v[60:63], v6 offset:30720
v_cvt_pk_bf16_f32 v41, v12, v13
v_mov_b64 v[8:9], 0
v_smfmac_f32_16x16x64_bf16 v[20:23], v[72:75], v[216:223], v0
s_waitcnt lgkmcnt(5)
ds_read_b128 v[64:67], v6 offset:31744
v_add_f32 v16, v16, v18
v_add_f32 v17, v17, v19
v_cvt_pk_bf16_f32 v42, v16, v17
v_smfmac_f32_16x16x64_bf16 v[24:27], v[68:71], v[44:51], v0
s_waitcnt lgkmcnt(4)
ds_read_b128 v[44:47], v6 offset:32768
buffer_store_dwordx4 v[40:43], v2, s[4:7], s60 offen sc1
v_mov_b64 v[16:17], 0
v_mov_b64 v[10:11], 0
v_smfmac_f32_16x16x64_bf16 v[24:27], v[72:75], v[52:59], v0
s_waitcnt lgkmcnt(3)
ds_read_b128 v[48:51], v6 offset:33792
v_add_f32 v20, v20, v22
v_add_f32 v21, v21, v23
v_smfmac_f32_16x16x64_bf16 v[28:31], v[68:71], v[32:39], v0
s_waitcnt lgkmcnt(2)
ds_read_b128 v[52:55], v6 offset:34816
v_cvt_pk_bf16_f32 v76, v20, v21
v_mov_b64 v[18:19], 0
v_smfmac_f32_16x16x64_bf16 v[28:31], v[72:75], v[60:67], v0
ds_read_b128 v[56:59], v6 offset:35840
v_add_f32 v24, v24, v26
v_add_f32 v25, v25, v27
v_smfmac_f32_16x16x64_bf16 v[16:19], v[68:71], v[240:247], v0
v_cvt_pk_bf16_f32 v77, v24, v25
v_mov_b64 v[12:13], 0
v_smfmac_f32_16x16x64_bf16 v[16:19], v[72:75], v[248:255], v0
v_add_f32 v28, v28, v30
v_add_f32 v29, v29, v31
v_cvt_pk_bf16_f32 v78, v28, v29
v_smfmac_f32_16x16x64_bf16 v[8:11], v[68:71], v[224:231], v0
s_waitcnt lgkmcnt(2)
buffer_store_dwordx4 v[76:79], v2, s[4:7], s61 offen sc1
v_mov_b64 v[14:15], 0
v_smfmac_f32_16x16x64_bf16 v[8:11], v[72:75], v[44:51], v0
v_add_f32 v16, v16, v18
v_add_f32 v17, v17, v19
v_smfmac_f32_16x16x64_bf16 v[12:15], v[68:71], v[232:239], v0
s_waitcnt lgkmcnt(0)
s_add_u32 s43, s43, 4
s_add_u32 s37, s37, 1
v_cvt_pk_bf16_f32 v42, v16, v17
v_smfmac_f32_16x16x64_bf16 v[12:15], v[72:75], v[52:59], v0
s_add_u32 s38, s38, 16384
s_add_u32 s42, s42, 4096
v_add_f32 v8, v8, v10
v_add_f32 v9, v9, v11
v_cvt_pk_bf16_f32 v40, v8, v9
s_nop 2
v_pk_add_f32 v[12:13], v[12:13], v[14:15]
v_cvt_pk_bf16_f32 v41, v12, v13
buffer_store_dwordx4 v[40:43], v2, s[4:7], s62 offen sc1
s_waitcnt vmcnt(5)
s_cmp_ge_u32 s37, 63
s_cbranch_scc1 CHf3_kv
v_cmp_eq_u32 vcc, 0, v3
s_cbranch_vccz CHf3_kv
s_add_u32 s90, s90, 1
s_add_u32 s41, s43, 4
v_mov_b32 v76, 0
s_mov_b32 s29, 0
Lwf65:
buffer_load_dword v77, v76, s[4:7], s41 offen sc1
s_add_u32 s29, s29, 1
s_waitcnt vmcnt(0)
v_cmp_eq_u32 vcc, 0, v77
s_cbranch_vccz Lwd66
s_sleep 1
s_cmp_lt_u32 s29, s25
s_cbranch_scc1 Lwf65
s_mov_b32 s25, 0
Lwd66:
CHf3_kv:
v_mov_b64 v[44:45], 0
v_mov_b64 v[46:47], 0
v_mov_b64 v[48:49], 0
v_mov_b64 v[50:51], 0
v_mov_b64 v[52:53], 0
v_mov_b64 v[54:55], 0
v_mov_b64 v[56:57], 0
v_mov_b64 v[58:59], 0
ds_read_b128 v[60:63], v6 offset:12288
ds_read_b128 v[64:67], v6 offset:13312
ds_read_b128 v[68:71], v6 offset:14336
ds_read_b128 v[72:75], v6 offset:15360
s_mov_b32 s26, s56
s_mov_b32 s56, s57
s_mov_b32 s57, s58
s_mov_b32 s58, s26
s_add_u32 s31, s31, 1
s_add_u32 s40, s56, 7168
s_barrier
buffer_load_dwordx4 v[36:39], v1, s[4:7], s40 offen offset:0 sc1
buffer_load_dwordx4 v[40:43], v1, s[4:7], s40 offen offset:1024 sc1
s_branch CHf3_step
CHf3_end:
s_waitcnt lgkmcnt(0)
s_barrier
s_lshr_b32 s41, s42, 10
s_sub_u32 s41, s41, 8192
s_waitcnt vmcnt(0)
v_mov_b32 v76, 1
s_mov_b64 exec, 1
buffer_store_dword v76, off, s[4:7], s41 sc1
s_mov_b64 exec, -1
s_waitcnt vmcnt(0)
s_barrier
s_mov_b32 s26, s56
s_mov_b32 s56, s57
s_mov_b32 s57, s58
s_mov_b32 s58, s26
s_add_u32 s36, s36, 1
s_cmp_lt_u32 s36, 2
s_cbranch_scc1 CHf3_layer
s_branch END
s_endpgm
.section .rodata,"a"
.p2align 6
.amdhsa_kernel interleave_layers__linear_attn_block__memory_aug_recurrent_mem_tr__prompt_kernel
  .amdhsa_next_free_vgpr 512
  .amdhsa_next_free_sgpr 102
  .amdhsa_accum_offset 256
  .amdhsa_group_segment_fixed_size 0
  .amdhsa_kernarg_size 104
  .amdhsa_user_sgpr_count 2
  .amdhsa_user_sgpr_kernarg_segment_ptr 1
  .amdhsa_system_sgpr_workgroup_id_x 1
.end_amdhsa_kernel
```
